```python
import torch

def _softmax(x, axis=-1):
    return torch.softmax(x, dim=axis)
def _gelu(x):
    return torch.nn.functional.gelu(x, approximate="tanh")
def _silu(x):
    return torch.nn.functional.silu(x)
def _sigmoid(x):
    return torch.sigmoid(x)
def _layernorm(x, axis=-1, eps=1e-5):
    m = x.mean(dim=axis, keepdim=True)
    v = x.var(dim=axis, keepdim=True, unbiased=False)
    return (x - m) / torch.sqrt(v + eps)
def _scatter_add(tgt, idx, src, axis=0):
    return tgt.clone().index_add_(axis, idx, src)
def _segment_sum(src, seg, n):
    out = torch.zeros((n,) + src.shape[1:], dtype=src.dtype)
    return out.index_add_(0, seg, src)
def _pad(x, pw):
    flat = tuple(v for pair in reversed(pw) for v in pair)
    return torch.nn.functional.pad(x, flat)

kernel_name = 'interleave_layers__linear_attn_block__glu_gated_swiglu__prompt'

def setup_inputs():

    _w = (lambda a: (lambda t: t.to(torch.bfloat16) if t.is_floating_point() else t)(torch.as_tensor(a)))
    def _A_setup():
        B, S, D = 1, 2048, 640
        return {
            "x": _w((lambda *s: torch.randn(*s, dtype=torch.bfloat16) * 0.05)(B, S, D)),
            "wqkv": _w((lambda *s: torch.randn(*s, dtype=torch.bfloat16) * 0.05)(D, 3 * D)),
            "wo": _w((lambda *s: torch.randn(*s, dtype=torch.bfloat16) * 0.05)(D, D)),
        }
    _A_in = _A_setup()

    def _B_setup():
        B, S, D, F = 1, 2048, 640, 1536
        return {
            "x": _w((lambda *s: torch.randn(*s, dtype=torch.bfloat16) * 0.05)(B, S, D)),
            "w1": _w((lambda *s: torch.randn(*s, dtype=torch.bfloat16) * 0.4)(D, F) * (2.0 / D) ** 0.5),
            "w3": _w((lambda *s: torch.randn(*s, dtype=torch.bfloat16) * 0.4)(D, F) * (2.0 / D) ** 0.5),
            "w2": _w((lambda *s: torch.randn(*s, dtype=torch.bfloat16) * 0.4)(F, D) * (2.0 / F) ** 0.5),
        }
    _B_in = _B_setup()

    return {
        "A_x": _A_in["x"],
        "A_wqkv": _A_in["wqkv"],
        "A_wo": _A_in["wo"],
        "B_x": _B_in["x"],
        "B_w1": _B_in["w1"],
        "B_w3": _B_in["w3"],
        "B_w2": _B_in["w2"],
    }

def reference(A_x, A_wqkv, A_wo, B_x, B_w1, B_w3, B_w2):
    def _A_ref(x, wqkv, wo):
        B, S, D = x.shape
        H = 32; Dh = D // H
        qkv = (lambda x, *d: x.permute(*d))((x @ wqkv).reshape(B, S, 3, H, Dh), 2, 0, 3, 1, 4)
        q, k, v = qkv[0], qkv[1], qkv[2]
        phi = lambda t: torch.where(t > 0, t + 1, torch.exp(t)) + 1e-6
        pq, pk = phi(q), phi(k)
        kv = torch.einsum("bhsd,bhse->bhde", pk, v)
        z = torch.einsum("bhsd->bhd", pk)
        num = torch.einsum("bhqd,bhde->bhqe", pq, kv)
        den = torch.einsum("bhqd,bhd->bhq", pq, z)[..., None] + 1e-6
        o = num / den
        return (lambda x, *d: x.permute(*d))(o, 0, 2, 1, 3).reshape(B, S, D) @ wo

    def _B_ref(x, w1, w3, w2):
        gate = torch.einsum("bsd,df->bsf", x, w1)
        up = torch.einsum("bsd,df->bsf", x, w3)
        h = _silu(gate) * up
        out = torch.einsum("bsf,fd->bsd", h, w2)
        return out

    x = A_x
    x = x + _A_ref(_layernorm(x, axis=-1), A_wqkv, A_wo)
    x = x + _B_ref(_layernorm(x, axis=-1), B_w1, B_w3, B_w2)
    x = x + _A_ref(_layernorm(x, axis=-1), A_wqkv, A_wo)
    x = x + _B_ref(_layernorm(x, axis=-1), B_w1, B_w3, B_w2)
    return x
```

```asm
; @launch grid=(256,1,1) block=(256,1,1) lds=163840
.amdgcn_target "amdgcn-amd-amdhsa--gfx950"
.text
.globl interleave_layers__linear_attn_block__glu_gated_swiglu__prompt_kernel
.p2align 8
.type interleave_layers__linear_attn_block__glu_gated_swiglu__prompt_kernel,@function
interleave_layers__linear_attn_block__glu_gated_swiglu__prompt_kernel:
    s_cmp_ge_u32 s2, 256
    s_cbranch_scc1 L_end
    s_getpc_b64 s[46:47]
    v_lshlrev_b32 v64, 6, v0
    v_mov_b32 v67, s47
    v_add_co_u32 v66, vcc, s46, v64
    s_nop 1
    v_addc_co_u32 v67, vcc, 0, v67, vcc
    global_load_dword v150, v[66:67], off
L_noipf:
    s_load_dwordx2 s[44:45], s[0:1], 56
    s_load_dwordx2 s[12:13], s[0:1], 72
    s_load_dwordx2 s[68:69], s[0:1], 64
    v_and_b32 v1, 63, v0
    v_lshlrev_b32 v2, 4, v1
    v_lshlrev_b32 v3, 4, v0
    v_lshrrev_b32 v30, 6, v0
    s_nop 0
    v_readfirstlane_b32 s3, v30
    s_waitcnt lgkmcnt(0)
    s_mov_b32 s4, s12
    s_and_b32 s5, s13, 0xffff
    s_mov_b32 s6, 62914560
    s_mov_b32 s7, 0x20000
    s_mov_b32 s64, s12
    s_and_b32 s65, s13, 0xffff
    s_mov_b32 s66, 62914560
    s_mov_b32 s67, 0x20000
    s_mov_b32 s8, s44
    s_and_b32 s9, s45, 0xffff
    s_mov_b32 s10, 2621440
    s_mov_b32 s11, 0x20000
    s_mov_b32 s16, 0
    s_mov_b32 s17, 12582912
    s_mov_b32 s18, 0
    s_lshl_b32 s58, s3, 8
    s_add_u32 s58, s58, s2
    s_mov_b32 s59, 0
    s_sub_u32 s46, 511, s2
    s_cmp_eq_u32 s3, 1
    s_cselect_b32 s58, s46, s58
    s_cmp_ge_u32 s58, 120
    s_cselect_b32 s59, 2, s59
    s_cmp_ge_u32 s58, 160
    s_cselect_b32 s59, 1, s59
    s_cmp_ge_u32 s58, 352
    s_cselect_b32 s59, 2, s59
    s_cmp_ge_u32 s58, 448
    s_cselect_b32 s59, 5, s59
    s_cmp_eq_u32 s3, 2
    s_cselect_b32 s59, 3, s59
    s_cselect_b32 s58, s2, s58
    s_cmp_eq_u32 s3, 3
    s_cselect_b32 s59, 4, s59
    s_cmp_lg_u32 s59, 0
    s_cbranch_scc1 Ls0n_2
    s_load_dwordx2 s[52:53], s[0:1], 8
    s_waitcnt lgkmcnt(0)
    s_mov_b32 s64, s52
    s_and_b32 s65, s53, 0xffff
    s_mov_b32 s66, 2457600
    s_mov_b32 s67, 0x20000
    s_mul_i32 s44, s58, 137
    s_lshr_b32 s44, s44, 12
    s_mul_i32 s46, s44, 30
    s_sub_u32 s45, s58, s46
    v_lshrrev_b32 v65, 3, v1
    v_and_b32 v66, 7, v1
    v_mul_u32_u24 v65, 3840, v65
    v_lshl_add_u32 v65, v66, 4, v65
    s_mul_i32 s46, s44, 614400
    s_lshl_b32 s47, s45, 7
    s_add_u32 s46, s46, s47
    s_mul_i32 s47, s3, 20480
    s_add_u32 s47, s47, 98304
    s_add_u32 m0, s47, 0
    s_nop 0
    buffer_load_dwordx4 v65, s[64:67], s46 offen lds
    s_add_u32 s46, s46, 30720
    s_add_u32 m0, s47, 1024
    s_nop 0
    buffer_load_dwordx4 v65, s[64:67], s46 offen lds
    s_add_u32 s46, s46, 30720
    s_add_u32 m0, s47, 2048
    s_nop 0
    buffer_load_dwordx4 v65, s[64:67], s46 offen lds
    s_add_u32 s46, s46, 30720
    s_add_u32 m0, s47, 3072
    s_nop 0
    buffer_load_dwordx4 v65, s[64:67], s46 offen lds
    s_add_u32 s46, s46, 30720
    s_add_u32 m0, s47, 4096
    s_nop 0
    buffer_load_dwordx4 v65, s[64:67], s46 offen lds
    s_add_u32 s46, s46, 30720
    s_add_u32 m0, s47, 5120
    s_nop 0
    buffer_load_dwordx4 v65, s[64:67], s46 offen lds
    s_add_u32 s46, s46, 30720
    s_add_u32 m0, s47, 6144
    s_nop 0
    buffer_load_dwordx4 v65, s[64:67], s46 offen lds
    s_add_u32 s46, s46, 30720
    s_add_u32 m0, s47, 7168
    s_nop 0
    buffer_load_dwordx4 v65, s[64:67], s46 offen lds
    s_add_u32 s46, s46, 30720
    s_add_u32 m0, s47, 8192
    s_nop 0
    buffer_load_dwordx4 v65, s[64:67], s46 offen lds
    s_add_u32 s46, s46, 30720
    s_add_u32 m0, s47, 9216
    s_nop 0
    buffer_load_dwordx4 v65, s[64:67], s46 offen lds
    s_add_u32 s46, s46, 30720
    s_add_u32 m0, s47, 10240
    s_nop 0
    buffer_load_dwordx4 v65, s[64:67], s46 offen lds
    s_add_u32 s46, s46, 30720
    s_add_u32 m0, s47, 11264
    s_nop 0
    buffer_load_dwordx4 v65, s[64:67], s46 offen lds
    s_add_u32 s46, s46, 30720
    s_add_u32 m0, s47, 12288
    s_nop 0
    buffer_load_dwordx4 v65, s[64:67], s46 offen lds
    s_add_u32 s46, s46, 30720
    s_add_u32 m0, s47, 13312
    s_nop 0
    buffer_load_dwordx4 v65, s[64:67], s46 offen lds
    s_add_u32 s46, s46, 30720
    s_add_u32 m0, s47, 14336
    s_nop 0
    buffer_load_dwordx4 v65, s[64:67], s46 offen lds
    s_add_u32 s46, s46, 30720
    s_add_u32 m0, s47, 15360
    s_nop 0
    buffer_load_dwordx4 v65, s[64:67], s46 offen lds
    s_add_u32 s46, s46, 30720
    s_add_u32 m0, s47, 16384
    s_nop 0
    buffer_load_dwordx4 v65, s[64:67], s46 offen lds
    s_add_u32 s46, s46, 30720
    s_add_u32 m0, s47, 17408
    s_nop 0
    buffer_load_dwordx4 v65, s[64:67], s46 offen lds
    s_add_u32 s46, s46, 30720
    s_add_u32 m0, s47, 18432
    s_nop 0
    buffer_load_dwordx4 v65, s[64:67], s46 offen lds
    s_add_u32 s46, s46, 30720
    s_add_u32 m0, s47, 19456
    s_nop 0
    buffer_load_dwordx4 v65, s[64:67], s46 offen lds
    s_add_u32 s46, s46, 30720
    s_branch Ls0p1_1
Ls0n_2:
    s_cmp_lg_u32 s59, 3
    s_cbranch_scc1 Ls0n_3
    s_load_dwordx2 s[52:53], s[0:1], 0
    s_waitcnt lgkmcnt(0)
    s_mov_b32 s64, s52
    s_and_b32 s65, s53, 0xffff
    s_mov_b32 s66, 2621440
    s_mov_b32 s67, 0x20000
    s_mul_i32 s46, s58, 10240
    v_and_b32 v65, 7, v1
    v_lshrrev_b32 v66, 3, v1
    v_mul_u32_u24 v67, 1280, v65
    v_lshl_add_u32 v67, v66, 4, v67
    buffer_load_dwordx4 v[76:79], v67, s[64:67], s46 offen offset:0
    buffer_load_dwordx4 v[80:83], v67, s[64:67], s46 offen offset:128
    buffer_load_dwordx4 v[84:87], v67, s[64:67], s46 offen offset:256
    buffer_load_dwordx4 v[88:91], v67, s[64:67], s46 offen offset:384
    buffer_load_dwordx4 v[92:95], v67, s[64:67], s46 offen offset:512
    buffer_load_dwordx4 v[96:99], v67, s[64:67], s46 offen offset:640
    buffer_load_dwordx4 v[100:103], v67, s[64:67], s46 offen offset:768
    buffer_load_dwordx4 v[104:107], v67, s[64:67], s46 offen offset:896
    buffer_load_dwordx4 v[108:111], v67, s[64:67], s46 offen offset:1024
    buffer_load_dwordx4 v[112:115], v67, s[64:67], s46 offen offset:1152
    s_branch Ls0p1_1
Ls0n_3:
    s_cmp_lg_u32 s59, 4
    s_cbranch_scc1 Ls0n_4
    s_sub_u32 s47, s2, 120
    s_cmp_ge_u32 s47, 20
    s_cbranch_scc1 Ls0b_5
    v_mov_b32 v64, 0
    v_mul_u32_u24 v65, 256, v1
    s_mul_i32 s46, s47, 16384
    buffer_store_dword v64, v65, s[4:7], s46 offen sc1
    s_mov_b64 exec, 1
    buffer_store_dword v64, v65, s[4:7], s46 offen offset:128 sc1
    s_mov_b64 exec, -1
    s_and_b32 s48, s47, 15
    s_cselect_b32 s48, 128, 0
    s_getreg_b32 s46, hwreg(HW_REG_XCC_ID)
    s_sub_u32 s46, s46, s2
    s_and_b32 s46, s46, 7
    s_lshl_b32 s46, s46, 8
    s_cmp_eq_u32 s47, 0
    s_cselect_b32 s46, s46, 0
    s_add_u32 s46, s46, 1
    s_waitcnt vmcnt(0)
    s_atomic_add s46, s[68:69], s48
Ls0b_5:
    s_cmp_lt_u32 s2, 120
    s_cbranch_scc1 Ls0c_6
    s_getpc_b64 s[50:51]
Ls0c_6_pc:
    s_sub_u32 s50, s50, Ls0c_6_pc-interleave_layers__linear_attn_block__glu_gated_swiglu__prompt_kernel
    s_subb_u32 s51, s51, 0
    s_lshr_b32 s52, s47, 3
    s_lshl_b32 s52, s52, 12
    v_lshlrev_b32 v68, 6, v1
    v_add_u32 v68, s52, v68
    v_cmp_gt_u32 vcc, L_end-interleave_layers__linear_attn_block__glu_gated_swiglu__prompt_kernel-4, v68
    v_mov_b32 v71, s51
    v_add_co_u32 v70, s[54:55], s50, v68
    s_nop 1
    v_addc_co_u32 v71, s[54:55], 0, v71, s[54:55]
    s_and_saveexec_b64 s[54:55], vcc
    s_cbranch_execz Ls0c_6
    global_load_dword v72, v[70:71], off
Ls0c_6:
    s_mov_b64 exec, -1
    s_branch Ls0p1_1
Ls0n_4:
    s_cmp_ge_u32 s2, 32
    s_cbranch_scc1 Ls0p1_1
    s_lshl_b32 s46, s2, 8
    s_add_u32 s46, s46, 393216
    s_add_u32 s47, s46, 8192
    s_mov_b32 s54, 0
    s_atomic_add s54, s[12:13], s46
    s_atomic_add s54, s[12:13], s47
Ls0p1_1:
    s_getreg_b32 s100, hwreg(HW_REG_XCC_ID)
    s_sub_u32 s100, s100, s2
    s_and_b32 s100, s100, 7
    s_mov_b32 s101, 0
L_ij:
    s_add_u32 s45, s2, s100
    s_and_b32 s45, s45, 7
    s_lshr_b32 s46, s45, 1
    s_lshl_b32 s46, s46, 2
    s_lshr_b32 s47, s2, 3
    s_and_b32 s47, s47, 3
    s_add_u32 s14, s46, s47
    s_and_b32 s46, s45, 1
    s_lshl_b32 s46, s46, 3
    s_lshr_b32 s47, s2, 5
    s_add_u32 s15, s46, s47
    s_lshl_b32 s19, s3, 10
    s_lshr_b32 s48, s15, 1
    s_and_b32 s49, s15, 1
    s_mul_i32 s20, s15, 167936
    s_add_u32 s20, s20, 524288
    s_mul_i32 s21, s48, 102400
    s_add_u32 s21, s21, 3211264
    s_mul_i32 s22, s15, 253952
    s_add_u32 s22, s22, 4030464
    s_mul_i32 s23, s48, 245760
    s_add_u32 s23, s23, 8093696
    s_lshl_b32 s83, s48, 2
    s_add_u32 s83, s83, s3
    s_lshl_b32 s24, s14, 2
    s_add_u32 s24, s24, s3
    s_lshr_b32 s46, s24, 5
    s_lshr_b32 s47, s24, 4
    s_xor_b32 s46, s46, s47
    s_and_b32 s46, s46, 1
    s_lshl_b32 s46, s46, 13
    s_and_b32 s47, s24, 31
    s_lshl_b32 s27, s47, 17
    s_add_u32 s27, s27, s46
    s_bfe_u32 s46, s24, 131072
    s_lshl_b32 s46, s46, 10
    s_add_u32 s27, s27, s46
    s_bfe_u32 s28, s24, 0x30002
    s_lshl_b32 s28, s28, 14
    s_bfe_u32 s46, s24, 65541
    s_lshl_b32 s46, s46, 13
    s_add_u32 s28, s28, s46
    s_bfe_u32 s46, s24, 131072
    s_lshl_b32 s46, s46, 11
    s_add_u32 s28, s28, s46
    s_lshl_b32 s84, s3, 11
    s_mul_i32 s85, s3, 3072
    s_lshl_b32 s86, s3, 12
    s_lshl_b32 s25, s14, 3
    s_lshl_b32 s46, s49, 2
    s_add_u32 s25, s25, s46
    s_add_u32 s25, s25, s3
    s_lshr_b32 s26, s25, 1
    s_and_b32 s50, s25, 1
    s_lshr_b32 s46, s25, 6
    s_lshr_b32 s47, s25, 5
    s_xor_b32 s46, s46, s47
    s_and_b32 s46, s46, 1
    s_lshl_b32 s46, s46, 13
    s_and_b32 s47, s25, 63
    s_lshl_b32 s29, s47, 16
    s_add_u32 s29, s29, s46
    s_bfe_u32 s46, s25, 131072
    s_lshl_b32 s46, s46, 10
    s_add_u32 s29, s29, s46
    s_lshr_b32 s46, s25, 6
    s_lshr_b32 s47, s25, 4
    s_xor_b32 s46, s46, s47
    s_and_b32 s46, s46, 1
    s_lshl_b32 s46, s46, 13
    s_and_b32 s47, s25, 63
    s_lshl_b32 s30, s47, 17
    s_add_u32 s30, s30, s46
    s_bfe_u32 s46, s25, 65537
    s_lshl_b32 s46, s46, 14
    s_add_u32 s30, s30, s46
    s_lshr_b32 s46, s26, 5
    s_lshr_b32 s47, s26, 4
    s_xor_b32 s46, s46, s47
    s_and_b32 s46, s46, 1
    s_lshl_b32 s46, s46, 13
    s_and_b32 s47, s26, 31
    s_lshl_b32 s31, s47, 17
    s_add_u32 s31, s31, s46
    s_bfe_u32 s46, s26, 131072
    s_lshl_b32 s46, s46, 10
    s_add_u32 s31, s31, s46
    s_bfe_u32 s32, s26, 0x30002
    s_lshl_b32 s32, s32, 14
    s_bfe_u32 s46, s26, 65541
    s_lshl_b32 s46, s46, 13
    s_add_u32 s32, s32, s46
    s_bfe_u32 s46, s26, 131072
    s_lshl_b32 s46, s46, 11
    s_add_u32 s32, s32, s46
    s_lshl_b32 s46, s48, 14
    s_add_u32 s31, s31, s46
    s_lshl_b32 s46, s50, 8
    s_add_u32 s31, s31, s46
    s_lshl_b32 s46, s48, 8
    s_add_u32 s32, s32, s46
    s_lshl_b32 s46, s50, 7
    s_add_u32 s32, s32, s46
    s_lshr_b32 s46, s24, 5
    s_lshr_b32 s47, s24, 4
    s_xor_b32 s46, s46, s47
    s_and_b32 s46, s46, 1
    s_lshl_b32 s46, s46, 13
    s_and_b32 s47, s24, 31
    s_lshl_b32 s33, s47, 17
    s_add_u32 s33, s33, s46
    s_bfe_u32 s46, s24, 65536
    s_lshl_b32 s46, s46, 11
    s_add_u32 s33, s33, s46
    s_lshr_b32 s46, s24, 5
    s_lshr_b32 s47, s24, 3
    s_xor_b32 s46, s46, s47
    s_and_b32 s46, s46, 1
    s_lshl_b32 s46, s46, 13
    s_and_b32 s47, s24, 31
    s_lshl_b32 s51, s47, 18
    s_add_u32 s51, s51, s46
    s_bfe_u32 s46, s24, 65536
    s_lshl_b32 s46, s46, 14
    s_add_u32 s51, s51, s46
    s_lshr_b32 s46, s15, 2
    s_lshl_b32 s46, s46, 14
    s_and_b32 s47, s15, 3
    s_mul_i32 s47, s47, 1280
    s_add_u32 s46, s46, s47
    s_add_u32 s33, s33, s46
    s_add_u32 s33, s33, 8388608
    s_add_u32 s51, s51, 12582912
    s_lshr_b32 s46, s15, 3
    s_lshl_b32 s46, s46, 14
    s_and_b32 s47, s15, 7
    s_lshl_b32 s47, s47, 10
    s_add_u32 s46, s46, s47
    s_add_u32 s34, s51, s46
    s_add_u32 s35, s34, 32768
    s_lshl_b32 s46, s15, 9
    s_add_u32 s46, s46, 65536
    s_add_u32 s36, s51, s46
    s_mul_i32 s39, s15, 28672
    s_add_u32 s39, s39, 21233664
    s_mul_i32 s46, s14, 1792
    s_add_u32 s38, s39, s46
    s_mul_i32 s40, s25, 20480
    s_mul_i32 s46, s48, 160
    s_add_u32 s40, s40, s46
    s_lshl_b32 s41, s15, 2
    s_add_u32 s41, s41, s3
    s_cmp_eq_u32 s101, 1
    s_cbranch_scc1 L_ijback
    s_mov_b32 s62, 1
    s_mov_b32 s42, 256
    s_mov_b32 s96, -1
    s_mov_b32 s97, 0
    v_mov_b32 v204, -1
    v_mov_b32 v205, -1
    v_mov_b32 v206, -1
    v_mov_b32 v207, -1
    s_mov_b32 s76, 897988541
    s_mov_b32 s77, 897988541
    v_mov_b32 v216, 210
    v_cmp_gt_u32 s[60:61], v216, v0
    v_add_u32 v4, 0x10000, v2
    v_add_u32 v5, 0x20000, v2
    v_and_b32 v208, 31, v1
    v_lshrrev_b32 v209, 5, v1
    v_and_b32 v210, 15, v1
    v_lshrrev_b32 v211, 4, v1
    v_lshlrev_b32 v212, 10, v209
    v_lshl_add_u32 v6, v208, 3, v212
    v_lshlrev_b32 v212, 8, v209
    v_lshl_add_u32 v212, v210, 4, v212
    v_bfe_u32 v213, v1, 4, 1
    v_mul_u32_u24 v214, 66560, v213
    v_add_u32 v7, v212, v214
    v_mul_u32_u24 v214, 131072, v213
    v_add_u32 v8, v212, v214
    v_lshlrev_b32 v212, 9, v211
    v_lshl_add_u32 v9, v210, 4, v212
    v_lshlrev_b32 v212, 9, v209
    v_lshl_add_u32 v212, v210, 4, v212
    v_lshl_add_u32 v212, v213, 3, v212
    v_add_u32 v10, 4096, v212
    v_mul_u32_u24 v212, 1280, v210
    v_lshl_add_u32 v11, v211, 4, v212
    v_lshl_add_u32 v212, v211, 3, v212
    v_add_u32 v12, 128, v212
    v_lshlrev_b32 v29, 3, v1
    s_mul_i32 s46, s3, 3360
    s_add_u32 s46, s46, 8192
    v_mul_u32_u24 v212, 80, v208
    v_lshl_add_u32 v212, v209, 4, v212
    v_add_u32 v212, s46, v212
    v_subrev_u32 v213, 80, v212
    v_cmp_le_u32 vcc, 20, v208
    s_nop 1
    v_cndmask_b32 v13, v212, v213, vcc
    v_add_u32 v213, 1840, v212
    v_add_u32 v212, 1280, v212
    v_cmp_gt_u32 vcc, 16, v208
    s_nop 1
    v_cndmask_b32 v14, v212, v213, vcc
    s_lshl_b32 s46, s3, 5
    v_add_u32 v215, s46, v208
    v_mov_b32 v216, 105
    v_cmp_gt_u32 s[88:89], v216, v215
    v_mul_u32_u24 v212, 1792, v209
    v_lshl_add_u32 v202, v215, 4, v212
    v_lshl_add_u32 v215, v215, 1, v209
    v_mul_u32_u24 v212, 205, v215
    v_lshrrev_b32 v212, 10, v212
    v_mul_u32_u24 v213, 5, v212
    v_sub_u32 v213, v215, v213
    v_mul_u32_u24 v214, 112, v212
    v_lshl_add_u32 v214, v213, 3, v214
    v_add_u32 v214, 21632, v214
    v_add_u32 v213, 40, v214
    v_cmp_le_u32 vcc, 20, v212
    s_nop 1
    v_cndmask_b32 v213, v214, v213, vcc
    v_cmp_eq_u32 vcc, 40, v212
    s_nop 1
    v_cndmask_b32 v15, v213, v214, vcc
    v_lshrrev_b32 v212, 4, v208
    v_mul_u32_u24 v212, 24, v212
    v_bfe_u32 v213, v208, 2, 1
    v_lshl_add_u32 v212, v213, 3, v212
    v_bfe_u32 v213, v208, 3, 1
    v_lshl_add_u32 v212, v213, 2, v212
    v_and_b32 v214, 3, v208
    v_add_u32 v212, v212, v214
    v_mul_u32_u24 v212, 112, v212
    v_lshl_add_u32 v212, v209, 4, v212
    v_add_u32 v16, 21632, v212
    v_lshl_add_u32 v212, v213, 2, v214
    v_add_u32 v212, 16, v212
    v_mov_b32 v213, 42
    v_and_b32 v215, 0x14, v208
    v_cmp_eq_u32 vcc, 0, v215
    s_nop 1
    v_cndmask_b32 v213, v213, v212, vcc
    v_add_u32 v212, 40, v214
    v_and_b32 v215, 0x1a, v208
    v_cmp_eq_u32 vcc, 16, v215
    s_nop 1
    v_cndmask_b32 v213, v213, v212, vcc
    v_mul_u32_u24 v212, 112, v213
    v_lshl_add_u32 v212, v209, 4, v212
    v_add_u32 v17, 21632, v212
    s_mul_i32 s46, s3, 2304
    s_add_u32 s46, s46, 26752
    s_mul_i32 s47, s3, 576
    s_add_u32 s47, s47, 160768
    v_mul_u32_u24 v212, 72, v208
    v_lshl_add_u32 v212, v209, 3, v212
    v_add_u32 v18, s46, v212
    v_add_u32 v212, s47, v212
    v_subrev_u32 v19, 1152, v212
    v_bfe_u32 v212, v1, 2, 2
    v_mul_u32_u24 v212, 72, v212
    v_bfe_u32 v213, v1, 4, 1
    v_lshl_add_u32 v212, v213, 5, v212
    v_and_b32 v213, 3, v1
    v_lshl_add_u32 v212, v213, 3, v212
    v_add_u32 v21, s47, v212
    v_mul_u32_u24 v213, 576, v209
    v_add_u32 v212, v212, v213
    v_add_u32 v20, s46, v212
    v_mov_b32 v22, 0
    v_mov_b32 v24, 0
    v_mov_b32 v26, 0
    v_mov_b32 v23, 0
    v_bfrev_b32 v25, 1
    s_mov_b32 exec_lo, 0xff00ff
    s_mov_b32 exec_hi, 0xff00ff
    v_mov_b32 v24, s76
    v_mov_b32 v26, s76
    s_mov_b32 exec_lo, 0xff00
    s_mov_b32 exec_hi, 0xff00
    v_mov_b32 v22, 0xff800000
    v_mov_b32 v26, 0xff800000
    s_mov_b64 exec, -1
    s_lshl_b32 s46, s3, 8
    s_add_u32 s46, s46, 159744
    v_lshlrev_b32 v212, 2, v1
    v_add_u32 v27, s46, v212
    v_lshlrev_b32 v212, 4, v209
    v_add_u32 v28, s46, v212
    v_bfrev_b32 v138, 1
    v_mov_b32 v139, 1
    s_cmp_lg_u32 s59, 3
    s_cbranch_scc1 Ls0_9
    s_and_b32 s44, s58, 3
    s_lshl_b32 s44, s44, 3
    s_lshr_b32 s45, s58, 2
    v_mov_b32 v64, s45
    s_mov_b32 s46, 0
    v_mul_u32_u24 v64, 256, v64
    v_add_u32 v64, s46, v64
    v_bfrev_b32 v66, 1
    v_cmp_gt_u32 vcc, 1, v1
    s_nop 1
    v_cndmask_b32 v138, v66, v64, vcc
    v_and_b32 v65, 7, v1
    v_add_u32 v65, s44, v65
    v_lshrrev_b32 v66, 3, v1
    v_lshlrev_b32 v71, 8, v66
    v_lshl_add_u32 v71, v65, 3, v71
    v_lshlrev_b32 v65, 4, v65
    s_lshr_b32 s46, s45, 5
    s_lshr_b32 s47, s45, 4
    s_xor_b32 s51, s46, s47
    v_add_u32 v67, 0, v66
    v_mul_u32_u24 v68, 205, v67
    v_lshrrev_b32 v68, 11, v68
    v_xor_b32 v69, s51, v68
    v_and_b32 v69, 1, v69
    v_mul_u32_u24 v68, 11264, v68
    v_lshl_add_u32 v68, v67, 9, v68
    v_lshl_add_u32 v68, v69, 13, v68
    v_add_u32 v116, v68, v65
    v_add_u32 v67, 8, v66
    v_mul_u32_u24 v68, 205, v67
    v_lshrrev_b32 v68, 11, v68
    v_xor_b32 v69, s51, v68
    v_and_b32 v69, 1, v69
    v_mul_u32_u24 v68, 11264, v68
    v_lshl_add_u32 v68, v67, 9, v68
    v_lshl_add_u32 v68, v69, 13, v68
    v_add_u32 v117, v68, v65
    v_add_u32 v67, 16, v66
    v_mul_u32_u24 v68, 205, v67
    v_lshrrev_b32 v68, 11, v68
    v_xor_b32 v69, s51, v68
    v_and_b32 v69, 1, v69
    v_mul_u32_u24 v68, 11264, v68
    v_lshl_add_u32 v68, v67, 9, v68
    v_lshl_add_u32 v68, v69, 13, v68
    v_add_u32 v118, v68, v65
    v_add_u32 v67, 24, v66
    v_mul_u32_u24 v68, 205, v67
    v_lshrrev_b32 v68, 11, v68
    v_xor_b32 v69, s51, v68
    v_and_b32 v69, 1, v69
    v_mul_u32_u24 v68, 11264, v68
    v_lshl_add_u32 v68, v67, 9, v68
    v_lshl_add_u32 v68, v69, 13, v68
    v_add_u32 v119, v68, v65
    v_add_u32 v67, 32, v66
    v_mul_u32_u24 v68, 205, v67
    v_lshrrev_b32 v68, 11, v68
    v_xor_b32 v69, s51, v68
    v_and_b32 v69, 1, v69
    v_mul_u32_u24 v68, 11264, v68
    v_lshl_add_u32 v68, v67, 9, v68
    v_lshl_add_u32 v68, v69, 13, v68
    v_add_u32 v120, v68, v65
    v_add_u32 v67, 40, v66
    v_mul_u32_u24 v68, 205, v67
    v_lshrrev_b32 v68, 11, v68
    v_xor_b32 v69, s51, v68
    v_and_b32 v69, 1, v69
    v_mul_u32_u24 v68, 11264, v68
    v_lshl_add_u32 v68, v67, 9, v68
    v_lshl_add_u32 v68, v69, 13, v68
    v_add_u32 v121, v68, v65
    v_add_u32 v67, 48, v66
    v_mul_u32_u24 v68, 205, v67
    v_lshrrev_b32 v68, 11, v68
    v_xor_b32 v69, s51, v68
    v_and_b32 v69, 1, v69
    v_mul_u32_u24 v68, 11264, v68
    v_lshl_add_u32 v68, v67, 9, v68
    v_lshl_add_u32 v68, v69, 13, v68
    v_add_u32 v122, v68, v65
    v_add_u32 v67, 56, v66
    v_mul_u32_u24 v68, 205, v67
    v_lshrrev_b32 v68, 11, v68
    v_xor_b32 v69, s51, v68
    v_and_b32 v69, 1, v69
    v_mul_u32_u24 v68, 11264, v68
    v_lshl_add_u32 v68, v67, 9, v68
    v_lshl_add_u32 v68, v69, 13, v68
    v_add_u32 v123, v68, v65
    v_add_u32 v67, 64, v66
    v_mul_u32_u24 v68, 205, v67
    v_lshrrev_b32 v68, 11, v68
    v_xor_b32 v69, s51, v68
    v_and_b32 v69, 1, v69
    v_mul_u32_u24 v68, 11264, v68
    v_lshl_add_u32 v68, v67, 9, v68
    v_lshl_add_u32 v68, v69, 13, v68
    v_add_u32 v124, v68, v65
    v_add_u32 v67, 72, v66
    v_mul_u32_u24 v68, 205, v67
    v_lshrrev_b32 v68, 11, v68
    v_xor_b32 v69, s51, v68
    v_and_b32 v69, 1, v69
    v_mul_u32_u24 v68, 11264, v68
    v_lshl_add_u32 v68, v67, 9, v68
    v_lshl_add_u32 v68, v69, 13, v68
    v_add_u32 v125, v68, v65
    s_and_b32 s50, s45, 3
    s_and_b32 s49, s45, 31
    s_lshl_b32 s46, s49, 7
    s_add_u32 s46, s46, s50
    s_lshl_b32 s46, s46, 10
    s_add_u32 s46, s46, 12582912
    s_lshr_b32 s47, s49, 2
    s_lshl_b32 s47, s47, 3
    s_lshr_b32 s49, s45, 5
    s_lshl_b32 s49, s49, 2
    s_add_u32 s47, s47, s49
    s_add_u32 s47, s47, s50
    s_lshl_b32 s47, s47, 11
    s_add_u32 s47, s47, 33554432
    s_mov_b32 s48, 0x3f803f80
    v_mov_b32 v72, 0
    v_mov_b32 v73, 0
    s_waitcnt vmcnt(0)
    buffer_store_dwordx4 v[76:79], v116, s[4:7], s46 offen sc1
    buffer_store_dwordx4 v[80:83], v117, s[4:7], s46 offen sc1
    buffer_store_dwordx4 v[84:87], v118, s[4:7], s46 offen sc1
    buffer_store_dwordx4 v[88:91], v119, s[4:7], s46 offen sc1
    buffer_store_dwordx4 v[92:95], v120, s[4:7], s46 offen sc1
    buffer_store_dwordx4 v[96:99], v121, s[4:7], s46 offen sc1
    buffer_store_dwordx4 v[100:103], v122, s[4:7], s46 offen sc1
    buffer_store_dwordx4 v[104:107], v123, s[4:7], s46 offen sc1
    buffer_store_dwordx4 v[108:111], v124, s[4:7], s46 offen sc1
    buffer_store_dwordx4 v[112:115], v125, s[4:7], s46 offen sc1
    s_barrier
    v_dot2_f32_bf16 v72, v76, s48, v72
    v_dot2_f32_bf16 v73, v77, s48, v73
    v_dot2_f32_bf16 v72, v78, s48, v72
    v_dot2_f32_bf16 v73, v79, s48, v73
    v_dot2_f32_bf16 v72, v80, s48, v72
    v_dot2_f32_bf16 v73, v81, s48, v73
    v_dot2_f32_bf16 v72, v82, s48, v72
    v_dot2_f32_bf16 v73, v83, s48, v73
    v_dot2_f32_bf16 v72, v84, s48, v72
    v_dot2_f32_bf16 v73, v85, s48, v73
    v_dot2_f32_bf16 v72, v86, s48, v72
    v_dot2_f32_bf16 v73, v87, s48, v73
    v_dot2_f32_bf16 v72, v88, s48, v72
    v_dot2_f32_bf16 v73, v89, s48, v73
    v_dot2_f32_bf16 v72, v90, s48, v72
    v_dot2_f32_bf16 v73, v91, s48, v73
    v_dot2_f32_bf16 v72, v92, s48, v72
    v_dot2_f32_bf16 v73, v93, s48, v73
    v_dot2_f32_bf16 v72, v94, s48, v72
    v_dot2_f32_bf16 v73, v95, s48, v73
    v_dot2_f32_bf16 v72, v96, s48, v72
    v_dot2_f32_bf16 v73, v97, s48, v73
    v_dot2_f32_bf16 v72, v98, s48, v72
    v_dot2_f32_bf16 v73, v99, s48, v73
    v_dot2_f32_bf16 v72, v100, s48, v72
    v_dot2_f32_bf16 v73, v101, s48, v73
    v_dot2_f32_bf16 v72, v102, s48, v72
    v_dot2_f32_bf16 v73, v103, s48, v73
    v_dot2_f32_bf16 v72, v104, s48, v72
    v_dot2_f32_bf16 v73, v105, s48, v73
    v_dot2_f32_bf16 v72, v106, s48, v72
    v_dot2_f32_bf16 v73, v107, s48, v73
    v_dot2_f32_bf16 v72, v108, s48, v72
    v_dot2_f32_bf16 v73, v109, s48, v73
    v_dot2_f32_bf16 v72, v110, s48, v72
    v_dot2_f32_bf16 v73, v111, s48, v73
    v_dot2_f32_bf16 v72, v112, s48, v72
    v_dot2_f32_bf16 v73, v113, s48, v73
    v_dot2_f32_bf16 v72, v114, s48, v72
    v_dot2_f32_bf16 v73, v115, s48, v73
    s_nop 2
    v_add_f32 v72, v72, v73
    v_mul_f32 v72, 1011666125, v72
    v_mov_b32 v74, 0
    v_mov_b32 v75, 0
    v_lshlrev_b32 v116, 16, v76
    v_and_b32 v117, 0xffff0000, v76
    v_pk_add_f32 v[116:117], v[116:117], v[72:73] op_sel_hi:[1,0] neg_lo:[0,1] neg_hi:[0,1]
    v_pk_fma_f32 v[74:75], v[116:117], v[116:117], v[74:75]
    v_lshlrev_b32 v118, 16, v77
    v_and_b32 v119, 0xffff0000, v77
    v_pk_add_f32 v[118:119], v[118:119], v[72:73] op_sel_hi:[1,0] neg_lo:[0,1] neg_hi:[0,1]
    v_pk_fma_f32 v[74:75], v[118:119], v[118:119], v[74:75]
    v_lshlrev_b32 v120, 16, v78
    v_and_b32 v121, 0xffff0000, v78
    v_pk_add_f32 v[120:121], v[120:121], v[72:73] op_sel_hi:[1,0] neg_lo:[0,1] neg_hi:[0,1]
    v_pk_fma_f32 v[74:75], v[120:121], v[120:121], v[74:75]
    v_lshlrev_b32 v122, 16, v79
    v_and_b32 v123, 0xffff0000, v79
    v_pk_add_f32 v[122:123], v[122:123], v[72:73] op_sel_hi:[1,0] neg_lo:[0,1] neg_hi:[0,1]
    v_pk_fma_f32 v[74:75], v[122:123], v[122:123], v[74:75]
    v_lshlrev_b32 v116, 16, v80
    v_and_b32 v117, 0xffff0000, v80
    v_pk_add_f32 v[116:117], v[116:117], v[72:73] op_sel_hi:[1,0] neg_lo:[0,1] neg_hi:[0,1]
    v_pk_fma_f32 v[74:75], v[116:117], v[116:117], v[74:75]
    v_lshlrev_b32 v118, 16, v81
    v_and_b32 v119, 0xffff0000, v81
    v_pk_add_f32 v[118:119], v[118:119], v[72:73] op_sel_hi:[1,0] neg_lo:[0,1] neg_hi:[0,1]
    v_pk_fma_f32 v[74:75], v[118:119], v[118:119], v[74:75]
    v_lshlrev_b32 v120, 16, v82
    v_and_b32 v121, 0xffff0000, v82
    v_pk_add_f32 v[120:121], v[120:121], v[72:73] op_sel_hi:[1,0] neg_lo:[0,1] neg_hi:[0,1]
    v_pk_fma_f32 v[74:75], v[120:121], v[120:121], v[74:75]
    v_lshlrev_b32 v122, 16, v83
    v_and_b32 v123, 0xffff0000, v83
    v_pk_add_f32 v[122:123], v[122:123], v[72:73] op_sel_hi:[1,0] neg_lo:[0,1] neg_hi:[0,1]
    v_pk_fma_f32 v[74:75], v[122:123], v[122:123], v[74:75]
    v_lshlrev_b32 v116, 16, v84
    v_and_b32 v117, 0xffff0000, v84
    v_pk_add_f32 v[116:117], v[116:117], v[72:73] op_sel_hi:[1,0] neg_lo:[0,1] neg_hi:[0,1]
    v_pk_fma_f32 v[74:75], v[116:117], v[116:117], v[74:75]
    v_lshlrev_b32 v118, 16, v85
    v_and_b32 v119, 0xffff0000, v85
    v_pk_add_f32 v[118:119], v[118:119], v[72:73] op_sel_hi:[1,0] neg_lo:[0,1] neg_hi:[0,1]
    v_pk_fma_f32 v[74:75], v[118:119], v[118:119], v[74:75]
    v_lshlrev_b32 v120, 16, v86
    v_and_b32 v121, 0xffff0000, v86
    v_pk_add_f32 v[120:121], v[120:121], v[72:73] op_sel_hi:[1,0] neg_lo:[0,1] neg_hi:[0,1]
    v_pk_fma_f32 v[74:75], v[120:121], v[120:121], v[74:75]
    v_lshlrev_b32 v122, 16, v87
    v_and_b32 v123, 0xffff0000, v87
    v_pk_add_f32 v[122:123], v[122:123], v[72:73] op_sel_hi:[1,0] neg_lo:[0,1] neg_hi:[0,1]
    v_pk_fma_f32 v[74:75], v[122:123], v[122:123], v[74:75]
    v_lshlrev_b32 v116, 16, v88
    v_and_b32 v117, 0xffff0000, v88
    v_pk_add_f32 v[116:117], v[116:117], v[72:73] op_sel_hi:[1,0] neg_lo:[0,1] neg_hi:[0,1]
    v_pk_fma_f32 v[74:75], v[116:117], v[116:117], v[74:75]
    v_lshlrev_b32 v118, 16, v89
    v_and_b32 v119, 0xffff0000, v89
    v_pk_add_f32 v[118:119], v[118:119], v[72:73] op_sel_hi:[1,0] neg_lo:[0,1] neg_hi:[0,1]
    v_pk_fma_f32 v[74:75], v[118:119], v[118:119], v[74:75]
    v_lshlrev_b32 v120, 16, v90
    v_and_b32 v121, 0xffff0000, v90
    v_pk_add_f32 v[120:121], v[120:121], v[72:73] op_sel_hi:[1,0] neg_lo:[0,1] neg_hi:[0,1]
    v_pk_fma_f32 v[74:75], v[120:121], v[120:121], v[74:75]
    v_lshlrev_b32 v122, 16, v91
    v_and_b32 v123, 0xffff0000, v91
    v_pk_add_f32 v[122:123], v[122:123], v[72:73] op_sel_hi:[1,0] neg_lo:[0,1] neg_hi:[0,1]
    v_pk_fma_f32 v[74:75], v[122:123], v[122:123], v[74:75]
    v_lshlrev_b32 v116, 16, v92
    v_and_b32 v117, 0xffff0000, v92
    v_pk_add_f32 v[116:117], v[116:117], v[72:73] op_sel_hi:[1,0] neg_lo:[0,1] neg_hi:[0,1]
    v_pk_fma_f32 v[74:75], v[116:117], v[116:117], v[74:75]
    v_lshlrev_b32 v118, 16, v93
    v_and_b32 v119, 0xffff0000, v93
    v_pk_add_f32 v[118:119], v[118:119], v[72:73] op_sel_hi:[1,0] neg_lo:[0,1] neg_hi:[0,1]
    v_pk_fma_f32 v[74:75], v[118:119], v[118:119], v[74:75]
    v_lshlrev_b32 v120, 16, v94
    v_and_b32 v121, 0xffff0000, v94
    v_pk_add_f32 v[120:121], v[120:121], v[72:73] op_sel_hi:[1,0] neg_lo:[0,1] neg_hi:[0,1]
    v_pk_fma_f32 v[74:75], v[120:121], v[120:121], v[74:75]
    v_lshlrev_b32 v122, 16, v95
    v_and_b32 v123, 0xffff0000, v95
    v_pk_add_f32 v[122:123], v[122:123], v[72:73] op_sel_hi:[1,0] neg_lo:[0,1] neg_hi:[0,1]
    v_pk_fma_f32 v[74:75], v[122:123], v[122:123], v[74:75]
    v_lshlrev_b32 v116, 16, v96
    v_and_b32 v117, 0xffff0000, v96
    v_pk_add_f32 v[116:117], v[116:117], v[72:73] op_sel_hi:[1,0] neg_lo:[0,1] neg_hi:[0,1]
    v_pk_fma_f32 v[74:75], v[116:117], v[116:117], v[74:75]
    v_lshlrev_b32 v118, 16, v97
    v_and_b32 v119, 0xffff0000, v97
    v_pk_add_f32 v[118:119], v[118:119], v[72:73] op_sel_hi:[1,0] neg_lo:[0,1] neg_hi:[0,1]
    v_pk_fma_f32 v[74:75], v[118:119], v[118:119], v[74:75]
    v_lshlrev_b32 v120, 16, v98
    v_and_b32 v121, 0xffff0000, v98
    v_pk_add_f32 v[120:121], v[120:121], v[72:73] op_sel_hi:[1,0] neg_lo:[0,1] neg_hi:[0,1]
    v_pk_fma_f32 v[74:75], v[120:121], v[120:121], v[74:75]
    v_lshlrev_b32 v122, 16, v99
    v_and_b32 v123, 0xffff0000, v99
    v_pk_add_f32 v[122:123], v[122:123], v[72:73] op_sel_hi:[1,0] neg_lo:[0,1] neg_hi:[0,1]
    v_pk_fma_f32 v[74:75], v[122:123], v[122:123], v[74:75]
    v_lshlrev_b32 v116, 16, v100
    v_and_b32 v117, 0xffff0000, v100
    v_pk_add_f32 v[116:117], v[116:117], v[72:73] op_sel_hi:[1,0] neg_lo:[0,1] neg_hi:[0,1]
    v_pk_fma_f32 v[74:75], v[116:117], v[116:117], v[74:75]
    v_lshlrev_b32 v118, 16, v101
    v_and_b32 v119, 0xffff0000, v101
    v_pk_add_f32 v[118:119], v[118:119], v[72:73] op_sel_hi:[1,0] neg_lo:[0,1] neg_hi:[0,1]
    v_pk_fma_f32 v[74:75], v[118:119], v[118:119], v[74:75]
    v_lshlrev_b32 v120, 16, v102
    v_and_b32 v121, 0xffff0000, v102
    v_pk_add_f32 v[120:121], v[120:121], v[72:73] op_sel_hi:[1,0] neg_lo:[0,1] neg_hi:[0,1]
    v_pk_fma_f32 v[74:75], v[120:121], v[120:121], v[74:75]
    v_lshlrev_b32 v122, 16, v103
    v_and_b32 v123, 0xffff0000, v103
    v_pk_add_f32 v[122:123], v[122:123], v[72:73] op_sel_hi:[1,0] neg_lo:[0,1] neg_hi:[0,1]
    v_pk_fma_f32 v[74:75], v[122:123], v[122:123], v[74:75]
    v_lshlrev_b32 v116, 16, v104
    v_and_b32 v117, 0xffff0000, v104
    v_pk_add_f32 v[116:117], v[116:117], v[72:73] op_sel_hi:[1,0] neg_lo:[0,1] neg_hi:[0,1]
    v_pk_fma_f32 v[74:75], v[116:117], v[116:117], v[74:75]
    v_lshlrev_b32 v118, 16, v105
    v_and_b32 v119, 0xffff0000, v105
    v_pk_add_f32 v[118:119], v[118:119], v[72:73] op_sel_hi:[1,0] neg_lo:[0,1] neg_hi:[0,1]
    v_pk_fma_f32 v[74:75], v[118:119], v[118:119], v[74:75]
    v_lshlrev_b32 v120, 16, v106
    v_and_b32 v121, 0xffff0000, v106
    v_pk_add_f32 v[120:121], v[120:121], v[72:73] op_sel_hi:[1,0] neg_lo:[0,1] neg_hi:[0,1]
    v_pk_fma_f32 v[74:75], v[120:121], v[120:121], v[74:75]
    v_lshlrev_b32 v122, 16, v107
    v_and_b32 v123, 0xffff0000, v107
    v_pk_add_f32 v[122:123], v[122:123], v[72:73] op_sel_hi:[1,0] neg_lo:[0,1] neg_hi:[0,1]
    v_pk_fma_f32 v[74:75], v[122:123], v[122:123], v[74:75]
    v_lshlrev_b32 v116, 16, v108
    v_and_b32 v117, 0xffff0000, v108
    v_pk_add_f32 v[116:117], v[116:117], v[72:73] op_sel_hi:[1,0] neg_lo:[0,1] neg_hi:[0,1]
    v_pk_fma_f32 v[74:75], v[116:117], v[116:117], v[74:75]
    v_lshlrev_b32 v118, 16, v109
    v_and_b32 v119, 0xffff0000, v109
    v_pk_add_f32 v[118:119], v[118:119], v[72:73] op_sel_hi:[1,0] neg_lo:[0,1] neg_hi:[0,1]
    v_pk_fma_f32 v[74:75], v[118:119], v[118:119], v[74:75]
    v_lshlrev_b32 v120, 16, v110
    v_and_b32 v121, 0xffff0000, v110
    v_pk_add_f32 v[120:121], v[120:121], v[72:73] op_sel_hi:[1,0] neg_lo:[0,1] neg_hi:[0,1]
    v_pk_fma_f32 v[74:75], v[120:121], v[120:121], v[74:75]
    v_lshlrev_b32 v122, 16, v111
    v_and_b32 v123, 0xffff0000, v111
    v_pk_add_f32 v[122:123], v[122:123], v[72:73] op_sel_hi:[1,0] neg_lo:[0,1] neg_hi:[0,1]
    v_pk_fma_f32 v[74:75], v[122:123], v[122:123], v[74:75]
    v_lshlrev_b32 v116, 16, v112
    v_and_b32 v117, 0xffff0000, v112
    v_pk_add_f32 v[116:117], v[116:117], v[72:73] op_sel_hi:[1,0] neg_lo:[0,1] neg_hi:[0,1]
    v_pk_fma_f32 v[74:75], v[116:117], v[116:117], v[74:75]
    v_lshlrev_b32 v118, 16, v113
    v_and_b32 v119, 0xffff0000, v113
    v_pk_add_f32 v[118:119], v[118:119], v[72:73] op_sel_hi:[1,0] neg_lo:[0,1] neg_hi:[0,1]
    v_pk_fma_f32 v[74:75], v[118:119], v[118:119], v[74:75]
    v_lshlrev_b32 v120, 16, v114
    v_and_b32 v121, 0xffff0000, v114
    v_pk_add_f32 v[120:121], v[120:121], v[72:73] op_sel_hi:[1,0] neg_lo:[0,1] neg_hi:[0,1]
    v_pk_fma_f32 v[74:75], v[120:121], v[120:121], v[74:75]
    v_lshlrev_b32 v122, 16, v115
    v_and_b32 v123, 0xffff0000, v115
    v_pk_add_f32 v[122:123], v[122:123], v[72:73] op_sel_hi:[1,0] neg_lo:[0,1] neg_hi:[0,1]
    v_pk_fma_f32 v[74:75], v[122:123], v[122:123], v[74:75]
    s_load_dword s56, s[68:69], 0
    s_waitcnt vmcnt(0) lgkmcnt(0)
    s_and_b32 s55, s56, 0xff
    s_cmp_ge_u32 s55, 2
    s_cbranch_scc1 Lbk_13
    s_mov_b32 s55, 0
    v_mov_b32 v68, 0
Lbw_14:
    s_sleep 4
    global_load_dword v69, v68, s[68:69] offset:0 sc1
    s_waitcnt vmcnt(0)
    v_readfirstlane_b32 s56, v69
    s_nop 1
    s_and_b32 s54, s56, 0xff
    s_cmp_ge_u32 s54, 2
    s_cbranch_scc1 Lbo_15
    s_add_u32 s55, s55, 1
    s_cmp_lt_u32 s55, 400000
    s_cbranch_scc1 Lbw_14
Lbo_15:
Lbk_13:
    s_mul_i32 s49, s45, 256
    s_mov_b32 s50, 1
    s_atomic_add s50, s[12:13], s49
    s_lshr_b32 s56, s56, 8
    v_mov_b32 v68, 163776
    v_mov_b32 v69, s56
    ds_write_b32 v68, v69
    v_add_f32 v73, v74, v75
    buffer_store_dwordx2 v[72:73], v71, s[4:7], s47 offen sc1
    v_mov_b32 v139, 256
    s_load_dword s56, s[68:69], 128
    s_waitcnt lgkmcnt(0)
    s_and_b32 s55, s56, 0xff
    s_cmp_ge_u32 s55, 18
    s_cbranch_scc1 Lbk_16
    s_mov_b32 s55, 0
    v_mov_b32 v68, 0
Lbw_17:
    s_sleep 4
    global_load_dword v69, v68, s[68:69] offset:128 sc1
    s_waitcnt vmcnt(0)
    v_readfirstlane_b32 s56, v69
    s_nop 1
    s_and_b32 s54, s56, 0xff
    s_cmp_ge_u32 s54, 18
    s_cbranch_scc1 Lbo_18
    s_add_u32 s55, s55, 1
    s_cmp_lt_u32 s55, 400000
    s_cbranch_scc1 Lbw_17
Lbo_18:
Lbk_16:
    s_branch Ls0_7
.p2align 12
L_page:
Ls0_9:
    s_cmp_lg_u32 s59, 0
    s_cbranch_scc1 Ls0_8
    s_mul_i32 s44, s58, 137
    s_lshr_b32 s44, s44, 12
    s_mul_i32 s46, s44, 30
    s_sub_u32 s45, s58, s46
    s_mul_i32 s51, s45, 26
    s_lshr_b32 s51, s51, 8
    s_lshl_b32 s57, s45, 3
    s_mul_i32 s47, s51, 80
    s_sub_u32 s57, s57, s47
    s_mul_i32 s47, s57, 205
    s_lshr_b32 s47, s47, 10
    s_add_u32 s48, s57, 8
    v_lshrrev_b32 v66, 2, v1
    v_add_u32 v66, s47, v66
    v_and_b32 v67, 3, v1
    v_lshl_add_u32 v64, v66, 2, v67
    v_mul_u32_u24 v66, 5, v66
    v_add_u32 v67, 5, v66
    v_min_i32 v67, s48, v67
    v_max_i32 v66, s57, v66
    v_sub_u32 v65, v67, v66
    s_mov_b32 s46, 262144
    v_mul_u32_u24 v64, 256, v64
    v_add_u32 v64, s46, v64
    v_bfrev_b32 v66, 1
    v_cmp_gt_u32 vcc, 12, v1
    s_nop 1
    v_cndmask_b32 v138, v66, v64, vcc
    v_cmp_lt_i32 vcc, 0, v65
    s_nop 1
    v_cndmask_b32 v138, v66, v138, vcc
    v_mov_b32 v139, v65
    v_bfe_u32 v66, v1, 3, 2
    v_add_u32 v66, s57, v66
    v_add_u32 v66, 0, v66
    v_mul_u32_u24 v71, 205, v66
    v_lshrrev_b32 v71, 10, v71
    v_mul_u32_u24 v67, 5, v71
    v_sub_u32 v66, v66, v67
    s_mov_b32 s48, 3
    s_mov_b32 s49, 16
    s_cmp_eq_u32 s51, 1
    s_cselect_b32 s48, 0, s48
    s_cselect_b32 s49, 0, s49
    s_cmp_eq_u32 s51, 2
    s_cselect_b32 s48, 2, s48
    s_cselect_b32 s49, 8, s49
    v_mov_b32 v70, s48
    v_lshlrev_b32 v72, 3, v66
    v_mov_b32 v67, s49
    v_cmp_eq_u32 vcc, 4, v66
    s_nop 1
    v_cndmask_b32 v70, v70, 1, vcc
    v_cndmask_b32 v72, v72, v67, vcc
    v_and_b32 v67, 7, v1
    v_add_u32 v72, v72, v67
    v_and_b32 v69, 0, v71
    v_sub_u32 v69, s44, v69
    v_and_b32 v69, 3, v69
    v_mul_u32_u24 v73, 30, v69
    v_add_u32 v73, v73, v70
    v_mov_b32 v74, 3072
    v_add_u32 v75, 100, v70
    v_mul_u32_u24 v66, 20, v69
    v_add3_u32 v66, v66, v70, 20
    v_mov_b32 v67, 2048
    v_mul_u32_u24 v65, 10, v69
    v_add_u32 v68, 82, v65
    v_cmp_eq_u32 vcc, 2, v70
    s_nop 1
    v_cndmask_b32 v66, v66, v68, vcc
    v_mov_b32 v68, 1024
    v_cndmask_b32 v67, v67, v68, vcc
    v_mov_b32 v68, 122
    v_cndmask_b32 v75, v75, v68, vcc
    v_cmp_lt_u32 vcc, 1, v69
    s_nop 1
    v_cndmask_b32 v73, v73, v66, vcc
    v_cndmask_b32 v74, v74, v67, vcc
    v_mul_u32_u24 v68, 41, v70
    v_add_u32 v66, v65, v68
    v_add_u32 v68, 40, v68
    v_mov_b32 v67, 1024
    v_cmp_lt_u32 vcc, 2, v70
    s_nop 1
    v_cndmask_b32 v73, v73, v66, vcc
    v_cndmask_b32 v74, v74, v67, vcc
    v_cndmask_b32 v75, v75, v68, vcc
    v_mul_u32_u24 v66, 167936, v71
    v_lshl_add_u32 v66, v72, 4, v66
    v_add_u32 v66, 524288, v66
    v_lshl_add_u32 v73, v73, 10, v66
    v_lshl_add_u32 v75, v75, 10, v66
    v_lshrrev_b32 v67, 5, v1
    v_lshl_add_u32 v73, v67, 9, v73
    s_lshr_b32 s46, s44, 1
    s_lshl_b32 s46, s46, 9
    s_and_b32 s47, s44, 1
    s_lshl_b32 s47, s47, 3
    s_add_u32 s46, s46, s47
    v_add_u32 v75, s46, v75
    v_bfe_u32 v66, v1, 3, 2
    v_add_u32 v66, s57, v66
    v_add_u32 v66, 4, v66
    v_mul_u32_u24 v71, 205, v66
    v_lshrrev_b32 v71, 10, v71
    v_mul_u32_u24 v67, 5, v71
    v_sub_u32 v66, v66, v67
    s_mov_b32 s48, 3
    s_mov_b32 s49, 16
    s_cmp_eq_u32 s51, 1
    s_cselect_b32 s48, 0, s48
    s_cselect_b32 s49, 0, s49
    s_cmp_eq_u32 s51, 2
    s_cselect_b32 s48, 2, s48
    s_cselect_b32 s49, 8, s49
    v_mov_b32 v70, s48
    v_lshlrev_b32 v72, 3, v66
    v_mov_b32 v67, s49
    v_cmp_eq_u32 vcc, 4, v66
    s_nop 1
    v_cndmask_b32 v70, v70, 1, vcc
    v_cndmask_b32 v72, v72, v67, vcc
    v_and_b32 v67, 7, v1
    v_add_u32 v72, v72, v67
    v_and_b32 v69, 0, v71
    v_sub_u32 v69, s44, v69
    v_and_b32 v69, 3, v69
    v_mul_u32_u24 v121, 30, v69
    v_add_u32 v121, v121, v70
    v_mov_b32 v122, 3072
    v_add_u32 v123, 100, v70
    v_mul_u32_u24 v66, 20, v69
    v_add3_u32 v66, v66, v70, 20
    v_mov_b32 v67, 2048
    v_mul_u32_u24 v65, 10, v69
    v_add_u32 v68, 82, v65
    v_cmp_eq_u32 vcc, 2, v70
    s_nop 1
    v_cndmask_b32 v66, v66, v68, vcc
    v_mov_b32 v68, 1024
    v_cndmask_b32 v67, v67, v68, vcc
    v_mov_b32 v68, 122
    v_cndmask_b32 v123, v123, v68, vcc
    v_cmp_lt_u32 vcc, 1, v69
    s_nop 1
    v_cndmask_b32 v121, v121, v66, vcc
    v_cndmask_b32 v122, v122, v67, vcc
    v_mul_u32_u24 v68, 41, v70
    v_add_u32 v66, v65, v68
    v_add_u32 v68, 40, v68
    v_mov_b32 v67, 1024
    v_cmp_lt_u32 vcc, 2, v70
    s_nop 1
    v_cndmask_b32 v121, v121, v66, vcc
    v_cndmask_b32 v122, v122, v67, vcc
    v_cndmask_b32 v123, v123, v68, vcc
    v_mul_u32_u24 v66, 167936, v71
    v_lshl_add_u32 v66, v72, 4, v66
    v_add_u32 v66, 524288, v66
    v_lshl_add_u32 v121, v121, 10, v66
    v_lshl_add_u32 v123, v123, 10, v66
    v_lshrrev_b32 v67, 5, v1
    v_lshl_add_u32 v121, v67, 9, v121
    s_lshr_b32 s46, s44, 1
    s_lshl_b32 s46, s46, 9
    s_and_b32 s47, s44, 1
    s_lshl_b32 s47, s47, 3
    s_add_u32 s46, s46, s47
    v_add_u32 v123, s46, v123
    s_mul_i32 s46, s3, 20480
    s_add_u32 s46, s46, 98304
    v_lshrrev_b32 v67, 5, v1
    v_lshlrev_b32 v67, 3, v67
    v_bfe_u32 v68, v1, 2, 2
    v_add_u32 v67, v67, v68
    v_lshlrev_b32 v67, 7, v67
    v_add_u32 v67, s46, v67
    v_bfe_u32 v66, v1, 4, 1
    v_lshl_add_u32 v67, v66, 5, v67
    v_and_b32 v66, 3, v1
    v_lshl_add_u32 v64, v66, 3, v67
    s_branch Ls0_11
Ls0_8:
    s_cmp_ge_u32 s2, 32
    s_cbranch_scc1 Ls0v_19
    s_cmp_lg_u32 s3, 1
    s_cbranch_scc1 Ls0v_19
    s_lshl_b32 s46, s2, 8
    s_add_u32 s46, s46, 393216
    s_add_u32 s47, s46, 8192
    s_mov_b32 s48, -1
    s_mov_b32 s49, -1
    s_mov_b32 s54, 0
    s_memtime s[50:51]
    s_waitcnt lgkmcnt(0)
    s_atomic_add s54, s[12:13], s47 glc
    s_waitcnt lgkmcnt(0)
    s_memtime s[52:53]
    s_waitcnt lgkmcnt(0)
    s_sub_u32 s52, s52, s50
    s_min_u32 s49, s49, s52
    s_mov_b32 s54, 0
    s_memtime s[50:51]
    s_waitcnt lgkmcnt(0)
    s_atomic_add s54, s[12:13], s46 glc
    s_waitcnt lgkmcnt(0)
    s_memtime s[52:53]
    s_waitcnt lgkmcnt(0)
    s_sub_u32 s52, s52, s50
    s_min_u32 s48, s48, s52
Ls0v_19:
    s_cmp_eq_u32 s3, 0
    s_cbranch_scc1 Ls0_20
    s_barrier
Ls0_20:
    s_cmp_ge_u32 s2, 32
    s_cbranch_scc1 Ls0v_21
    s_cmp_lg_u32 s3, 1
    s_cbranch_scc1 Ls0v_21
    s_mov_b32 s54, 0
    s_memtime s[50:51]
    s_waitcnt lgkmcnt(0)
    s_atomic_add s54, s[12:13], s46 glc
    s_waitcnt lgkmcnt(0)
    s_memtime s[52:53]
    s_waitcnt lgkmcnt(0)
    s_sub_u32 s52, s52, s50
    s_min_u32 s48, s48, s52
    s_mov_b32 s54, 0
    s_memtime s[50:51]
    s_waitcnt lgkmcnt(0)
    s_atomic_add s54, s[12:13], s47 glc
    s_waitcnt lgkmcnt(0)
    s_memtime s[52:53]
    s_waitcnt lgkmcnt(0)
    s_sub_u32 s52, s52, s50
    s_min_u32 s49, s49, s52
    s_mov_b32 s54, 0
    s_memtime s[50:51]
    s_waitcnt lgkmcnt(0)
    s_atomic_add s54, s[12:13], s47 glc
    s_waitcnt lgkmcnt(0)
    s_memtime s[52:53]
    s_waitcnt lgkmcnt(0)
    s_sub_u32 s52, s52, s50
    s_min_u32 s49, s49, s52
    s_mov_b32 s54, 0
    s_memtime s[50:51]
    s_waitcnt lgkmcnt(0)
    s_atomic_add s54, s[12:13], s46 glc
    s_waitcnt lgkmcnt(0)
    s_memtime s[52:53]
    s_waitcnt lgkmcnt(0)
    s_sub_u32 s52, s52, s50
    s_min_u32 s48, s48, s52
    s_cmp_lt_u32 s49, s48
    s_cselect_b32 s46, 1, 0
    s_getreg_b32 s47, hwreg(HW_REG_XCC_ID)
    s_bfe_u32 s47, s47, 0x10002
    s_xor_b32 s46, s46, s47
    s_lshl_b32 s46, s46, 8
    s_add_u32 s46, s46, 1
    s_load_dword s56, s[68:69], 0
    s_waitcnt lgkmcnt(0)
    s_and_b32 s55, s56, 0xff
    s_cmp_ge_u32 s55, 2
    s_cbranch_scc1 Lbk_22
    s_mov_b32 s55, 0
    v_mov_b32 v68, 0
Lbw_23:
    s_sleep 4
    global_load_dword v69, v68, s[68:69] offset:0 sc1
    s_waitcnt vmcnt(0)
    v_readfirstlane_b32 s56, v69
    s_nop 1
    s_and_b32 s54, s56, 0xff
    s_cmp_ge_u32 s54, 2
    s_cbranch_scc1 Lbo_24
    s_add_u32 s55, s55, 1
    s_cmp_lt_u32 s55, 400000
    s_cbranch_scc1 Lbw_23
Lbo_24:
Lbk_22:
    s_atomic_add s46, s[12:13], 128
Ls0v_21:
    s_cmp_lg_u32 s59, 2
    s_cbranch_scc1 Ls0_10
    s_sub_u32 s45, s58, 352
    s_sub_u32 s46, s58, 120
    s_cmp_lt_u32 s58, 160
    s_cselect_b32 s45, s46, s45
    s_cselect_b32 s51, 1, 0
    s_and_b32 s44, s45, 1
    s_lshr_b32 s45, s45, 1
    s_cmp_eq_u32 s51, 1
    s_cselect_b32 s46, 16, 48
    s_mov_b32 s50, 1966080
    s_cselect_b32 s50, 819200, s50
    s_load_dwordx2 s[52:53], s[0:1], s46
    s_waitcnt lgkmcnt(0)
    s_mov_b32 s64, s52
    s_and_b32 s65, s53, 0xffff
    s_mov_b32 s66, s50
    s_mov_b32 s67, 0x20000
    v_add_u32 v65, 0, v1
    v_mul_u32_u24 v66, 205, v65
    v_lshrrev_b32 v66, 13, v66
    v_mul_u32_u24 v66, 640, v66
    v_lshl_add_u32 v68, v65, 4, v66
    v_add_u32 v65, 64, v1
    v_mul_u32_u24 v66, 205, v65
    v_lshrrev_b32 v66, 13, v66
    v_mul_u32_u24 v66, 640, v66
    v_lshl_add_u32 v69, v65, 4, v66
    v_add_u32 v65, 128, v1
    v_mul_u32_u24 v66, 205, v65
    v_lshrrev_b32 v66, 13, v66
    v_mul_u32_u24 v66, 640, v66
    v_lshl_add_u32 v70, v65, 4, v66
    v_add_u32 v65, 192, v1
    v_mul_u32_u24 v66, 205, v65
    v_lshrrev_b32 v66, 13, v66
    v_mul_u32_u24 v66, 640, v66
    v_lshl_add_u32 v71, v65, 4, v66
    v_add_u32 v65, 256, v1
    v_mul_u32_u24 v66, 205, v65
    v_lshrrev_b32 v66, 13, v66
    v_mul_u32_u24 v66, 640, v66
    v_lshl_add_u32 v72, v65, 4, v66
    s_mul_i32 s46, s45, 40960
    s_mul_i32 s47, s44, 640
    s_add_u32 s46, s46, s47
    s_mul_i32 s47, s3, 20480
    s_add_u32 s47, s47, 98304
    s_add_u32 m0, s47, 0
    s_nop 0
    buffer_load_dwordx4 v68, s[64:67], s46 offen lds
    s_add_u32 m0, s47, 1024
    s_nop 0
    buffer_load_dwordx4 v69, s[64:67], s46 offen lds
    s_add_u32 m0, s47, 2048
    s_nop 0
    buffer_load_dwordx4 v70, s[64:67], s46 offen lds
    s_add_u32 m0, s47, 3072
    s_nop 0
    buffer_load_dwordx4 v71, s[64:67], s46 offen lds
    s_add_u32 m0, s47, 4096
    s_nop 0
    buffer_load_dwordx4 v72, s[64:67], s46 offen lds
    s_add_u32 s46, s46, 10240
    s_add_u32 m0, s47, 5120
    s_nop 0
    buffer_load_dwordx4 v68, s[64:67], s46 offen lds
    s_add_u32 m0, s47, 6144
    s_nop 0
    buffer_load_dwordx4 v69, s[64:67], s46 offen lds
    s_add_u32 m0, s47, 7168
    s_nop 0
    buffer_load_dwordx4 v70, s[64:67], s46 offen lds
    s_add_u32 m0, s47, 8192
    s_nop 0
    buffer_load_dwordx4 v71, s[64:67], s46 offen lds
    s_add_u32 m0, s47, 9216
    s_nop 0
    buffer_load_dwordx4 v72, s[64:67], s46 offen lds
    s_add_u32 s46, s46, 10240
    s_add_u32 m0, s47, 10240
    s_nop 0
    buffer_load_dwordx4 v68, s[64:67], s46 offen lds
    s_add_u32 m0, s47, 11264
    s_nop 0
    buffer_load_dwordx4 v69, s[64:67], s46 offen lds
    s_add_u32 m0, s47, 12288
    s_nop 0
    buffer_load_dwordx4 v70, s[64:67], s46 offen lds
    s_add_u32 m0, s47, 13312
    s_nop 0
    buffer_load_dwordx4 v71, s[64:67], s46 offen lds
    s_add_u32 m0, s47, 14336
    s_nop 0
    buffer_load_dwordx4 v72, s[64:67], s46 offen lds
    s_add_u32 s46, s46, 10240
    s_add_u32 m0, s47, 15360
    s_nop 0
    buffer_load_dwordx4 v68, s[64:67], s46 offen lds
    s_add_u32 m0, s47, 16384
    s_nop 0
    buffer_load_dwordx4 v69, s[64:67], s46 offen lds
    s_add_u32 m0, s47, 17408
    s_nop 0
    buffer_load_dwordx4 v70, s[64:67], s46 offen lds
    s_add_u32 m0, s47, 18432
    s_nop 0
    buffer_load_dwordx4 v71, s[64:67], s46 offen lds
    s_add_u32 m0, s47, 19456
    s_nop 0
    buffer_load_dwordx4 v72, s[64:67], s46 offen lds
    s_cmp_eq_u32 s3, 0
    s_cbranch_scc0 Ls0_25
    s_barrier
Ls0_25:
    s_sub_u32 s45, s58, 352
    s_sub_u32 s46, s58, 120
    s_cmp_lt_u32 s58, 160
    s_cselect_b32 s45, s46, s45
    s_cselect_b32 s51, 1, 0
    s_and_b32 s44, s45, 1
    s_lshr_b32 s45, s45, 1
    s_lshl_b32 s46, s44, 2
    v_and_b32 v66, 3, v1
    v_add_u32 v66, s46, v66
    v_lshrrev_b32 v67, 2, v1
    v_lshl_add_u32 v64, v66, 2, v67
    s_mov_b32 s46, 311296
    s_cmp_eq_u32 s51, 1
    s_cselect_b32 s46, 278528, s46
    v_mul_u32_u24 v64, 256, v64
    v_add_u32 v64, s46, v64
    v_bfrev_b32 v66, 1
    v_cmp_gt_u32 vcc, 16, v1
    s_nop 1
    v_cndmask_b32 v138, v66, v64, vcc
    s_mov_b32 s49, 8093696
    s_mov_b32 s50, 245760
    s_cmp_eq_u32 s51, 1
    s_cselect_b32 s49, 3211264, s49
    s_cselect_b32 s50, 102400, s50
    s_lshl_b32 s48, s44, 2
    s_mul_i32 s48, s48, s50
    s_add_u32 s49, s49, s48
    s_mul_i32 s48, s45, 5120
    s_add_u32 s49, s49, s48
    s_mul_i32 s46, s3, 20480
    s_add_u32 s46, s46, 98304
    v_lshrrev_b32 v67, 4, v1
    v_lshlrev_b32 v67, 3, v67
    v_bfe_u32 v68, v1, 2, 2
    v_add_u32 v67, v67, v68
    v_mul_u32_u24 v67, 640, v67
    v_add_u32 v67, s46, v67
    v_and_b32 v68, 3, v1
    v_lshl_add_u32 v64, v68, 4, v67
    v_lshl_add_u32 v65, v68, 3, v67
    s_waitcnt vmcnt(0)
    ds_read_b64_tr_b16 v[76:77], v64 offset:0
    ds_read_b64_tr_b16 v[78:79], v64 offset:2560
    ds_read_b64_tr_b16 v[80:81], v64 offset:8
    ds_read_b64_tr_b16 v[82:83], v64 offset:2568
    ds_read_b64_tr_b16 v[84:85], v64 offset:64
    ds_read_b64_tr_b16 v[86:87], v64 offset:2624
    ds_read_b64_tr_b16 v[88:89], v64 offset:72
    ds_read_b64_tr_b16 v[90:91], v64 offset:2632
    ds_read_b64_tr_b16 v[92:93], v65 offset:128
    ds_read_b64_tr_b16 v[94:95], v65 offset:2688
    ds_read_b64_tr_b16 v[96:97], v64 offset:160
    ds_read_b64_tr_b16 v[98:99], v64 offset:2720
    ds_read_b64_tr_b16 v[100:101], v64 offset:168
    ds_read_b64_tr_b16 v[102:103], v64 offset:2728
    s_waitcnt lgkmcnt(12)
    buffer_store_dwordx4 v[76:79], v2, s[4:7], s49 offen offset:0 sc1
    ds_read_b64_tr_b16 v[104:105], v64 offset:224
    ds_read_b64_tr_b16 v[106:107], v64 offset:2784
    s_waitcnt lgkmcnt(12)
    buffer_store_dwordx4 v[80:83], v2, s[4:7], s49 offen offset:1024 sc1
    ds_read_b64_tr_b16 v[108:109], v64 offset:232
    ds_read_b64_tr_b16 v[110:111], v64 offset:2792
    s_waitcnt lgkmcnt(12)
    buffer_store_dwordx4 v[84:87], v2, s[4:7], s49 offen offset:2048 sc1
    ds_read_b64_tr_b16 v[112:113], v65 offset:288
    ds_read_b64_tr_b16 v[114:115], v65 offset:2848
    s_waitcnt lgkmcnt(12)
    buffer_store_dwordx4 v[88:91], v2, s[4:7], s49 offen offset:3072 sc1
    ds_read_b64_tr_b16 v[160:161], v64 offset:320
    ds_read_b64_tr_b16 v[162:163], v64 offset:2880
    s_waitcnt lgkmcnt(12)
    s_add_u32 s48, s49, 4096
    buffer_store_dwordx4 v[92:95], v2, s[4:7], s48 offen sc1
    s_add_u32 s49, s49, s50
    ds_read_b64_tr_b16 v[164:165], v64 offset:328
    ds_read_b64_tr_b16 v[166:167], v64 offset:2888
    s_waitcnt lgkmcnt(12)
    buffer_store_dwordx4 v[96:99], v2, s[4:7], s49 offen offset:0 sc1
    ds_read_b64_tr_b16 v[168:169], v64 offset:384
    ds_read_b64_tr_b16 v[170:171], v64 offset:2944
    s_waitcnt lgkmcnt(12)
    buffer_store_dwordx4 v[100:103], v2, s[4:7], s49 offen offset:1024 sc1
    ds_read_b64_tr_b16 v[172:173], v64 offset:392
    ds_read_b64_tr_b16 v[174:175], v64 offset:2952
    s_waitcnt lgkmcnt(12)
    buffer_store_dwordx4 v[104:107], v2, s[4:7], s49 offen offset:2048 sc1
    ds_read_b64_tr_b16 v[176:177], v65 offset:448
    ds_read_b64_tr_b16 v[178:179], v65 offset:3008
    s_waitcnt lgkmcnt(12)
    buffer_store_dwordx4 v[108:111], v2, s[4:7], s49 offen offset:3072 sc1
    ds_read_b64_tr_b16 v[180:181], v64 offset:480
    ds_read_b64_tr_b16 v[182:183], v64 offset:3040
    s_waitcnt lgkmcnt(12)
    s_add_u32 s48, s49, 4096
    buffer_store_dwordx4 v[112:115], v2, s[4:7], s48 offen sc1
    s_add_u32 s49, s49, s50
    ds_read_b64_tr_b16 v[184:185], v64 offset:488
    ds_read_b64_tr_b16 v[186:187], v64 offset:3048
    s_waitcnt lgkmcnt(12)
    buffer_store_dwordx4 v[160:163], v2, s[4:7], s49 offen offset:0 sc1
    ds_read_b64_tr_b16 v[188:189], v64 offset:544
    ds_read_b64_tr_b16 v[190:191], v64 offset:3104
    s_waitcnt lgkmcnt(12)
    buffer_store_dwordx4 v[164:167], v2, s[4:7], s49 offen offset:1024 sc1
    ds_read_b64_tr_b16 v[192:193], v64 offset:552
    ds_read_b64_tr_b16 v[194:195], v64 offset:3112
    s_waitcnt lgkmcnt(12)
    buffer_store_dwordx4 v[168:171], v2, s[4:7], s49 offen offset:2048 sc1
    ds_read_b64_tr_b16 v[196:197], v65 offset:608
    ds_read_b64_tr_b16 v[198:199], v65 offset:3168
    s_waitcnt lgkmcnt(12)
    buffer_store_dwordx4 v[172:175], v2, s[4:7], s49 offen offset:3072 sc1
    s_waitcnt lgkmcnt(10)
    s_add_u32 s48, s49, 4096
    buffer_store_dwordx4 v[176:179], v2, s[4:7], s48 offen sc1
    s_add_u32 s49, s49, s50
    s_waitcnt lgkmcnt(8)
    buffer_store_dwordx4 v[180:183], v2, s[4:7], s49 offen offset:0 sc1
    s_waitcnt lgkmcnt(6)
    buffer_store_dwordx4 v[184:187], v2, s[4:7], s49 offen offset:1024 sc1
    s_waitcnt lgkmcnt(4)
    buffer_store_dwordx4 v[188:191], v2, s[4:7], s49 offen offset:2048 sc1
    s_waitcnt lgkmcnt(2)
    buffer_store_dwordx4 v[192:195], v2, s[4:7], s49 offen offset:3072 sc1
    s_waitcnt lgkmcnt(0)
    s_add_u32 s48, s49, 4096
    buffer_store_dwordx4 v[196:199], v2, s[4:7], s48 offen sc1
    s_add_u32 s49, s49, s50
    s_branch Ls0_7
Ls0_10:
    s_cmp_lg_u32 s3, 3
    s_cbranch_scc1 Ls0_26
    s_mov_b64 exec, 0
    s_branch Lw_0
Lw_done:
    s_mov_b64 exec, -1
    s_branch Ls0_7
Ls0_26:
    s_cmp_lg_u32 s59, 1
    s_cbranch_scc1 Ls0_7
    s_sub_u32 s45, s58, 160
    s_and_b32 s51, s45, 1
    s_lshr_b32 s45, s45, 1
    s_mul_i32 s44, s45, 43
    s_lshr_b32 s44, s44, 10
    s_mul_i32 s46, s44, 24
    s_sub_u32 s45, s45, s46
    s_lshl_b32 s46, s51, 3
    s_add_u32 s46, s46, 32
    s_load_dwordx2 s[52:53], s[0:1], s46
    s_waitcnt lgkmcnt(0)
    s_mov_b32 s64, s52
    s_and_b32 s65, s53, 0xffff
    s_mov_b32 s66, 1966080
    s_mov_b32 s67, 0x20000
    v_lshrrev_b32 v65, 3, v1
    v_and_b32 v66, 7, v1
    v_mul_u32_u24 v65, 3072, v65
    v_lshl_add_u32 v65, v66, 4, v65
    s_mul_i32 s46, s44, 491520
    s_lshl_b32 s47, s45, 7
    s_add_u32 s46, s46, s47
    s_mul_i32 s47, s3, 20480
    s_add_u32 s47, s47, 98304
    s_add_u32 m0, s47, 0
    s_nop 0
    buffer_load_dwordx4 v65, s[64:67], s46 offen lds
    s_add_u32 s46, s46, 24576
    s_add_u32 m0, s47, 1024
    s_nop 0
    buffer_load_dwordx4 v65, s[64:67], s46 offen lds
    s_add_u32 s46, s46, 24576
    s_add_u32 m0, s47, 2048
    s_nop 0
    buffer_load_dwordx4 v65, s[64:67], s46 offen lds
    s_add_u32 s46, s46, 24576
    s_add_u32 m0, s47, 3072
    s_nop 0
    buffer_load_dwordx4 v65, s[64:67], s46 offen lds
    s_add_u32 s46, s46, 24576
    s_add_u32 m0, s47, 4096
    s_nop 0
    buffer_load_dwordx4 v65, s[64:67], s46 offen lds
    s_add_u32 s46, s46, 24576
    s_add_u32 m0, s47, 5120
    s_nop 0
    buffer_load_dwordx4 v65, s[64:67], s46 offen lds
    s_add_u32 s46, s46, 24576
    s_add_u32 m0, s47, 6144
    s_nop 0
    buffer_load_dwordx4 v65, s[64:67], s46 offen lds
    s_add_u32 s46, s46, 24576
    s_add_u32 m0, s47, 7168
    s_nop 0
    buffer_load_dwordx4 v65, s[64:67], s46 offen lds
    s_add_u32 s46, s46, 24576
    s_add_u32 m0, s47, 8192
    s_nop 0
    buffer_load_dwordx4 v65, s[64:67], s46 offen lds
    s_add_u32 s46, s46, 24576
    s_add_u32 m0, s47, 9216
    s_nop 0
    buffer_load_dwordx4 v65, s[64:67], s46 offen lds
    s_add_u32 s46, s46, 24576
    s_add_u32 m0, s47, 10240
    s_nop 0
    buffer_load_dwordx4 v65, s[64:67], s46 offen lds
    s_add_u32 s46, s46, 24576
    s_add_u32 m0, s47, 11264
    s_nop 0
    buffer_load_dwordx4 v65, s[64:67], s46 offen lds
    s_add_u32 s46, s46, 24576
    s_add_u32 m0, s47, 12288
    s_nop 0
    buffer_load_dwordx4 v65, s[64:67], s46 offen lds
    s_add_u32 s46, s46, 24576
    s_add_u32 m0, s47, 13312
    s_nop 0
    buffer_load_dwordx4 v65, s[64:67], s46 offen lds
    s_add_u32 s46, s46, 24576
    s_add_u32 m0, s47, 14336
    s_nop 0
    buffer_load_dwordx4 v65, s[64:67], s46 offen lds
    s_add_u32 s46, s46, 24576
    s_add_u32 m0, s47, 15360
    s_nop 0
    buffer_load_dwordx4 v65, s[64:67], s46 offen lds
    s_add_u32 s46, s46, 24576
    s_add_u32 m0, s47, 16384
    s_nop 0
    buffer_load_dwordx4 v65, s[64:67], s46 offen lds
    s_add_u32 s46, s46, 24576
    s_add_u32 m0, s47, 17408
    s_nop 0
    buffer_load_dwordx4 v65, s[64:67], s46 offen lds
    s_add_u32 s46, s46, 24576
    s_add_u32 m0, s47, 18432
    s_nop 0
    buffer_load_dwordx4 v65, s[64:67], s46 offen lds
    s_add_u32 s46, s46, 24576
    s_add_u32 m0, s47, 19456
    s_nop 0
    buffer_load_dwordx4 v65, s[64:67], s46 offen lds
    s_add_u32 s46, s46, 24576
    s_cmp_eq_u32 s3, 0
    s_cbranch_scc0 Ls0_27
    s_barrier
Ls0_27:
    s_sub_u32 s45, s58, 160
    s_and_b32 s51, s45, 1
    s_lshr_b32 s45, s45, 1
    s_mul_i32 s44, s45, 43
    s_lshr_b32 s44, s44, 10
    s_mul_i32 s46, s44, 24
    s_sub_u32 s45, s45, s46
    s_lshl_b32 s49, s45, 2
    v_and_b32 v66, 3, v1
    v_add_u32 v66, s49, v66
    v_lshrrev_b32 v70, 5, v66
    v_and_b32 v67, 1, v66
    v_lshl_add_u32 v70, v70, 1, v67
    v_bfe_u32 v71, v66, 1, 4
    v_lshrrev_b32 v67, 4, v66
    v_and_b32 v68, 15, v66
    v_cmp_lt_u32 vcc, 63, v66
    s_nop 1
    v_cndmask_b32 v70, v70, v67, vcc
    v_cndmask_b32 v71, v71, v68, vcc
    v_lshrrev_b32 v67, 2, v1
    v_lshl_add_u32 v64, v71, 2, v67
    s_mov_b32 s46, 294912
    v_mul_u32_u24 v64, 256, v64
    v_add_u32 v64, s46, v64
    v_bfrev_b32 v66, 1
    v_cmp_gt_u32 vcc, 16, v1
    s_nop 1
    v_cndmask_b32 v138, v66, v64, vcc
    s_lshl_b32 s48, s51, 4
    v_bfe_u32 v66, v1, 4, 1
    v_add3_u32 v66, s49, v66, 0
    v_lshrrev_b32 v70, 5, v66
    v_and_b32 v67, 1, v66
    v_lshl_add_u32 v70, v70, 1, v67
    v_bfe_u32 v71, v66, 1, 4
    v_lshrrev_b32 v67, 4, v66
    v_and_b32 v68, 15, v66
    v_cmp_lt_u32 vcc, 63, v66
    s_nop 1
    v_cndmask_b32 v70, v70, v67, vcc
    v_cndmask_b32 v71, v71, v68, vcc
    v_and_b32 v72, 15, v1
    v_add_u32 v72, s48, v72
    v_and_b32 v69, 0, v71
    v_sub_u32 v69, s44, v69
    v_and_b32 v69, 3, v69
    v_mul_u32_u24 v73, 30, v69
    v_add_u32 v73, v73, v70
    v_mov_b32 v74, 3072
    v_add_u32 v75, 100, v70
    v_mul_u32_u24 v66, 20, v69
    v_add3_u32 v66, v66, v70, 20
    v_mov_b32 v67, 2048
    v_mul_u32_u24 v65, 10, v69
    v_add_u32 v68, 82, v65
    v_cmp_eq_u32 vcc, 2, v70
    s_nop 1
    v_cndmask_b32 v66, v66, v68, vcc
    v_mov_b32 v68, 1024
    v_cndmask_b32 v67, v67, v68, vcc
    v_mov_b32 v68, 122
    v_cndmask_b32 v75, v75, v68, vcc
    v_cmp_lt_u32 vcc, 1, v69
    s_nop 1
    v_cndmask_b32 v73, v73, v66, vcc
    v_cndmask_b32 v74, v74, v67, vcc
    v_mul_u32_u24 v68, 41, v70
    v_add_u32 v66, v65, v68
    v_add_u32 v68, 40, v68
    v_mov_b32 v67, 1024
    v_cmp_lt_u32 vcc, 2, v70
    s_nop 1
    v_cndmask_b32 v73, v73, v66, vcc
    v_cndmask_b32 v74, v74, v67, vcc
    v_cndmask_b32 v75, v75, v68, vcc
    v_mul_u32_u24 v66, 253952, v71
    v_lshl_add_u32 v66, v72, 4, v66
    v_add_u32 v66, 4030464, v66
    v_lshl_add_u32 v73, v73, 10, v66
    v_lshl_add_u32 v75, v75, 10, v66
    v_lshrrev_b32 v67, 5, v1
    v_lshl_add_u32 v73, v67, 9, v73
    s_lshr_b32 s46, s44, 1
    s_lshl_b32 s46, s46, 9
    s_and_b32 s47, s44, 1
    s_lshl_b32 s47, s47, 3
    s_add_u32 s46, s46, s47
    v_add_u32 v75, s46, v75
    s_lshl_b32 s48, s51, 4
    v_bfe_u32 v66, v1, 4, 1
    v_add3_u32 v66, s49, v66, 2
    v_lshrrev_b32 v70, 5, v66
    v_and_b32 v67, 1, v66
    v_lshl_add_u32 v70, v70, 1, v67
    v_bfe_u32 v71, v66, 1, 4
    v_lshrrev_b32 v67, 4, v66
    v_and_b32 v68, 15, v66
    v_cmp_lt_u32 vcc, 63, v66
    s_nop 1
    v_cndmask_b32 v70, v70, v67, vcc
    v_cndmask_b32 v71, v71, v68, vcc
    v_and_b32 v72, 15, v1
    v_add_u32 v72, s48, v72
    v_and_b32 v69, 0, v71
    v_sub_u32 v69, s44, v69
    v_and_b32 v69, 3, v69
    v_mul_u32_u24 v121, 30, v69
    v_add_u32 v121, v121, v70
    v_mov_b32 v122, 3072
    v_add_u32 v123, 100, v70
    v_mul_u32_u24 v66, 20, v69
    v_add3_u32 v66, v66, v70, 20
    v_mov_b32 v67, 2048
    v_mul_u32_u24 v65, 10, v69
    v_add_u32 v68, 82, v65
    v_cmp_eq_u32 vcc, 2, v70
    s_nop 1
    v_cndmask_b32 v66, v66, v68, vcc
    v_mov_b32 v68, 1024
    v_cndmask_b32 v67, v67, v68, vcc
    v_mov_b32 v68, 122
    v_cndmask_b32 v123, v123, v68, vcc
    v_cmp_lt_u32 vcc, 1, v69
    s_nop 1
    v_cndmask_b32 v121, v121, v66, vcc
    v_cndmask_b32 v122, v122, v67, vcc
    v_mul_u32_u24 v68, 41, v70
    v_add_u32 v66, v65, v68
    v_add_u32 v68, 40, v68
    v_mov_b32 v67, 1024
    v_cmp_lt_u32 vcc, 2, v70
    s_nop 1
    v_cndmask_b32 v121, v121, v66, vcc
    v_cndmask_b32 v122, v122, v67, vcc
    v_cndmask_b32 v123, v123, v68, vcc
    v_mul_u32_u24 v66, 253952, v71
    v_lshl_add_u32 v66, v72, 4, v66
    v_add_u32 v66, 4030464, v66
    v_lshl_add_u32 v121, v121, 10, v66
    v_lshl_add_u32 v123, v123, 10, v66
    v_lshrrev_b32 v67, 5, v1
    v_lshl_add_u32 v121, v67, 9, v121
    s_lshr_b32 s46, s44, 1
    s_lshl_b32 s46, s46, 9
    s_and_b32 s47, s44, 1
    s_lshl_b32 s47, s47, 3
    s_add_u32 s46, s46, s47
    v_add_u32 v123, s46, v123
    s_mul_i32 s46, s3, 20480
    s_add_u32 s46, s46, 98304
    v_lshrrev_b32 v67, 5, v1
    v_lshlrev_b32 v67, 3, v67
    v_bfe_u32 v68, v1, 2, 2
    v_add_u32 v67, v67, v68
    v_lshlrev_b32 v67, 7, v67
    v_add_u32 v67, s46, v67
    v_bfe_u32 v66, v1, 4, 1
    v_lshl_add_u32 v67, v66, 5, v67
    v_and_b32 v68, 1, v1
    v_lshl_add_u32 v67, v68, 4, v67
    v_bfe_u32 v68, v1, 1, 1
    v_lshl_add_u32 v64, v68, 3, v67
Ls0_11:
    v_mov_b32 v69, 0
    v_mov_b32 v65, 0
    v_mov_b32 v70, 0
    v_mov_b32 v71, 0
    s_mov_b32 s46, 0x3f803f80
    s_waitcnt vmcnt(0)
    ds_read_b64_tr_b16 v[76:77], v64 offset:0
    ds_read_b64_tr_b16 v[78:79], v64 offset:512
    ds_read_b64_tr_b16 v[80:81], v64 offset:2048
    ds_read_b64_tr_b16 v[82:83], v64 offset:2560
    ds_read_b64_tr_b16 v[84:85], v64 offset:4096
    ds_read_b64_tr_b16 v[86:87], v64 offset:4608
    ds_read_b64_tr_b16 v[88:89], v64 offset:6144
    ds_read_b64_tr_b16 v[90:91], v64 offset:6656
    ds_read_b64_tr_b16 v[92:93], v64 offset:8192
    ds_read_b64_tr_b16 v[94:95], v64 offset:8704
    ds_read_b64_tr_b16 v[96:97], v64 offset:10240
    ds_read_b64_tr_b16 v[98:99], v64 offset:10752
    ds_read_b64_tr_b16 v[100:101], v64 offset:12288
    ds_read_b64_tr_b16 v[102:103], v64 offset:12800
    s_waitcnt lgkmcnt(12)
    buffer_store_dwordx4 v[76:79], v73, s[4:7], 0 offen sc1
    v_add_u32 v73, v73, v74
    ds_read_b64_tr_b16 v[104:105], v64 offset:14336
    ds_read_b64_tr_b16 v[106:107], v64 offset:14848
    s_waitcnt lgkmcnt(12)
    buffer_store_dwordx4 v[80:83], v73, s[4:7], 0 offen sc1
    v_add_u32 v73, v73, v74
    ds_read_b64_tr_b16 v[108:109], v64 offset:16384
    ds_read_b64_tr_b16 v[110:111], v64 offset:16896
    s_waitcnt lgkmcnt(12)
    buffer_store_dwordx4 v[84:87], v73, s[4:7], 0 offen sc1
    v_add_u32 v73, v73, v74
    ds_read_b64_tr_b16 v[112:113], v64 offset:18432
    ds_read_b64_tr_b16 v[114:115], v64 offset:18944
    s_waitcnt lgkmcnt(12)
    buffer_store_dwordx4 v[88:91], v73, s[4:7], 0 offen sc1
    v_add_u32 v73, v73, v74
    ds_read_b64_tr_b16 v[160:161], v64 offset:64
    ds_read_b64_tr_b16 v[162:163], v64 offset:576
    s_waitcnt lgkmcnt(12)
    buffer_store_dwordx4 v[92:95], v73, s[4:7], 0 offen sc1
    v_add_u32 v73, v73, v74
    ds_read_b64_tr_b16 v[164:165], v64 offset:2112
    ds_read_b64_tr_b16 v[166:167], v64 offset:2624
    s_waitcnt lgkmcnt(12)
    buffer_store_dwordx4 v[96:99], v73, s[4:7], 0 offen sc1
    v_add_u32 v73, v73, v74
    ds_read_b64_tr_b16 v[168:169], v64 offset:4160
    ds_read_b64_tr_b16 v[170:171], v64 offset:4672
    s_waitcnt lgkmcnt(12)
    buffer_store_dwordx4 v[100:103], v73, s[4:7], 0 offen sc1
    v_add_u32 v73, v73, v74
    ds_read_b64_tr_b16 v[172:173], v64 offset:6208
    ds_read_b64_tr_b16 v[174:175], v64 offset:6720
    s_waitcnt lgkmcnt(12)
    buffer_store_dwordx4 v[104:107], v73, s[4:7], 0 offen sc1
    v_add_u32 v73, v73, v74
    ds_read_b64_tr_b16 v[176:177], v64 offset:8256
    ds_read_b64_tr_b16 v[178:179], v64 offset:8768
    s_waitcnt lgkmcnt(12)
    buffer_store_dwordx4 v[108:111], v73, s[4:7], 0 offen sc1
    v_add_u32 v73, v73, v74
    ds_read_b64_tr_b16 v[180:181], v64 offset:10304
    ds_read_b64_tr_b16 v[182:183], v64 offset:10816
    s_waitcnt lgkmcnt(12)
    buffer_store_dwordx4 v[112:115], v73, s[4:7], 0 offen sc1
    v_add_u32 v73, v73, v74
    ds_read_b64_tr_b16 v[184:185], v64 offset:12352
    ds_read_b64_tr_b16 v[186:187], v64 offset:12864
    s_waitcnt lgkmcnt(12)
    buffer_store_dwordx4 v[160:163], v121, s[4:7], 0 offen sc1
    v_add_u32 v121, v121, v122
    ds_read_b64_tr_b16 v[188:189], v64 offset:14400
    ds_read_b64_tr_b16 v[190:191], v64 offset:14912
    s_waitcnt lgkmcnt(12)
    buffer_store_dwordx4 v[164:167], v121, s[4:7], 0 offen sc1
    v_add_u32 v121, v121, v122
    ds_read_b64_tr_b16 v[192:193], v64 offset:16448
    ds_read_b64_tr_b16 v[194:195], v64 offset:16960
    s_waitcnt lgkmcnt(12)
    buffer_store_dwordx4 v[168:171], v121, s[4:7], 0 offen sc1
    v_add_u32 v121, v121, v122
    ds_read_b64_tr_b16 v[196:197], v64 offset:18496
    ds_read_b64_tr_b16 v[198:199], v64 offset:19008
    s_waitcnt lgkmcnt(12)
    buffer_store_dwordx4 v[172:175], v121, s[4:7], 0 offen sc1
    v_add_u32 v121, v121, v122
    s_waitcnt lgkmcnt(10)
    buffer_store_dwordx4 v[176:179], v121, s[4:7], 0 offen sc1
    v_add_u32 v121, v121, v122
    s_waitcnt lgkmcnt(8)
    buffer_store_dwordx4 v[180:183], v121, s[4:7], 0 offen sc1
    v_add_u32 v121, v121, v122
    s_waitcnt lgkmcnt(6)
    buffer_store_dwordx4 v[184:187], v121, s[4:7], 0 offen sc1
    v_add_u32 v121, v121, v122
    s_waitcnt lgkmcnt(4)
    buffer_store_dwordx4 v[188:191], v121, s[4:7], 0 offen sc1
    v_add_u32 v121, v121, v122
    s_waitcnt lgkmcnt(2)
    buffer_store_dwordx4 v[192:195], v121, s[4:7], 0 offen sc1
    v_add_u32 v121, v121, v122
    s_waitcnt lgkmcnt(0)
    buffer_store_dwordx4 v[196:199], v121, s[4:7], 0 offen sc1
    v_add_u32 v121, v121, v122
    s_cmp_lg_u32 s59, 0
    s_cbranch_scc1 Ls0_12
    s_barrier
Ls0_12:
    v_dot2_f32_bf16 v69, v76, s46, v69
    v_dot2_f32_bf16 v70, v160, s46, v70
    v_dot2_f32_bf16 v65, v77, s46, v65
    v_dot2_f32_bf16 v71, v161, s46, v71
    v_dot2_f32_bf16 v69, v78, s46, v69
    v_dot2_f32_bf16 v70, v162, s46, v70
    v_dot2_f32_bf16 v65, v79, s46, v65
    v_dot2_f32_bf16 v71, v163, s46, v71
    v_dot2_f32_bf16 v69, v80, s46, v69
    v_dot2_f32_bf16 v70, v164, s46, v70
    v_dot2_f32_bf16 v65, v81, s46, v65
    v_dot2_f32_bf16 v71, v165, s46, v71
    v_dot2_f32_bf16 v69, v82, s46, v69
    v_dot2_f32_bf16 v70, v166, s46, v70
    v_dot2_f32_bf16 v65, v83, s46, v65
    v_dot2_f32_bf16 v71, v167, s46, v71
    v_dot2_f32_bf16 v69, v84, s46, v69
    v_dot2_f32_bf16 v70, v168, s46, v70
    v_dot2_f32_bf16 v65, v85, s46, v65
    v_dot2_f32_bf16 v71, v169, s46, v71
    v_dot2_f32_bf16 v69, v86, s46, v69
    v_dot2_f32_bf16 v70, v170, s46, v70
    v_dot2_f32_bf16 v65, v87, s46, v65
    v_dot2_f32_bf16 v71, v171, s46, v71
    v_dot2_f32_bf16 v69, v88, s46, v69
    v_dot2_f32_bf16 v70, v172, s46, v70
    v_dot2_f32_bf16 v65, v89, s46, v65
    v_dot2_f32_bf16 v71, v173, s46, v71
    v_dot2_f32_bf16 v69, v90, s46, v69
    v_dot2_f32_bf16 v70, v174, s46, v70
    v_dot2_f32_bf16 v65, v91, s46, v65
    v_dot2_f32_bf16 v71, v175, s46, v71
    v_dot2_f32_bf16 v69, v92, s46, v69
    v_dot2_f32_bf16 v70, v176, s46, v70
    v_dot2_f32_bf16 v65, v93, s46, v65
    v_dot2_f32_bf16 v71, v177, s46, v71
    v_dot2_f32_bf16 v69, v94, s46, v69
    v_dot2_f32_bf16 v70, v178, s46, v70
    v_dot2_f32_bf16 v65, v95, s46, v65
    v_dot2_f32_bf16 v71, v179, s46, v71
    v_dot2_f32_bf16 v69, v96, s46, v69
    v_dot2_f32_bf16 v70, v180, s46, v70
    v_dot2_f32_bf16 v65, v97, s46, v65
    v_dot2_f32_bf16 v71, v181, s46, v71
    v_dot2_f32_bf16 v69, v98, s46, v69
    v_dot2_f32_bf16 v70, v182, s46, v70
    v_dot2_f32_bf16 v65, v99, s46, v65
    v_dot2_f32_bf16 v71, v183, s46, v71
    v_dot2_f32_bf16 v69, v100, s46, v69
    v_dot2_f32_bf16 v70, v184, s46, v70
    v_dot2_f32_bf16 v65, v101, s46, v65
    v_dot2_f32_bf16 v71, v185, s46, v71
    v_dot2_f32_bf16 v69, v102, s46, v69
    v_dot2_f32_bf16 v70, v186, s46, v70
    v_dot2_f32_bf16 v65, v103, s46, v65
    v_dot2_f32_bf16 v71, v187, s46, v71
    v_dot2_f32_bf16 v69, v104, s46, v69
    v_dot2_f32_bf16 v70, v188, s46, v70
    v_dot2_f32_bf16 v65, v105, s46, v65
    v_dot2_f32_bf16 v71, v189, s46, v71
    v_dot2_f32_bf16 v69, v106, s46, v69
    v_dot2_f32_bf16 v70, v190, s46, v70
    v_dot2_f32_bf16 v65, v107, s46, v65
    v_dot2_f32_bf16 v71, v191, s46, v71
    v_dot2_f32_bf16 v69, v108, s46, v69
    v_dot2_f32_bf16 v70, v192, s46, v70
    v_dot2_f32_bf16 v65, v109, s46, v65
    v_dot2_f32_bf16 v71, v193, s46, v71
    v_dot2_f32_bf16 v69, v110, s46, v69
    v_dot2_f32_bf16 v70, v194, s46, v70
    v_dot2_f32_bf16 v65, v111, s46, v65
    v_dot2_f32_bf16 v71, v195, s46, v71
    v_dot2_f32_bf16 v69, v112, s46, v69
    v_dot2_f32_bf16 v70, v196, s46, v70
    v_dot2_f32_bf16 v65, v113, s46, v65
    v_dot2_f32_bf16 v71, v197, s46, v71
    v_dot2_f32_bf16 v69, v114, s46, v69
    v_dot2_f32_bf16 v70, v198, s46, v70
    v_dot2_f32_bf16 v65, v115, s46, v65
    v_dot2_f32_bf16 v71, v199, s46, v71
    s_nop 1
    v_add_f32 v69, v69, v65
    v_add_f32 v70, v70, v71
    s_nop 1
    v_permlane32_swap_b32 v69, v70
    v_add_f32 v69, v69, v70
    v_cvt_pk_bf16_f32 v66, v69, v69
    v_and_b32 v70, 0xffff0000, v66
    v_sub_f32 v70, v69, v70
    v_cvt_pk_bf16_f32 v67, v70, v70
    v_cmp_gt_u32 vcc, 32, v1
    s_nop 1
    v_cndmask_b32 v72, v123, v75, vcc
    s_cmp_lg_u32 s59, 0
    s_cbranch_scc1 Ls0_28
    s_load_dword s56, s[68:69], 0
    s_waitcnt vmcnt(0) lgkmcnt(0)
    s_and_b32 s55, s56, 0xff
    s_cmp_ge_u32 s55, 2
    s_cbranch_scc1 Lbk_29
    s_mov_b32 s55, 0
    v_mov_b32 v68, 0
Lbw_30:
    s_sleep 4
    global_load_dword v69, v68, s[68:69] offset:0 sc1
    s_waitcnt vmcnt(0)
    v_readfirstlane_b32 s56, v69
    s_nop 1
    s_and_b32 s54, s56, 0xff
    s_cmp_ge_u32 s54, 2
    s_cbranch_scc1 Lbo_31
    s_add_u32 s55, s55, 1
    s_cmp_lt_u32 s55, 400000
    s_cbranch_scc1 Lbw_30
Lbo_31:
Lbk_29:
    s_mul_i32 s47, s57, 205
    s_lshr_b32 s47, s47, 10
    s_add_u32 s48, s57, 8
    s_add_u32 s49, s47, 0
    s_mul_i32 s50, s49, 5
    s_add_u32 s51, s50, 5
    s_min_i32 s51, s51, s48
    s_max_i32 s50, s50, s57
    s_sub_i32 s52, s51, s50
    s_cmp_lt_i32 s52, 1
    s_cbranch_scc1 Ls0k_32
    s_mul_i32 s49, s49, 1024
    s_add_u32 s49, s49, 262144
    s_atomic_add s52, s[12:13], s49
    s_add_u32 s49, s49, 256
    s_atomic_add s52, s[12:13], s49
    s_add_u32 s49, s49, 256
    s_atomic_add s52, s[12:13], s49
    s_add_u32 s49, s49, 256
    s_atomic_add s52, s[12:13], s49
Ls0k_32:
    s_add_u32 s49, s47, 1
    s_mul_i32 s50, s49, 5
    s_add_u32 s51, s50, 5
    s_min_i32 s51, s51, s48
    s_max_i32 s50, s50, s57
    s_sub_i32 s53, s51, s50
    s_cmp_lt_i32 s53, 1
    s_cbranch_scc1 Ls0k_33
    s_mul_i32 s49, s49, 1024
    s_add_u32 s49, s49, 262144
    s_atomic_add s53, s[12:13], s49
    s_add_u32 s49, s49, 256
    s_atomic_add s53, s[12:13], s49
    s_add_u32 s49, s49, 256
    s_atomic_add s53, s[12:13], s49
    s_add_u32 s49, s49, 256
    s_atomic_add s53, s[12:13], s49
Ls0k_33:
    s_add_u32 s49, s47, 2
    s_mul_i32 s50, s49, 5
    s_add_u32 s51, s50, 5
    s_min_i32 s51, s51, s48
    s_max_i32 s50, s50, s57
    s_sub_i32 s54, s51, s50
    s_cmp_lt_i32 s54, 1
    s_cbranch_scc1 Ls0k_34
    s_mul_i32 s49, s49, 1024
    s_add_u32 s49, s49, 262144
    s_atomic_add s54, s[12:13], s49
    s_add_u32 s49, s49, 256
    s_atomic_add s54, s[12:13], s49
    s_add_u32 s49, s49, 256
    s_atomic_add s54, s[12:13], s49
    s_add_u32 s49, s49, 256
    s_atomic_add s54, s[12:13], s49
Ls0k_34:
    v_lshlrev_b32 v139, 8, v139
Ls0_28:
    buffer_store_dwordx2 v[66:67], v72, s[4:7], 0 offen sc1
Ls0_7:
    s_barrier
    s_mov_b32 s64, s12
    s_and_b32 s65, s13, 0xffff
    s_mov_b32 s66, 62914560
    s_mov_b32 s67, 0x20000
    v_mov_b32 v64, 163776
    ds_read_b32 v65, v64
L_ijback:
    s_mul_i32 s56, s41, 256
    s_add_u32 s56, s56, s18
    s_add_u32 s56, s56, 262144
    s_mov_b32 s63, 0
    s_atomic_add s63, s[12:13], s56 glc
    s_mul_i32 s71, s24, 256
    s_add_u32 s71, s71, s18
    s_mov_b32 s37, 0
    s_mov_b32 s43, 0
    s_atomic_umax s37, s[12:13], s71 glc
    s_nop 1
    v_add_u32 v196, s84, v2
    v_add_u32 v197, s85, v2
    v_add_u32 v198, s86, v2
    v_add_u32 v199, 0x10000, v3
    v_add_u32 v200, 0x20000, v3
    v_lshlrev_b32 v201, 3, v0
Lpoll_35:
    s_mov_b32 s55, 0
Lpoll_35_l:
    s_waitcnt lgkmcnt(0)
    s_bfe_u32 s63, s63, 524288
    s_cmp_ge_u32 s63, 60
    s_cbranch_scc1 Lok_36
    s_mov_b32 s63, 0
    s_atomic_add s63, s[12:13], s56 glc
    s_add_u32 s55, s55, 1
    s_cmp_lt_u32 s55, 400000
    s_cbranch_scc1 Lpoll_35_l
    s_waitcnt lgkmcnt(0)
Lok_36:
    v_readfirstlane_b32 s44, v65
    s_atomic_umax s43, s[12:13], s71 glc
    s_mov_b32 s55, 0
Lpoll_37:
    s_waitcnt lgkmcnt(1)
    s_max_u32 s98, s37, s43
    s_and_b32 s98, s98, 0xff
    s_cmp_ge_u32 s98, 4
    s_cbranch_scc1 Lok_38
    s_atomic_umax s37, s[12:13], s71 glc
    s_waitcnt lgkmcnt(1)
    s_max_u32 s98, s37, s43
    s_and_b32 s98, s98, 0xff
    s_cmp_ge_u32 s98, 4
    s_cbranch_scc1 Lok_38
    s_atomic_umax s43, s[12:13], s71 glc
    s_add_u32 s55, s55, 1
    s_cmp_lt_u32 s55, 400000
    s_cbranch_scc1 Lpoll_37
Lok_38:
    s_cmp_lg_u32 s44, s100
    s_cbranch_scc1 L_ijredo
    s_add_u32 m0, s85, 0
    s_add_u32 s59, s20, 0
    buffer_load_dwordx4 v197, s[4:7], s59 offen offset:0 sc1 lds
    buffer_load_dwordx4 v197, s[4:7], s59 offen offset:1024 sc1 lds
    buffer_load_dwordx4 v197, s[4:7], s59 offen offset:2048 sc1 lds
    s_add_u32 s70, s17, s27
    buffer_load_dwordx4 a[0:3], v2, s[4:7], s70 offen offset:0 sc1
    buffer_load_dwordx4 a[4:7], v2, s[4:7], s70 offen offset:1024 sc1
    buffer_load_dwordx4 a[8:11], v2, s[4:7], s70 offen offset:2048 sc1
    buffer_load_dwordx4 a[12:15], v2, s[4:7], s70 offen offset:3072 sc1
    s_add_u32 m0, s85, 12288
    s_add_u32 s59, s20, 12288
    buffer_load_dwordx4 v197, s[4:7], s59 offen offset:0 sc1 lds
    buffer_load_dwordx4 v197, s[4:7], s59 offen offset:1024 sc1 lds
    buffer_load_dwordx4 v197, s[4:7], s59 offen offset:2048 sc1 lds
    s_add_u32 s70, s70, 4096
    buffer_load_dwordx4 a[16:19], v2, s[4:7], s70 offen offset:0 sc1
    s_add_u32 s70, s70, 12288
    s_xor_b32 s70, s70, 8192
    buffer_load_dwordx4 a[20:23], v2, s[4:7], s70 offen offset:0 sc1
    buffer_load_dwordx4 a[24:27], v2, s[4:7], s70 offen offset:1024 sc1
    buffer_load_dwordx4 a[28:31], v2, s[4:7], s70 offen offset:2048 sc1
    s_add_u32 m0, s85, 24576
    s_add_u32 s59, s20, 24576
    buffer_load_dwordx4 v197, s[4:7], s59 offen offset:0 sc1 lds
    buffer_load_dwordx4 v197, s[4:7], s59 offen offset:1024 sc1 lds
    buffer_load_dwordx4 v197, s[4:7], s59 offen offset:2048 sc1 lds
    buffer_load_dwordx4 a[32:35], v2, s[4:7], s70 offen offset:3072 sc1
    s_add_u32 s70, s70, 4096
    buffer_load_dwordx4 a[36:39], v2, s[4:7], s70 offen offset:0 sc1
    s_add_u32 s70, s70, 12288
    s_xor_b32 s70, s70, 8192
    buffer_load_dwordx4 a[40:43], v2, s[4:7], s70 offen offset:0 sc1
    buffer_load_dwordx4 a[44:47], v2, s[4:7], s70 offen offset:1024 sc1
    s_waitcnt vmcnt(18)
    s_barrier
    ds_read_b128 v[160:163], v2 offset:0
    ds_read_b128 v[164:167], v2 offset:1024
    ds_read_b128 v[168:171], v2 offset:2048
    ds_read_b128 v[172:175], v2 offset:3072
    ds_read_b128 v[176:179], v2 offset:4096
    ds_read_b128 v[180:183], v2 offset:5120
    ds_read_b128 v[184:187], v2 offset:6144
    ds_read_b128 v[188:191], v2 offset:7168
    s_waitcnt vmcnt(17) lgkmcnt(5)
    v_mfma_f32_32x32x16_bf16 v[64:79], a[0:3], v[160:163], 0
    ds_read_b128 v[192:195], v2 offset:8192
    s_add_u32 m0, s85, 36864
    s_add_u32 s59, s20, 36864
    buffer_load_dwordx4 v197, s[4:7], s59 offen offset:0 sc1 lds
    v_mfma_f32_32x32x16_bf16 v[80:95], a[0:3], v[164:167], 0
    ds_read_b128 v[160:163], v2 offset:9216
    buffer_atomic_add v139, v138, s[4:7], 0 offen sc1
    v_mfma_f32_32x32x16_bf16 v[96:111], a[0:3], v[168:171], 0
    ds_read_b128 v[164:167], v2 offset:10240
    buffer_load_dwordx4 v197, s[4:7], s59 offen offset:1024 sc1 lds
    s_waitcnt vmcnt(19) lgkmcnt(5)
    v_mfma_f32_32x32x16_bf16 v[64:79], a[4:7], v[172:175], v[64:79]
    ds_read_b128 v[168:171], v2 offset:11264
    v_mfma_f32_32x32x16_bf16 v[80:95], a[4:7], v[176:179], v[80:95]
    s_waitcnt vmcnt(14)
    s_barrier
    ds_read_b128 v[172:175], v2 offset:12288
    buffer_load_dwordx4 v197, s[4:7], s59 offen offset:2048 sc1 lds
    v_mfma_f32_32x32x16_bf16 v[96:111], a[4:7], v[180:183], v[96:111]
    ds_read_b128 v[176:179], v2 offset:13312
    buffer_load_dwordx4 a[48:51], v2, s[4:7], s70 offen offset:2048 sc1
    s_waitcnt lgkmcnt(5)
    v_mfma_f32_32x32x16_bf16 v[64:79], a[8:11], v[184:187], v[64:79]
    ds_read_b128 v[180:183], v2 offset:14336
    v_mfma_f32_32x32x16_bf16 v[80:95], a[8:11], v[188:191], v[80:95]
    ds_read_b128 v[184:187], v2 offset:15360
    buffer_load_dwordx4 a[52:55], v2, s[4:7], s70 offen offset:3072 sc1
    v_mfma_f32_32x32x16_bf16 v[96:111], a[8:11], v[192:195], v[96:111]
    ds_read_b128 v[188:191], v2 offset:16384
    s_add_u32 s70, s70, 4096
    buffer_load_dwordx4 a[56:59], v2, s[4:7], s70 offen offset:0 sc1
    s_waitcnt lgkmcnt(5)
    v_mfma_f32_32x32x16_bf16 v[64:79], a[12:15], v[160:163], v[64:79]
    ds_read_b128 v[192:195], v2 offset:17408
    v_mfma_f32_32x32x16_bf16 v[80:95], a[12:15], v[164:167], v[80:95]
    ds_read_b128 v[160:163], v2 offset:18432
    s_add_u32 m0, s85, 49152
    s_add_u32 s59, s20, 49152
    buffer_load_dwordx4 v197, s[4:7], s59 offen offset:0 sc1 lds
    v_mfma_f32_32x32x16_bf16 v[96:111], a[12:15], v[168:171], v[96:111]
    ds_read_b128 v[164:167], v2 offset:19456
    s_waitcnt vmcnt(18) lgkmcnt(5)
    v_mfma_f32_32x32x16_bf16 v[64:79], a[16:19], v[172:175], v[64:79]
    ds_read_b128 v[168:171], v2 offset:20480
    buffer_load_dwordx4 v197, s[4:7], s59 offen offset:1024 sc1 lds
    v_mfma_f32_32x32x16_bf16 v[80:95], a[16:19], v[176:179], v[80:95]
    ds_read_b128 v[172:175], v2 offset:21504
    buffer_load_dwordx4 v197, s[4:7], s59 offen offset:2048 sc1 lds
    v_mfma_f32_32x32x16_bf16 v[96:111], a[16:19], v[180:183], v[96:111]
    ds_read_b128 v[176:179], v2 offset:22528
    s_waitcnt vmcnt(19) lgkmcnt(5)
    v_mfma_f32_32x32x16_bf16 v[64:79], a[20:23], v[184:187], v[64:79]
    ds_read_b128 v[180:183], v2 offset:23552
    s_add_u32 s70, s70, 12288
    s_xor_b32 s70, s70, 8192
    buffer_load_dwordx4 a[60:63], v2, s[4:7], s70 offen offset:0 sc1
    v_mfma_f32_32x32x16_bf16 v[80:95], a[20:23], v[188:191], v[80:95]
    s_waitcnt vmcnt(15)
    s_barrier
    ds_read_b128 v[184:187], v2 offset:24576
    buffer_load_dwordx4 a[64:67], v2, s[4:7], s70 offen offset:1024 sc1
    v_mfma_f32_32x32x16_bf16 v[96:111], a[20:23], v[192:195], v[96:111]
    ds_read_b128 v[188:191], v2 offset:25600
    s_waitcnt lgkmcnt(5)
    v_mfma_f32_32x32x16_bf16 v[64:79], a[24:27], v[160:163], v[64:79]
    ds_read_b128 v[192:195], v2 offset:26624
    buffer_load_dwordx4 a[68:71], v2, s[4:7], s70 offen offset:2048 sc1
    v_mfma_f32_32x32x16_bf16 v[80:95], a[24:27], v[164:167], v[80:95]
    ds_read_b128 v[160:163], v2 offset:27648
    v_mfma_f32_32x32x16_bf16 v[96:111], a[24:27], v[168:171], v[96:111]
    ds_read_b128 v[164:167], v2 offset:28672
    buffer_load_dwordx4 a[72:75], v2, s[4:7], s70 offen offset:3072 sc1
    s_waitcnt lgkmcnt(5)
    v_mfma_f32_32x32x16_bf16 v[64:79], a[28:31], v[172:175], v[64:79]
    ds_read_b128 v[168:171], v2 offset:29696
    s_add_u32 m0, s85, 61440
    s_add_u32 s59, s20, 61440
    buffer_load_dwordx4 v197, s[4:7], s59 offen offset:0 sc1 lds
    v_mfma_f32_32x32x16_bf16 v[80:95], a[28:31], v[176:179], v[80:95]
    ds_read_b128 v[172:175], v2 offset:30720
    v_mfma_f32_32x32x16_bf16 v[96:111], a[28:31], v[180:183], v[96:111]
    ds_read_b128 v[176:179], v2 offset:31744
    buffer_load_dwordx4 v197, s[4:7], s59 offen offset:1024 sc1 lds
    s_waitcnt vmcnt(19) lgkmcnt(5)
    v_mfma_f32_32x32x16_bf16 v[64:79], a[32:35], v[184:187], v[64:79]
    ds_read_b128 v[180:183], v2 offset:32768
    v_mfma_f32_32x32x16_bf16 v[80:95], a[32:35], v[188:191], v[80:95]
    ds_read_b128 v[184:187], v2 offset:33792
    buffer_load_dwordx4 v197, s[4:7], s59 offen offset:2048 sc1 lds
    v_mfma_f32_32x32x16_bf16 v[96:111], a[32:35], v[192:195], v[96:111]
    ds_read_b128 v[188:191], v2 offset:34816
    s_add_u32 s70, s70, 4096
    buffer_load_dwordx4 a[76:79], v2, s[4:7], s70 offen offset:0 sc1
    s_mul_i32 s56, s24, 256
    s_add_u32 s56, s56, s18
    s_mov_b32 s63, 0
    s_atomic_add s63, s[12:13], s56 glc
    s_waitcnt vmcnt(20) lgkmcnt(5)
    v_mfma_f32_32x32x16_bf16 v[64:79], a[36:39], v[160:163], v[64:79]
    ds_read_b128 v[192:195], v2 offset:35840
    v_mfma_f32_32x32x16_bf16 v[80:95], a[36:39], v[164:167], v[80:95]
    s_waitcnt vmcnt(14)
    s_barrier
    ds_read_b128 v[160:163], v2 offset:36864
    s_add_u32 s70, s70, 12288
    s_xor_b32 s70, s70, 8192
    buffer_load_dwordx4 a[80:83], v2, s[4:7], s70 offen offset:0 sc1
    v_mfma_f32_32x32x16_bf16 v[96:111], a[36:39], v[168:171], v[96:111]
    ds_read_b128 v[164:167], v2 offset:37888
    buffer_load_dwordx4 a[84:87], v2, s[4:7], s70 offen offset:1024 sc1
    s_waitcnt lgkmcnt(5)
    v_mfma_f32_32x32x16_bf16 v[64:79], a[40:43], v[172:175], v[64:79]
    ds_read_b128 v[168:171], v2 offset:38912
    v_mfma_f32_32x32x16_bf16 v[80:95], a[40:43], v[176:179], v[80:95]
    ds_read_b128 v[172:175], v2 offset:39936
    buffer_load_dwordx4 a[88:91], v2, s[4:7], s70 offen offset:2048 sc1
    v_mfma_f32_32x32x16_bf16 v[96:111], a[40:43], v[180:183], v[96:111]
    ds_read_b128 v[176:179], v2 offset:40960
    s_waitcnt lgkmcnt(5)
    v_mfma_f32_32x32x16_bf16 v[64:79], a[44:47], v[184:187], v[64:79]
    ds_read_b128 v[180:183], v2 offset:41984
    buffer_load_dwordx4 a[92:95], v2, s[4:7], s70 offen offset:3072 sc1
    v_mfma_f32_32x32x16_bf16 v[80:95], a[44:47], v[188:191], v[80:95]
    ds_read_b128 v[184:187], v2 offset:43008
    s_add_u32 m0, s85, 73728
    s_add_u32 s59, s20, 73728
    buffer_load_dwordx4 v197, s[4:7], s59 offen offset:0 sc1 lds
    v_mfma_f32_32x32x16_bf16 v[96:111], a[44:47], v[192:195], v[96:111]
    ds_read_b128 v[188:191], v2 offset:44032
    s_waitcnt vmcnt(18) lgkmcnt(5)
    v_mfma_f32_32x32x16_bf16 v[64:79], a[48:51], v[160:163], v[64:79]
    ds_read_b128 v[192:195], v2 offset:45056
    buffer_load_dwordx4 v197, s[4:7], s59 offen offset:1024 sc1 lds
    v_mfma_f32_32x32x16_bf16 v[80:95], a[48:51], v[164:167], v[80:95]
    ds_read_b128 v[160:163], v2 offset:46080
    buffer_load_dwordx4 v197, s[4:7], s59 offen offset:2048 sc1 lds
    v_mfma_f32_32x32x16_bf16 v[96:111], a[48:51], v[168:171], v[96:111]
    ds_read_b128 v[164:167], v2 offset:47104
Lpoll_39:
    s_mov_b32 s55, 0
Lpoll_39_l:
    s_waitcnt lgkmcnt(0)
    s_bfe_u32 s63, s63, 524296
    s_cmp_ge_u32 s63, 4
    s_cbranch_scc1 Lok_40
    s_mov_b32 s63, 0
    s_atomic_add s63, s[12:13], s56 glc
    s_add_u32 s55, s55, 1
    s_cmp_lt_u32 s55, 400000
    s_cbranch_scc1 Lpoll_39_l
    s_waitcnt lgkmcnt(0)
Lok_40:
    s_add_u32 s44, s17, s28
    s_add_u32 s44, s44, 20971520
    buffer_load_dwordx2 v[56:57], v6, s[4:7], s44 offen offset:0 sc1
    buffer_load_dwordx2 v[58:59], v6, s[4:7], s44 offen offset:256 sc1
    buffer_load_dwordx2 v[60:61], v6, s[4:7], s44 offen offset:512 sc1
Lw_0:
    s_cbranch_execz Lw_1
    buffer_load_dwordx2 v[62:63], v6, s[4:7], s44 offen offset:768 sc1
    s_waitcnt vmcnt(23)
    v_mfma_f32_32x32x16_bf16 v[64:79], a[52:55], v[172:175], v[64:79]
    ds_read_b128 v[168:171], v2 offset:48128
    s_add_u32 s70, s70, 4096
    buffer_load_dwordx4 a[96:99], v2, s[4:7], s70 offen offset:0 sc1
    v_mfma_f32_32x32x16_bf16 v[80:95], a[52:55], v[176:179], v[80:95]
    s_waitcnt vmcnt(20)
    s_barrier
    ds_read_b128 v[172:175], v2 offset:49152
    s_mul_i32 s56, s41, 256
    s_add_u32 s56, s56, s18
    s_add_u32 s56, s56, 262144
    s_mov_b32 s63, 0
    s_atomic_add s63, s[12:13], s56 glc
    v_mfma_f32_32x32x16_bf16 v[96:111], a[52:55], v[180:183], v[96:111]
    ds_read_b128 v[176:179], v2 offset:50176
    s_add_u32 s70, s70, 12288
    s_xor_b32 s70, s70, 8192
    buffer_load_dwordx4 a[100:103], v2, s[4:7], s70 offen offset:0 sc1
    v_mfma_f32_32x32x16_bf16 v[64:79], a[56:59], v[184:187], v[64:79]
    ds_read_b128 v[180:183], v2 offset:51200
    buffer_load_dwordx4 a[104:107], v2, s[4:7], s70 offen offset:1024 sc1
    v_mfma_f32_32x32x16_bf16 v[80:95], a[56:59], v[188:191], v[80:95]
    ds_read_b128 v[184:187], v2 offset:52224
    ds_read_b128 a[160:163], v3 offset:49152
    v_mfma_f32_32x32x16_bf16 v[96:111], a[56:59], v[192:195], v[96:111]
    ds_read_b128 v[188:191], v2 offset:53248
    buffer_load_dwordx4 a[108:111], v2, s[4:7], s70 offen offset:2048 sc1
    s_waitcnt vmcnt(22) lgkmcnt(6)
    v_mfma_f32_32x32x16_bf16 v[64:79], a[60:63], v[160:163], v[64:79]
    ds_read_b128 v[192:195], v2 offset:54272
    buffer_load_dwordx4 a[112:115], v2, s[4:7], s70 offen offset:3072 sc1
    v_mfma_f32_32x32x16_bf16 v[80:95], a[60:63], v[164:167], v[80:95]
    ds_read_b128 v[160:163], v2 offset:55296
    v_mfma_f32_32x32x16_bf16 v[96:111], a[60:63], v[168:171], v[96:111]
    ds_read_b128 v[164:167], v2 offset:56320
    ds_read_b128 a[164:167], v3 offset:53248
    s_add_u32 s70, s70, 4096
    buffer_load_dwordx4 a[116:119], v2, s[4:7], s70 offen offset:0 sc1
    s_waitcnt vmcnt(23) lgkmcnt(7)
    v_mfma_f32_32x32x16_bf16 v[64:79], a[64:67], v[172:175], v[64:79]
    ds_read_b128 v[168:171], v2 offset:57344
    v_mfma_f32_32x32x16_bf16 v[80:95], a[64:67], v[176:179], v[80:95]
    ds_read_b128 v[172:175], v2 offset:58368
    s_add_u32 m0, s85, 86016
    s_add_u32 s59, s20, 86016
    buffer_load_dwordx4 v197, s[4:7], s59 offen offset:0 sc1 lds
    v_mfma_f32_32x32x16_bf16 v[96:111], a[64:67], v[180:183], v[96:111]
    ds_read_b128 v[176:179], v2 offset:59392
    buffer_load_dwordx4 v197, s[4:7], s59 offen offset:1024 sc1 lds
    v_mov_b32 v252, 0
    v_mov_b32 v253, 0
    v_mov_b32 v254, 0
    s_waitcnt vmcnt(24) lgkmcnt(6)
    v_mfma_f32_32x32x16_bf16 v[64:79], a[68:71], v[184:187], v[64:79]
    ds_read_b128 v[180:183], v2 offset:60416
    ds_read_b128 a[168:171], v3 offset:57344
    v_mov_b32 v255, 0
    v_mfma_f32_32x32x16_bf16 v[80:95], a[68:71], v[188:191], v[80:95]
    s_waitcnt vmcnt(20)
    s_barrier
    ds_read_b128 v[184:187], v2 offset:61440
    buffer_load_dwordx4 v197, s[4:7], s59 offen offset:2048 sc1 lds
Lpoll_41:
    s_mov_b32 s55, 0
Lpoll_41_l:
    s_waitcnt lgkmcnt(0)
    s_bfe_u32 s63, s63, 524296
    s_cmp_ge_u32 s63, 60
    s_cbranch_scc1 Lok_42
    s_mov_b32 s63, 0
    s_atomic_add s63, s[12:13], s56 glc
    s_add_u32 s55, s55, 1
    s_cmp_lt_u32 s55, 400000
    s_cbranch_scc1 Lpoll_41_l
    s_waitcnt lgkmcnt(0)
Lok_42:
    v_mfma_f32_32x32x16_bf16 v[96:111], a[68:71], v[192:195], v[96:111]
    ds_read_b128 v[188:191], v2 offset:62464
    s_add_u32 s70, s70, 12288
    s_xor_b32 s70, s70, 8192
    buffer_load_dwordx4 a[120:123], v2, s[4:7], s70 offen offset:0 sc1
    v_mfma_f32_32x32x16_bf16 v[64:79], a[72:75], v[160:163], v[64:79]
    ds_read_b128 v[192:195], v2 offset:63488
    s_mul_i32 s56, s83, 256
    s_add_u32 s56, s56, s18
    s_add_u32 s56, s56, 278528
    s_mov_b32 s63, 0
    s_atomic_add s63, s[12:13], s56 glc
    v_mfma_f32_32x32x16_bf16 v[80:95], a[72:75], v[164:167], v[80:95]
    ds_read_b128 v[160:163], v2 offset:64512
    ds_read_b128 a[172:175], v3 offset:61440
    buffer_load_dwordx4 a[124:127], v2, s[4:7], s70 offen offset:1024 sc1
    v_mfma_f32_32x32x16_bf16 v[96:111], a[72:75], v[168:171], v[96:111]
    ds_read_b128 v[164:167], v4 offset:0
    s_waitcnt vmcnt(22)
    v_mfma_f32_32x32x16_bf16 v[64:79], a[76:79], v[172:175], v[64:79]
    ds_read_b128 v[168:171], v4 offset:1024
    buffer_load_dwordx4 a[128:131], v2, s[4:7], s70 offen offset:2048 sc1
    v_mfma_f32_32x32x16_bf16 v[80:95], a[76:79], v[176:179], v[80:95]
    ds_read_b128 v[172:175], v4 offset:2048
    buffer_load_dwordx4 a[132:135], v2, s[4:7], s70 offen offset:3072 sc1
    v_mfma_f32_32x32x16_bf16 v[96:111], a[76:79], v[180:183], v[96:111]
    ds_read_b128 v[176:179], v4 offset:3072
    ds_read_b128 a[176:179], v199 offset:0
    s_waitcnt vmcnt(22) lgkmcnt(6)
    v_mfma_f32_32x32x16_bf16 v[64:79], a[80:83], v[184:187], v[64:79]
    ds_read_b128 v[180:183], v4 offset:4096
    s_add_u32 s70, s70, 4096
    buffer_load_dwordx4 a[136:139], v2, s[4:7], s70 offen offset:0 sc1
    v_mfma_f32_32x32x16_bf16 v[80:95], a[80:83], v[188:191], v[80:95]
    ds_read_b128 v[184:187], v4 offset:5120
    s_add_u32 s70, s70, 12288
    s_xor_b32 s70, s70, 8192
    buffer_load_dwordx4 a[140:143], v2, s[4:7], s70 offen offset:0 sc1
    v_mfma_f32_32x32x16_bf16 v[64:79], a[84:87], v[192:195], v[64:79]
    ds_read_b128 v[188:191], v4 offset:6144
    s_waitcnt vmcnt(15)
    v_add_f32 v248, v56, v58
    v_add_f32 v249, v60, v62
    v_add_f32 v248, v248, v249
    v_mfma_f32_32x32x16_bf16 v[80:95], a[84:87], v[160:163], v[80:95]
    ds_read_b128 v[192:195], v4 offset:7168
    ds_read_b128 a[180:183], v199 offset:4096
    s_add_u32 m0, s85, 98304
    s_add_u32 s59, s20, 98304
    buffer_load_dwordx4 v197, s[4:7], s59 offen offset:0 sc1 lds
    v_mov_b32 v249, v248
    s_nop 1
    v_permlane32_swap_b32 v248, v249
    v_add_f32 v248, v248, v249
    v_mul_f32 v248, 3187671040, v248
    s_waitcnt lgkmcnt(6)
    v_mfma_f32_32x32x16_bf16 v[64:79], a[88:91], v[164:167], v[64:79]
    s_barrier
    ds_read_b128 v[160:163], v4 offset:8192
    buffer_load_dwordx4 v197, s[4:7], s59 offen offset:1024 sc1 lds
    v_add_f32 v249, v56, v248
    v_mul_f32 v249, v249, v249
    v_fmac_f32 v57, 1117782016, v249
    v_mfma_f32_32x32x16_bf16 v[80:95], a[88:91], v[168:171], v[80:95]
    ds_read_b128 v[164:167], v4 offset:9216
    buffer_load_dwordx4 v197, s[4:7], s59 offen offset:2048 sc1 lds
    v_add_f32 v249, v58, v248
    v_mul_f32 v249, v249, v249
    v_fmac_f32 v59, 1117782016, v249
    v_add_f32 v249, v60, v248
    v_mfma_f32_32x32x16_bf16 v[64:79], a[92:95], v[172:175], v[64:79]
    ds_read_b128 v[168:171], v4 offset:10240
    buffer_load_dwordx4 a[144:147], v2, s[4:7], s70 offen offset:1024 sc1
Lpoll_43:
    s_mov_b32 s55, 0
Lpoll_43_l:
    s_waitcnt lgkmcnt(0)
    s_bfe_u32 s63, s63, 524288
    s_cmp_ge_u32 s63, 20
    s_cbranch_scc1 Lok_44
    s_mov_b32 s63, 0
    s_atomic_add s63, s[12:13], s56 glc
    s_add_u32 s55, s55, 1
    s_cmp_lt_u32 s55, 400000
    s_cbranch_scc1 Lpoll_43_l
    s_waitcnt lgkmcnt(0)
Lok_44:
    ds_write_b128 v3, v[252:255] offset:21632
    v_mfma_f32_32x32x16_bf16 v[80:95], a[92:95], v[176:179], v[80:95]
    ds_read_b128 v[172:175], v4 offset:11264
    ds_read_b128 a[184:187], v199 offset:8192
    v_mul_f32 v249, v249, v249
    v_fmac_f32 v61, 1117782016, v249
    v_add_f32 v249, v62, v248
    v_mul_f32 v249, v249, v249
    s_waitcnt vmcnt(17)
    v_mfma_f32_32x32x16_bf16 v[64:79], a[96:99], v[180:183], v[64:79]
    ds_read_b128 v[176:179], v4 offset:12288
    buffer_load_dwordx4 a[148:151], v2, s[4:7], s70 offen offset:2048 sc1
    s_mul_i32 s56, s41, 256
    s_add_u32 s56, s56, s18
    s_add_u32 s56, s56, 294912
    s_mov_b32 s63, 0
    s_atomic_add s63, s[12:13], s56 glc
    ds_write_b128 v3, v[252:255] offset:22656
    v_mfma_f32_32x32x16_bf16 v[80:95], a[96:99], v[184:187], v[80:95]
    ds_read_b128 v[180:183], v4 offset:13312
    v_fmac_f32 v63, 1117782016, v249
    v_add_f32 v249, v57, v59
    v_add_f32 v250, v61, v63
    v_add_f32 v249, v249, v250
    v_mfma_f32_32x32x16_bf16 v[64:79], a[100:103], v[188:191], v[64:79]
    ds_read_b128 v[184:187], v4 offset:14336
    buffer_load_dwordx4 a[152:155], v2, s[4:7], s70 offen offset:3072 sc1
    v_mov_b32 v250, v249
    s_nop 1
    v_permlane32_swap_b32 v249, v250
    v_add_f32 v249, v249, v250
    v_mfma_f32_32x32x16_bf16 v[80:95], a[100:103], v[192:195], v[80:95]
    ds_read_b128 v[188:191], v4 offset:15360
    ds_read_b128 a[188:191], v199 offset:12288
    v_mov_b32 v250, 925353388
    v_fmac_f32 v250, 986500301, v249
    v_rsq_f32 v56, v250
    v_cvt_pk_bf16_f32 v249, v248, v248
    s_waitcnt vmcnt(17) lgkmcnt(7)
    v_mfma_f32_32x32x16_bf16 v[64:79], a[104:107], v[160:163], v[64:79]
    ds_read_b128 v[192:195], v4 offset:16384
    s_add_u32 s70, s70, 4096
    buffer_load_dwordx4 a[156:159], v2, s[4:7], s70 offen offset:0 sc1
    v_and_b32 v249, 0xffff0000, v249
    v_sub_f32 v249, v248, v249
    v_cvt_pk_bf16_f32 v52, v248, v249
    v_mfma_f32_32x32x16_bf16 v[80:95], a[104:107], v[164:167], v[80:95]
    ds_read_b128 v[160:163], v4 offset:17408
    v_mov_b32 v53, v52
    v_mov_b32 v54, v52
    v_mov_b32 v55, v52
    v_mul_f32 v248, 1069066811, v56
    v_mfma_f32_32x32x16_bf16 v[64:79], a[108:111], v[168:171], v[64:79]
    ds_read_b128 v[164:167], v4 offset:18432
    s_add_u32 m0, s85, 110592
    s_add_u32 s59, s20, 110592
    buffer_load_dwordx4 v197, s[4:7], s59 offen offset:0 sc1 lds
    v_cndmask_b32 v248, v248, v56, s[96:97]
    ds_write_b32 v27, v248
    ds_read_b128 v[208:211], v28 offset:0
    ds_read_b128 v[224:227], v28 offset:128
    v_mfma_f32_32x32x16_bf16 v[80:95], a[108:111], v[172:175], v[80:95]
    ds_read_b128 v[168:171], v4 offset:19456
    ds_read_b128 a[192:195], v199 offset:16384
    ds_read_b128 v[212:215], v28 offset:32
    ds_read_b128 v[228:231], v28 offset:160
    ds_read_b128 v[216:219], v28 offset:64
    ds_read_b128 v[232:235], v28 offset:192
    s_waitcnt vmcnt(17) lgkmcnt(13)
    v_mfma_f32_32x32x16_bf16 v[64:79], a[112:115], v[176:179], v[64:79]
    s_waitcnt vmcnt(14)
    s_barrier
    ds_read_b128 v[172:175], v4 offset:20480
    buffer_load_dwordx4 v197, s[4:7], s59 offen offset:1024 sc1 lds
    ds_read_b128 v[220:223], v28 offset:96
    ds_read_b128 v[236:239], v28 offset:224
    v_mfma_f32_32x32x16_bf16 v[80:95], a[112:115], v[180:183], v[80:95]
    ds_read_b128 v[176:179], v4 offset:21504
    buffer_load_dwordx4 v197, s[4:7], s59 offen offset:2048 sc1 lds
    v_mfma_f32_32x32x16_bf16 v[64:79], a[116:119], v[184:187], v[64:79]
    ds_read_b128 v[180:183], v4 offset:22528
    v_mfma_f32_32x32x16_bf16 v[80:95], a[116:119], v[188:191], v[80:95]
    ds_read_b128 v[184:187], v4 offset:23552
    ds_read_b128 a[196:199], v199 offset:20480
    s_add_u32 m0, s85, 122880
    s_add_u32 s59, s20, 122880
    buffer_load_dwordx4 v197, s[4:7], s59 offen offset:0 sc1 lds
    s_waitcnt vmcnt(15) lgkmcnt(12)
    v_mfma_f32_32x32x16_bf16 v[64:79], a[120:123], v[192:195], v[64:79]
    ds_read_b128 v[188:191], v4 offset:24576
    buffer_load_dwordx4 v197, s[4:7], s59 offen offset:1024 sc1 lds
Lpoll_45:
    s_mov_b32 s55, 0
Lpoll_45_l:
    s_waitcnt lgkmcnt(0)
    s_bfe_u32 s63, s63, 524288
    s_cmp_ge_u32 s63, 48
    s_cbranch_scc1 Lok_46
    s_mov_b32 s63, 0
    s_atomic_add s63, s[12:13], s56 glc
    s_add_u32 s55, s55, 1
    s_cmp_lt_u32 s55, 400000
    s_cbranch_scc1 Lpoll_45_l
    s_waitcnt lgkmcnt(0)
Lok_46:
    v_mfma_f32_32x32x16_bf16 v[80:95], a[120:123], v[160:163], v[80:95]
    ds_read_b128 v[192:195], v4 offset:25600
    v_mfma_f32_32x32x16_bf16 v[64:79], a[124:127], v[164:167], v[64:79]
    ds_read_b128 v[160:163], v4 offset:26624
    buffer_load_dwordx4 v197, s[4:7], s59 offen offset:2048 sc1 lds
    s_mul_i32 s56, s83, 256
    s_add_u32 s56, s56, s18
    s_add_u32 s56, s56, 311296
    s_mov_b32 s63, 0
    s_atomic_add s63, s[12:13], s56 glc
    v_mfma_f32_32x32x16_bf16 v[80:95], a[124:127], v[168:171], v[80:95]
    ds_read_b128 v[164:167], v4 offset:27648
    ds_read_b128 a[200:203], v199 offset:24576
    s_waitcnt vmcnt(15)
    v_mfma_f32_32x32x16_bf16 v[64:79], a[128:131], v[172:175], v[64:79]
    ds_read_b128 v[168:171], v4 offset:28672
    s_add_u32 m0, s85, 135168
    s_add_u32 s59, s20, 135168
    buffer_load_dwordx4 v197, s[4:7], s59 offen offset:0 sc1 lds
    v_mfma_f32_32x32x16_bf16 v[80:95], a[128:131], v[176:179], v[80:95]
    ds_read_b128 v[172:175], v4 offset:29696
    buffer_load_dwordx4 v197, s[4:7], s59 offen offset:1024 sc1 lds
    v_mfma_f32_32x32x16_bf16 v[64:79], a[132:135], v[180:183], v[64:79]
    ds_read_b128 v[176:179], v4 offset:30720
    v_mfma_f32_32x32x16_bf16 v[80:95], a[132:135], v[184:187], v[80:95]
    ds_read_b128 v[180:183], v4 offset:31744
    ds_read_b128 a[204:207], v199 offset:28672
    buffer_load_dwordx4 v197, s[4:7], s59 offen offset:2048 sc1 lds
    s_waitcnt vmcnt(16) lgkmcnt(6)
    v_mfma_f32_32x32x16_bf16 v[64:79], a[136:139], v[188:191], v[64:79]
    s_waitcnt vmcnt(13)
    s_barrier
    ds_read_b128 v[184:187], v4 offset:32768
    s_add_u32 m0, s85, 147456
    s_add_u32 s59, s20, 147456
    buffer_load_dwordx4 v197, s[4:7], s59 offen offset:0 sc1 lds
    v_mfma_f32_32x32x16_bf16 v[80:95], a[136:139], v[192:195], v[80:95]
    ds_read_b128 v[188:191], v4 offset:33792
    v_mfma_f32_32x32x16_bf16 v[64:79], a[140:143], v[160:163], v[64:79]
    ds_read_b128 v[192:195], v4 offset:34816
    buffer_load_dwordx4 v197, s[4:7], s59 offen offset:1024 sc1 lds
    v_mfma_f32_32x32x16_bf16 v[80:95], a[140:143], v[164:167], v[80:95]
    ds_read_b128 v[160:163], v4 offset:35840
    ds_read_b128 a[208:211], v199 offset:32768
    s_waitcnt vmcnt(13) lgkmcnt(6)
    v_mfma_f32_32x32x16_bf16 v[64:79], a[144:147], v[168:171], v[64:79]
    ds_read_b128 v[164:167], v4 offset:36864
    buffer_load_dwordx4 v197, s[4:7], s59 offen offset:2048 sc1 lds
    v_mfma_f32_32x32x16_bf16 v[80:95], a[144:147], v[172:175], v[80:95]
    ds_read_b128 v[168:171], v4 offset:37888
    s_add_u32 m0, s84, 0
    s_add_u32 s59, s20, 159744
    buffer_load_dwordx4 v196, s[4:7], s59 offen offset:0 sc1 lds
    v_mfma_f32_32x32x16_bf16 v[64:79], a[148:151], v[176:179], v[64:79]
    ds_read_b128 v[172:175], v4 offset:38912
Lpoll_47:
    s_mov_b32 s55, 0
Lpoll_47_l:
    s_waitcnt lgkmcnt(0)
    s_bfe_u32 s63, s63, 524288
    s_cmp_ge_u32 s63, 48
    s_cbranch_scc1 Lok_48
    s_mov_b32 s63, 0
    s_atomic_add s63, s[12:13], s56 glc
    s_add_u32 s55, s55, 1
    s_cmp_lt_u32 s55, 400000
    s_cbranch_scc1 Lpoll_47_l
    s_waitcnt lgkmcnt(0)
Lok_48:
    v_mfma_f32_32x32x16_bf16 v[80:95], a[148:151], v[180:183], v[80:95]
    ds_read_b128 v[176:179], v4 offset:39936
    ds_read_b128 a[212:215], v199 offset:36864
    buffer_load_dwordx4 v196, s[4:7], s59 offen offset:1024 sc1 lds
    s_waitcnt vmcnt(14)
    v_mfma_f32_32x32x16_bf16 v[64:79], a[152:155], v[184:187], v[64:79]
    ds_read_b128 v[180:183], v4 offset:40960
    s_add_u32 s44, s31, 12582912
    s_lshl_b32 s48, s83, 11
    s_and_b32 s48, s48, 8192
    s_xor_b32 s44, s44, s48
    buffer_load_dwordx4 v[128:131], v9, s[4:7], s44 offen sc1
    buffer_load_dwordx4 v[132:135], v9, s[4:7], s44 offen offset:2048 sc1
    buffer_load_dwordx2 v[136:137], v10, s[4:7], s44 offen sc1
    v_mfma_f32_32x32x16_bf16 v[80:95], a[152:155], v[188:191], v[80:95]
    ds_read_b128 v[184:187], v4 offset:41984
    s_load_dword s78, s[12:13], 128
    v_mfma_f32_32x32x16_bf16 v[64:79], a[156:159], v[192:195], v[64:79]
    ds_read_b128 v[188:191], v4 offset:43008
    v_mfma_f32_32x32x16_bf16 v[80:95], a[156:159], v[160:163], v[80:95]
    ds_read_b128 v[192:195], v4 offset:44032
    ds_read_b128 a[216:219], v199 offset:40960
    s_waitcnt lgkmcnt(0)
    s_mov_b32 s99, 0
Lvw_49:
    s_and_b32 s98, s78, 0xff
    s_cmp_ge_u32 s98, 32
    s_cbranch_scc1 Lvo_50
    v_mov_b32 v203, 0
    global_load_dword v203, v203, s[12:13] offset:128 sc1
    s_waitcnt vmcnt(0)
    v_readfirstlane_b32 s78, v203
    s_add_u32 s99, s99, 1
    s_cmp_lt_u32 s99, 400000
    s_cbranch_scc1 Lvw_49
Lvo_50:
    s_lshr_b32 s78, s78, 8
    s_cmp_gt_u32 s78, 16
    s_cselect_b32 s78, 1, 0
    s_lshl_b32 s48, s78, 13
    s_xor_b32 s27, s27, s48
    s_xor_b32 s28, s28, s48
    s_xor_b32 s29, s29, s48
    s_xor_b32 s30, s30, s48
    s_xor_b32 s31, s31, s48
    s_xor_b32 s32, s32, s48
    s_xor_b32 s33, s33, s48
    s_xor_b32 s34, s34, s48
    s_xor_b32 s35, s35, s48
    s_xor_b32 s36, s36, s48
    s_lshl_b32 s48, s78, 5
    s_xor_b32 s24, s24, s48
    s_xor_b32 s26, s26, s48
    v_mfma_f32_32x32x16_bf16 v[64:79], v[52:55], v[164:167], v[64:79]
    s_waitcnt vmcnt(14)
    s_barrier
    ds_read_b128 v[160:163], v4 offset:45056
    v_mfma_f32_32x32x16_bf16 v[80:95], v[52:55], v[168:171], v[80:95]
    ds_read_b128 v[164:167], v4 offset:46080
    s_add_u32 s54, s17, s38
    s_mov_b64 exec, s[60:61]
    buffer_store_dwordx2 v[204:205], v201, s[4:7], s54 offen sc1
    s_mov_b64 exec, -1
    v_mfma_f32_32x32x16_bf16 v[96:111], a[80:83], v[172:175], v[96:111]
    ds_read_b128 v[168:171], v4 offset:47104
    v_mfma_f32_32x32x16_bf16 v[96:111], a[84:87], v[176:179], v[96:111]
    ds_read_b128 v[172:175], v4 offset:48128
    ds_read_b128 a[220:223], v199 offset:45056
    v_mul_f32 v112, v64, v224
    v_mul_f32 v113, v65, v225
    v_mul_f32 v114, v66, v226
    v_mul_f32 v115, v67, v227
    v_mul_f32 v116, v68, v228
    v_mfma_f32_32x32x16_bf16 v[96:111], a[88:91], v[180:183], v[96:111]
    ds_read_b128 v[176:179], v4 offset:49152
    v_exp_f32 v112, v112 clamp
    v_fma_f32 v64, v64, v208, s76
    v_fma_f32 v65, v65, v209, s76
    v_mfma_f32_32x32x16_bf16 v[96:111], a[92:95], v[184:187], v[96:111]
    ds_read_b128 v[180:183], v4 offset:50176
    s_add_u32 s54, s17, s33
    buffer_store_dwordx4 v[204:207], v7, s[4:7], s54 offen sc1
    v_max_f32 v64, s76, v64
    v_mfma_f32_32x32x16_bf16 v[96:111], a[96:99], v[188:191], v[96:111]
    ds_read_b128 v[184:187], v4 offset:51200
    v_add_f32 v64, v64, v112
    v_exp_f32 v113, v113 clamp
    v_max_f32 v65, s76, v65
    v_fma_f32 v66, v66, v210, s76
    v_mfma_f32_32x32x16_bf16 v[96:111], a[100:103], v[192:195], v[96:111]
    ds_read_b128 v[188:191], v4 offset:52224
    ds_read_b128 a[224:227], v199 offset:49152
    v_add_f32 v65, v65, v113
    v_exp_f32 v114, v114 clamp
    v_max_f32 v66, s76, v66
    s_waitcnt lgkmcnt(7)
    v_mfma_f32_32x32x16_bf16 v[96:111], a[104:107], v[160:163], v[96:111]
    ds_read_b128 v[192:195], v4 offset:53248
    s_mov_b32 exec_hi, 0
    buffer_store_dwordx4 v[204:207], v7, s[4:7], s54 offen offset:512 sc1
    s_mov_b64 exec, -1
    v_cvt_pk_bf16_f32 v144, v64, v65
    v_mfma_f32_32x32x16_bf16 v[96:111], a[108:111], v[164:167], v[96:111]
    ds_read_b128 v[160:163], v4 offset:54272
    v_add_f32 v66, v66, v114
    v_exp_f32 v115, v115 clamp
    v_fma_f32 v67, v67, v211, s76
    v_fma_f32 v68, v68, v212, s76
    v_mfma_f32_32x32x16_bf16 v[96:111], a[112:115], v[168:171], v[96:111]
    ds_read_b128 v[164:167], v4 offset:55296
    v_max_f32 v67, s76, v67
    v_exp_f32 v116, v116 clamp
    v_max_f32 v68, s76, v68
    s_waitcnt lgkmcnt(6)
    v_mfma_f32_32x32x16_bf16 v[96:111], a[116:119], v[172:175], v[96:111]
    ds_read_b128 v[168:171], v4 offset:56320
    ds_read_b128 a[228:231], v199 offset:53248
    buffer_store_dwordx4 v[204:207], v7, s[4:7], s54 offen offset:768 sc1
    v_add_f32 v67, v67, v115
    v_mfma_f32_32x32x16_bf16 v[96:111], a[120:123], v[176:179], v[96:111]
    s_waitcnt vmcnt(15)
    s_barrier
    ds_read_b128 v[172:175], v4 offset:57344
    v_cvt_pk_bf16_f32 v145, v66, v67
    v_add_f32 v68, v68, v116
    v_mul_f32 v117, v69, v229
    v_mfma_f32_32x32x16_bf16 v[96:111], a[124:127], v[180:183], v[96:111]
    ds_read_b128 v[176:179], v4 offset:58368
    v_exp_f32 v117, v117 clamp
    v_fma_f32 v69, v69, v213, s76
    v_mul_f32 v118, v70, v230
    s_waitcnt lgkmcnt(6)
    v_mfma_f32_32x32x16_bf16 v[96:111], a[128:131], v[184:187], v[96:111]
    ds_read_b128 v[180:183], v4 offset:59392
    ds_read_b128 a[232:235], v199 offset:57344
    v_max_f32 v69, s76, v69
    v_exp_f32 v118, v118 clamp
    v_fma_f32 v70, v70, v214, s76
    v_mul_f32 v119, v71, v231
    v_mfma_f32_32x32x16_bf16 v[96:111], a[132:135], v[188:191], v[96:111]
    v_add_f32 v69, v69, v117
    v_max_f32 v70, s76, v70
    v_exp_f32 v119, v119 clamp
    v_fma_f32 v71, v71, v215, s76
    v_mul_f32 v112, v72, v232
    v_mfma_f32_32x32x16_bf16 v[96:111], a[136:139], v[192:195], v[96:111]
    v_cvt_pk_bf16_f32 v146, v68, v69
    v_add_f32 v70, v70, v118
    v_max_f32 v71, s76, v71
    v_exp_f32 v112, v112 clamp
    s_waitcnt lgkmcnt(5)
    v_mfma_f32_32x32x16_bf16 v[96:111], a[140:143], v[160:163], v[96:111]
    v_add_f32 v71, v71, v119
    v_fma_f32 v72, v72, v216, s76
    v_mul_f32 v113, v73, v233
    v_mul_f32 v114, v74, v234
    v_mul_f32 v115, v75, v235
    v_mul_f32 v116, v76, v236
    v_mfma_f32_32x32x16_bf16 v[96:111], a[144:147], v[164:167], v[96:111]
    v_cvt_pk_bf16_f32 v147, v70, v71
    v_max_f32 v72, s76, v72
    v_exp_f32 v113, v113 clamp
    v_fma_f32 v73, v73, v217, s76
    v_fma_f32 v74, v74, v218, s76
    v_mfma_f32_32x32x16_bf16 v[96:111], a[148:151], v[168:171], v[96:111]
    v_add_f32 v72, v72, v112
    v_max_f32 v73, s76, v73
    v_exp_f32 v114, v114 clamp
    v_max_f32 v74, s76, v74
    s_waitcnt lgkmcnt(1)
    v_mfma_f32_32x32x16_bf16 v[96:111], a[152:155], v[172:175], v[96:111]
    v_add_f32 v73, v73, v113
    v_add_f32 v74, v74, v114
    v_exp_f32 v115, v115 clamp
    v_fma_f32 v75, v75, v219, s76
    v_fma_f32 v76, v76, v220, s76
    v_mfma_f32_32x32x16_bf16 v[96:111], a[156:159], v[176:179], v[96:111]
    v_cvt_pk_bf16_f32 v148, v72, v73
    v_max_f32 v75, s76, v75
    v_exp_f32 v116, v116 clamp
    v_max_f32 v76, s76, v76
    v_mul_f32 v117, v77, v237
    v_mfma_f32_32x32x16_bf16 v[96:111], v[52:55], v[180:183], v[96:111]
    v_add_f32 v75, v75, v115
    v_add_f32 v76, v76, v116
    v_exp_f32 v117, v117 clamp
    v_fma_f32 v77, v77, v221, s76
    v_mul_f32 v118, v78, v238
    v_cvt_pk_bf16_f32 v149, v74, v75
    v_max_f32 v77, s76, v77
    v_exp_f32 v118, v118 clamp
    v_fma_f32 v78, v78, v222, s76
    v_mul_f32 v119, v79, v239
    v_add_f32 v77, v77, v117
    v_max_f32 v78, s76, v78
    v_exp_f32 v119, v119 clamp
    v_fma_f32 v79, v79, v223, s76
    v_cvt_pk_bf16_f32 v150, v76, v77
    v_add_f32 v78, v78, v118
    v_max_f32 v79, s76, v79
    v_add_f32 v79, v79, v119
    v_cvt_pk_bf16_f32 v151, v78, v79
    s_waitcnt vmcnt(4)
    v_lshlrev_b32 v32, 16, v128
    v_and_b32 v33, 0xffff0000, v128
    v_lshlrev_b32 v34, 16, v129
    v_and_b32 v35, 0xffff0000, v129
    v_lshlrev_b32 v36, 16, v130
    v_and_b32 v37, 0xffff0000, v130
    v_lshlrev_b32 v38, 16, v131
    v_and_b32 v39, 0xffff0000, v131
    v_lshlrev_b32 v40, 16, v132
    v_and_b32 v41, 0xffff0000, v132
    v_lshlrev_b32 v42, 16, v133
    v_and_b32 v43, 0xffff0000, v133
    v_lshlrev_b32 v44, 16, v134
    v_and_b32 v45, 0xffff0000, v134
    v_lshlrev_b32 v46, 16, v135
    v_and_b32 v47, 0xffff0000, v135
    v_lshlrev_b32 v48, 16, v136
    v_and_b32 v49, 0xffff0000, v136
    v_lshlrev_b32 v50, 16, v137
    v_and_b32 v51, 0xffff0000, v137
    v_pk_fma_f32 v[250:251], v[80:81], v[224:225], v[22:23] op_sel_hi:[1,1,0]
    s_add_u32 m0, s86, 36864
    s_add_u32 s59, s21, 0
    buffer_load_dwordx4 v198, s[4:7], s59 offen offset:0 sc1 lds
    v_pk_fma_f32 v[248:249], v[80:81], v[208:209], v[24:25] op_sel_hi:[1,1,0]
    v_exp_f32 v250, v250 clamp
    v_exp_f32 v251, v251 clamp
    v_max_f32 v248, v26, v248
    v_max_f32 v249, v26, v249
    v_pk_add_f32 v[248:249], v[248:249], v[250:251]
    v_cvt_pk_bf16_f32 v152, v248, v249
    v_pk_fma_f32 v[254:255], v[82:83], v[226:227], v[22:23] op_sel_hi:[1,1,0]
    v_pk_fma_f32 v[252:253], v[82:83], v[210:211], v[24:25] op_sel_hi:[1,1,0]
    v_exp_f32 v254, v254 clamp
    v_exp_f32 v255, v255 clamp
    v_max_f32 v252, v26, v252
    v_max_f32 v253, v26, v253
    v_pk_add_f32 v[252:253], v[252:253], v[254:255]
    buffer_load_dwordx4 v198, s[4:7], s59 offen offset:1024 sc1 lds
    v_cvt_pk_bf16_f32 v153, v252, v253
    v_pk_fma_f32 v[250:251], v[84:85], v[228:229], v[22:23] op_sel_hi:[1,1,0]
    v_pk_fma_f32 v[248:249], v[84:85], v[212:213], v[24:25] op_sel_hi:[1,1,0]
    v_exp_f32 v250, v250 clamp
    v_exp_f32 v251, v251 clamp
    v_max_f32 v248, v26, v248
    v_max_f32 v249, v26, v249
    v_pk_add_f32 v[248:249], v[248:249], v[250:251]
    v_cvt_pk_bf16_f32 v154, v248, v249
    v_pk_fma_f32 v[254:255], v[86:87], v[230:231], v[22:23] op_sel_hi:[1,1,0]
    v_pk_fma_f32 v[252:253], v[86:87], v[214:215], v[24:25] op_sel_hi:[1,1,0]
    v_exp_f32 v254, v254 clamp
    v_exp_f32 v255, v255 clamp
    v_max_f32 v252, v26, v252
    buffer_load_dwordx4 v198, s[4:7], s59 offen offset:2048 sc1 lds
    v_max_f32 v253, v26, v253
    v_pk_add_f32 v[252:253], v[252:253], v[254:255]
    v_cvt_pk_bf16_f32 v155, v252, v253
    v_pk_fma_f32 v[250:251], v[88:89], v[232:233], v[22:23] op_sel_hi:[1,1,0]
    v_pk_fma_f32 v[248:249], v[88:89], v[216:217], v[24:25] op_sel_hi:[1,1,0]
    v_exp_f32 v250, v250 clamp
    v_exp_f32 v251, v251 clamp
    v_max_f32 v248, v26, v248
    v_max_f32 v249, v26, v249
    v_pk_add_f32 v[248:249], v[248:249], v[250:251]
    v_cvt_pk_bf16_f32 v156, v248, v249
    v_pk_fma_f32 v[254:255], v[90:91], v[234:235], v[22:23] op_sel_hi:[1,1,0]
    v_pk_fma_f32 v[252:253], v[90:91], v[218:219], v[24:25] op_sel_hi:[1,1,0]
    v_exp_f32 v254, v254 clamp
    buffer_load_dwordx4 v198, s[4:7], s59 offen offset:3072 sc1 lds
    v_exp_f32 v255, v255 clamp
    v_max_f32 v252, v26, v252
    v_max_f32 v253, v26, v253
    v_pk_add_f32 v[252:253], v[252:253], v[254:255]
    v_cvt_pk_bf16_f32 v157, v252, v253
    v_pk_fma_f32 v[250:251], v[92:93], v[236:237], v[22:23] op_sel_hi:[1,1,0]
    v_pk_fma_f32 v[248:249], v[92:93], v[220:221], v[24:25] op_sel_hi:[1,1,0]
    v_exp_f32 v250, v250 clamp
    v_exp_f32 v251, v251 clamp
    v_max_f32 v248, v26, v248
    v_max_f32 v249, v26, v249
    v_pk_add_f32 v[248:249], v[248:249], v[250:251]
    v_cvt_pk_bf16_f32 v158, v248, v249
    v_pk_fma_f32 v[254:255], v[94:95], v[238:239], v[22:23] op_sel_hi:[1,1,0]
    s_add_u32 m0, s86, 53248
    s_add_u32 s59, s21, 16384
    buffer_load_dwordx4 v198, s[4:7], s59 offen offset:0 sc1 lds
    v_pk_fma_f32 v[252:253], v[94:95], v[222:223], v[24:25] op_sel_hi:[1,1,0]
    v_exp_f32 v254, v254 clamp
    v_exp_f32 v255, v255 clamp
    v_max_f32 v252, v26, v252
    v_max_f32 v253, v26, v253
Lw_1:
    s_cbranch_execz Lw_2
    v_pk_add_f32 v[252:253], v[252:253], v[254:255]
    v_cvt_pk_bf16_f32 v159, v252, v253
    s_mov_b32 exec_lo, 0xff000000
    s_mov_b32 exec_hi, 0xff000000
    v_mov_b32 v152, 0x3f803f80
    v_mov_b32 v153, 0x3f803f80
    v_mov_b32 v154, 0x3f803f80
    v_mov_b32 v155, 0x3f803f80
    v_mov_b32 v156, 0x3f803f80
    v_mov_b32 v157, 0x3f803f80
    v_mov_b32 v158, 0x3f803f80
    v_mov_b32 v159, 0x3f803f80
    s_mov_b64 exec, -1
    v_mfma_f32_32x32x16_bf16 v[64:79], v[144:147], v[152:155], 0
    v_mul_f32 v96, v96, v208
    v_mul_f32 v97, v97, v209
    v_mul_f32 v98, v98, v210
    v_mul_f32 v99, v99, v211
    v_cvt_pk_bf16_f32 v240, v96, v97
    v_cvt_pk_bf16_f32 v241, v98, v99
    v_mfma_f32_32x32x16_bf16 v[64:79], v[148:151], v[156:159], v[64:79]
    buffer_load_dwordx4 v198, s[4:7], s59 offen offset:1024 sc1 lds
    v_mul_f32 v100, v100, v212
    v_mul_f32 v101, v101, v213
    v_mul_f32 v102, v102, v214
    v_mul_f32 v103, v103, v215
    v_cvt_pk_bf16_f32 v242, v100, v101
    v_cvt_pk_bf16_f32 v243, v102, v103
    v_mfma_f32_32x32x16_bf16 v[128:143], v[152:155], v[152:155], 0
    v_mul_f32 v104, v104, v216
    v_mul_f32 v105, v105, v217
    v_mul_f32 v106, v106, v218
    v_mul_f32 v107, v107, v219
    v_cvt_pk_bf16_f32 v244, v104, v105
    v_cvt_pk_bf16_f32 v245, v106, v107
    v_mfma_f32_32x32x16_bf16 v[128:143], v[156:159], v[156:159], v[128:143]
    buffer_load_dwordx4 v198, s[4:7], s59 offen offset:2048 sc1 lds
    v_mul_f32 v108, v108, v220
    v_mul_f32 v109, v109, v221
    v_mul_f32 v110, v110, v222
    v_mul_f32 v111, v111, v223
    v_cvt_pk_bf16_f32 v246, v108, v109
    v_cvt_pk_bf16_f32 v247, v110, v111
    v_mfma_f32_32x32x16_bf16 v[80:95], v[144:147], v[240:243], 0
    buffer_load_dwordx4 v198, s[4:7], s59 offen offset:3072 sc1 lds
    s_mov_b32 exec_lo, 0x1000000
    s_mov_b32 exec_hi, 0x1000000
    ds_write_b128 v14, v[64:67] offset:0
    s_mov_b64 exec, -1
    v_mfma_f32_32x32x16_bf16 v[80:95], v[148:151], v[244:247], v[80:95]
    s_add_u32 m0, s86, 69632
    s_add_u32 s59, s21, 32768
    buffer_load_dwordx4 v198, s[4:7], s59 offen offset:0 sc1 lds
    s_mov_b32 exec_lo, 0x1000000
    s_mov_b32 exec_hi, 0x1000000
    ds_write_b128 v14, v[68:71] offset:32
    s_mov_b64 exec, -1
    v_mfma_f32_32x32x16_bf16 v[96:111], v[152:155], v[240:243], 0
    buffer_load_dwordx4 v198, s[4:7], s59 offen offset:1024 sc1 lds
    s_mov_b32 exec_lo, 0x1000000
    s_mov_b32 exec_hi, 0x100ff00
    ds_write_b128 v14, v[72:75] offset:64
    s_mov_b64 exec, -1
    v_mfma_f32_32x32x16_bf16 v[96:111], v[156:159], v[244:247], v[96:111]
    buffer_load_dwordx4 v198, s[4:7], s59 offen offset:2048 sc1 lds
    s_mov_b32 exec_lo, 0x100ff00
    s_mov_b32 exec_hi, 0x100ff00
    ds_write_b128 v14, v[76:79] offset:96
    s_mov_b32 exec_lo, 0x100ff00
    s_mov_b32 exec_hi, 0x100ff00
    ds_write_b128 v14, v[128:131] offset:128
    s_mov_b32 exec_lo, 0xfffff
    s_mov_b32 exec_hi, 0xfffff
    ds_write_b128 v13, v[80:83] offset:0
    s_mov_b32 exec_lo, 0xfffff
    s_mov_b32 exec_hi, 0xfffff
    ds_write_b128 v13, v[84:87] offset:32
    s_mov_b32 exec_lo, 0xfffff
    s_mov_b32 exec_hi, 0xfff00000
    ds_write_b128 v13, v[88:91] offset:64
    s_mov_b32 exec_lo, 0xfff00000
    s_mov_b32 exec_hi, 0xfff00000
    ds_write_b128 v13, v[92:95] offset:96
    s_mov_b32 exec_lo, 0xfff00000
    s_mov_b32 exec_hi, 0xfff00000
    ds_write_b128 v13, v[96:99] offset:128
    s_mov_b64 exec, -1
    s_waitcnt lgkmcnt(0)
    s_barrier
    ds_read_b128 v[64:67], v3 offset:8192
    ds_read_b128 v[68:71], v3 offset:11552
    ds_read_b128 v[72:75], v3 offset:14912
    ds_read_b128 v[76:79], v3 offset:18272
    s_add_u32 s44, s17, s38
    ds_read_b128 v[160:163], v4 offset:60416
    ds_read_b128 v[164:167], v4 offset:61440
    ds_read_b128 v[168:171], v4 offset:62464
    ds_read_b128 v[172:175], v4 offset:63488
    ds_read_b128 v[176:179], v4 offset:64512
    ds_read_b128 a[236:239], v199 offset:61440
    ds_read_b128 v[180:183], v5 offset:0
    ds_read_b128 v[184:187], v5 offset:1024
    ds_read_b128 v[188:191], v5 offset:2048
    s_waitcnt lgkmcnt(9)
    v_pk_add_f32 v[64:65], v[64:65], v[68:69]
    v_pk_add_f32 v[66:67], v[66:67], v[70:71]
    v_pk_add_f32 v[72:73], v[72:73], v[76:77]
    v_pk_add_f32 v[74:75], v[74:75], v[78:79]
    v_pk_add_f32 v[64:65], v[64:65], v[72:73]
    v_pk_add_f32 v[66:67], v[66:67], v[74:75]
    v_cvt_pk_bf16_f32 v68, v64, v65
    v_cvt_pk_bf16_f32 v69, v66, v67
    s_waitcnt vmcnt(14)
    s_mov_b64 exec, s[60:61]
    buffer_store_dwordx2 v[68:69], v201, s[4:7], s44 offen sc1
    s_mul_i32 s57, s41, 256
    s_add_u32 s57, s57, s18
    s_add_u32 s57, s57, 16384
    s_atomic_add s62, s[12:13], s57
    s_mov_b32 exec_lo, 0xff0000
    s_mov_b32 exec_hi, 0xff0000
    ds_write_b64 v19, v[152:153] offset:0
    ds_write_b64 v19, v[154:155] offset:16
    ds_write_b64 v19, v[156:157] offset:32
    ds_write_b64 v19, v[158:159] offset:48
    s_mov_b64 exec, -1
    s_waitcnt lgkmcnt(10)
    v_mfma_f32_32x32x16_bf16 v[112:127], a[0:3], v[160:163], 0
    ds_read_b128 v[192:195], v5 offset:3072
    ds_read_b128 a[240:243], v200 offset:0
    buffer_load_dwordx4 v198, s[4:7], s59 offen offset:3072 sc1 lds
    v_mfma_f32_32x32x16_bf16 v[112:127], a[4:7], v[164:167], v[112:127]
    ds_read_b128 v[160:163], v5 offset:4096
    v_mfma_f32_32x32x16_bf16 v[112:127], a[8:11], v[168:171], v[112:127]
    ds_read_b128 v[164:167], v5 offset:5120
    s_add_u32 s54, s17, s31
    s_add_u32 s54, s54, 4194304
    buffer_store_dwordx4 v[204:207], v9, s[4:7], s54 offen sc1
    s_waitcnt lgkmcnt(10)
    v_mfma_f32_32x32x16_bf16 v[112:127], a[12:15], v[172:175], v[112:127]
    ds_read_b128 v[168:171], v5 offset:6144
    v_mfma_f32_32x32x16_bf16 v[112:127], a[16:19], v[176:179], v[112:127]
    ds_read_b128 v[172:175], v5 offset:7168
    ds_read_b128 a[244:247], v200 offset:4096
    v_and_b32 v108, 1, v1
    v_mfma_f32_32x32x16_bf16 v[112:127], a[20:23], v[180:183], v[112:127]
    ds_read_b128 v[176:179], v5 offset:8192
    buffer_store_dwordx4 v[204:207], v9, s[4:7], s54 offen offset:2048 sc1
    s_waitcnt lgkmcnt(7)
    v_mfma_f32_32x32x16_bf16 v[112:127], a[24:27], v[184:187], v[112:127]
    ds_read_b128 v[180:183], v5 offset:9216
    v_lshlrev_b32 v108, 4, v108
    v_mfma_f32_32x32x16_bf16 v[112:127], a[28:31], v[188:191], v[112:127]
    ds_read_b128 v[184:187], v5 offset:10240
    v_mov_b32 v109, 0x3f80
    v_mfma_f32_32x32x16_bf16 v[112:127], a[32:35], v[192:195], v[112:127]
    ds_read_b128 v[188:191], v5 offset:11264
    ds_read_b128 a[248:251], v200 offset:8192
    s_mov_b32 exec_lo, 0xffff
    s_mov_b32 exec_hi, 0xffff
    buffer_store_dwordx4 v[204:207], v10, s[4:7], s54 offen sc1
    s_mov_b64 exec, -1
    s_waitcnt lgkmcnt(7)
    v_mfma_f32_32x32x16_bf16 v[112:127], a[36:39], v[160:163], v[112:127]
    ds_read_b128 v[192:195], v5 offset:12288
    v_lshlrev_b32 v108, v108, v109
    v_mfma_f32_32x32x16_bf16 v[112:127], a[40:43], v[164:167], v[112:127]
    ds_read_b128 v[160:163], v5 offset:13312
    s_add_u32 m0, s86, 86016
    s_add_u32 s59, s21, 49152
    buffer_load_dwordx4 v198, s[4:7], s59 offen offset:0 sc1 lds
    v_mfma_f32_32x32x16_bf16 v[112:127], a[44:47], v[168:171], v[112:127]
    ds_read_b128 v[164:167], v5 offset:14336
    v_bfe_u32 v109, v1, 1, 4
    s_waitcnt lgkmcnt(6)
    v_mfma_f32_32x32x16_bf16 v[112:127], a[48:51], v[172:175], v[112:127]
    ds_read_b128 v[168:171], v5 offset:15360
    ds_read_b128 a[252:255], v200 offset:12288
    buffer_load_dwordx4 v198, s[4:7], s59 offen offset:1024 sc1 lds
    v_cmp_eq_u32 vcc, 0, v109
    v_mfma_f32_32x32x16_bf16 v[112:127], a[52:55], v[176:179], v[112:127]
    ds_read_b128 v[172:175], v5 offset:16384
    v_cndmask_b32 v104, 0, v108, vcc
    v_mfma_f32_32x32x16_bf16 v[112:127], a[56:59], v[180:183], v[112:127]
    ds_read_b128 v[176:179], v5 offset:17408
    v_cmp_eq_u32 vcc, 1, v109
    s_waitcnt lgkmcnt(6)
    v_mfma_f32_32x32x16_bf16 v[112:127], a[60:63], v[184:187], v[112:127]
    ds_read_b128 v[180:183], v5 offset:18432
    buffer_load_dwordx4 v198, s[4:7], s59 offen offset:2048 sc1 lds
    v_cndmask_b32 v105, 0, v108, vcc
    v_mfma_f32_32x32x16_bf16 v[112:127], a[64:67], v[188:191], v[112:127]
    s_barrier
    ds_read_b128 v[184:187], v5 offset:19456
    v_cmp_eq_u32 vcc, 2, v109
    v_mfma_f32_32x32x16_bf16 v[112:127], a[68:71], v[192:195], v[112:127]
    ds_read_b128 v[188:191], v5 offset:20480
    buffer_load_dwordx4 v198, s[4:7], s59 offen offset:3072 sc1 lds
    v_cndmask_b32 v106, 0, v108, vcc
    s_waitcnt lgkmcnt(6)
    v_mfma_f32_32x32x16_bf16 v[112:127], a[72:75], v[160:163], v[112:127]
    ds_read_b128 v[192:195], v5 offset:21504
    s_mul_i32 s56, s41, 256
    s_add_u32 s56, s56, s18
    s_add_u32 s56, s56, 16384
    s_mov_b32 s63, 0
    s_atomic_add s63, s[12:13], s56 glc
    v_mfma_f32_32x32x16_bf16 v[112:127], a[76:79], v[164:167], v[112:127]
    ds_read_b128 v[160:163], v5 offset:22528
    v_cmp_eq_u32 vcc, 3, v109
    v_mfma_f32_32x32x16_bf16 v[112:127], a[80:83], v[168:171], v[112:127]
    ds_read_b128 v[164:167], v5 offset:23552
    s_add_u32 m0, s86, 102400
    s_add_u32 s59, s21, 65536
    buffer_load_dwordx4 v198, s[4:7], s59 offen offset:0 sc1 lds
    s_waitcnt lgkmcnt(5)
    v_mfma_f32_32x32x16_bf16 v[112:127], a[84:87], v[172:175], v[112:127]
    ds_read_b128 v[168:171], v5 offset:24576
    v_cndmask_b32 v107, 0, v108, vcc
    v_mfma_f32_32x32x16_bf16 v[112:127], a[88:91], v[176:179], v[112:127]
    ds_read_b128 v[172:175], v5 offset:25600
    buffer_load_dwordx4 v198, s[4:7], s59 offen offset:1024 sc1 lds
    v_mfma_f32_32x32x16_bf16 v[112:127], a[92:95], v[180:183], v[112:127]
    ds_read_b128 v[176:179], v5 offset:26624
    s_waitcnt lgkmcnt(5)
    v_mfma_f32_32x32x16_bf16 v[112:127], a[96:99], v[184:187], v[112:127]
    ds_read_b128 v[180:183], v5 offset:27648
    buffer_load_dwordx4 v198, s[4:7], s59 offen offset:2048 sc1 lds
    v_mfma_f32_32x32x16_bf16 v[112:127], a[100:103], v[188:191], v[112:127]
    ds_read_b128 v[184:187], v2 offset:0
    v_mfma_f32_32x32x16_bf16 v[112:127], a[104:107], v[192:195], v[112:127]
    ds_read_b128 v[188:191], v2 offset:1024
    s_waitcnt lgkmcnt(5)
    v_mfma_f32_32x32x16_bf16 v[112:127], a[108:111], v[160:163], v[112:127]
    ds_read_b128 v[192:195], v2 offset:2048
    buffer_load_dwordx4 v198, s[4:7], s59 offen offset:3072 sc1 lds
    v_mfma_f32_32x32x16_bf16 v[112:127], a[112:115], v[164:167], v[112:127]
    ds_read_b128 v[160:163], v2 offset:3072
    v_mfma_f32_32x32x16_bf16 v[112:127], a[116:119], v[168:171], v[112:127]
    ds_read_b128 v[164:167], v2 offset:4096
    s_add_u32 m0, s86, 118784
    s_add_u32 s59, s21, 81920
    buffer_load_dwordx4 v198, s[4:7], s59 offen offset:0 sc1 lds
    s_waitcnt lgkmcnt(5)
    v_mfma_f32_32x32x16_bf16 v[112:127], a[120:123], v[172:175], v[112:127]
    ds_read_b128 v[168:171], v2 offset:5120
    v_mfma_f32_32x32x16_bf16 v[112:127], a[124:127], v[176:179], v[112:127]
    ds_read_b128 v[172:175], v2 offset:6144
    v_mfma_f32_32x32x16_bf16 v[112:127], a[128:131], v[180:183], v[112:127]
    ds_read_b128 v[176:179], v2 offset:7168
    buffer_load_dwordx4 v198, s[4:7], s59 offen offset:1024 sc1 lds
    s_waitcnt lgkmcnt(5)
    v_mfma_f32_32x32x16_bf16 v[112:127], a[132:135], v[184:187], v[112:127]
    v_mfma_f32_32x32x16_bf16 v[112:127], a[136:139], v[188:191], v[112:127]
    buffer_load_dwordx4 v198, s[4:7], s59 offen offset:2048 sc1 lds
    v_mfma_f32_32x32x16_bf16 v[112:127], a[140:143], v[192:195], v[112:127]
    s_waitcnt lgkmcnt(2)
    v_mfma_f32_32x32x16_bf16 v[112:127], a[144:147], v[160:163], v[112:127]
    buffer_load_dwordx4 v198, s[4:7], s59 offen offset:3072 sc1 lds
    v_mfma_f32_32x32x16_bf16 v[112:127], a[148:151], v[164:167], v[112:127]
    v_mfma_f32_32x32x16_bf16 v[112:127], a[152:155], v[168:171], v[112:127]
    s_waitcnt lgkmcnt(0)
    v_mfma_f32_32x32x16_bf16 v[112:127], a[156:159], v[172:175], v[112:127]
    v_mfma_f32_32x32x16_bf16 v[112:127], v[52:55], v[176:179], v[112:127]
Lpoll_51:
    s_mov_b32 s55, 0
Lpoll_51_l:
    s_waitcnt lgkmcnt(0)
    s_bfe_u32 s63, s63, 524288
    s_cmp_ge_u32 s63, 16
    s_cbranch_scc1 Lok_52
    s_mov_b32 s63, 0
    s_atomic_add s63, s[12:13], s56 glc
    s_add_u32 s55, s55, 1
    s_cmp_lt_u32 s55, 400000
    s_cbranch_scc1 Lpoll_51_l
    s_waitcnt lgkmcnt(0)
Lok_52:
    s_add_u32 s44, s17, s39
    s_mov_b64 exec, s[88:89]
    buffer_load_dwordx4 v[72:75], v202, s[4:7], s44 offen sc1
    s_add_u32 s44, s44, 3584
    buffer_load_dwordx4 v[76:79], v202, s[4:7], s44 offen sc1
    s_add_u32 s44, s44, 3584
    buffer_load_dwordx4 v[80:83], v202, s[4:7], s44 offen sc1
    s_add_u32 s44, s44, 3584
    buffer_load_dwordx4 v[84:87], v202, s[4:7], s44 offen sc1
    s_add_u32 s44, s44, 3584
    buffer_load_dwordx4 v[88:91], v202, s[4:7], s44 offen sc1
    s_add_u32 s44, s44, 3584
    buffer_load_dwordx4 v[92:95], v202, s[4:7], s44 offen sc1
    s_add_u32 s44, s44, 3584
    buffer_load_dwordx4 v[96:99], v202, s[4:7], s44 offen sc1
    s_add_u32 s44, s44, 3584
    buffer_load_dwordx4 v[100:103], v202, s[4:7], s44 offen sc1
    s_mov_b64 exec, -1
    v_pk_mul_f32 v[250:251], v[112:113], v[224:225]
    v_pk_fma_f32 v[248:249], v[112:113], v[208:209], s[76:77]
    v_exp_f32 v250, v250 clamp
    v_exp_f32 v251, v251 clamp
    v_max_f32 v248, s76, v248
    v_max_f32 v249, s76, v249
    v_pk_add_f32 v[248:249], v[248:249], v[250:251]
    v_cvt_pk_bf16_f32 v144, v248, v249
    v_pk_mul_f32 v[254:255], v[114:115], v[226:227]
    v_pk_fma_f32 v[252:253], v[114:115], v[210:211], s[76:77]
    v_exp_f32 v254, v254 clamp
    v_exp_f32 v255, v255 clamp
    v_max_f32 v252, s76, v252
    s_add_u32 s58, s22, 77824
    buffer_load_dwordx4 a[80:83], v3, s[4:7], s58 offen sc1
    v_max_f32 v253, s76, v253
    v_pk_add_f32 v[252:253], v[252:253], v[254:255]
    v_cvt_pk_bf16_f32 v145, v252, v253
    v_pk_mul_f32 v[250:251], v[116:117], v[228:229]
    v_pk_fma_f32 v[248:249], v[116:117], v[212:213], s[76:77]
    v_exp_f32 v250, v250 clamp
    v_exp_f32 v251, v251 clamp
    v_max_f32 v248, s76, v248
    v_max_f32 v249, s76, v249
    v_pk_add_f32 v[248:249], v[248:249], v[250:251]
    v_cvt_pk_bf16_f32 v146, v248, v249
    v_pk_mul_f32 v[254:255], v[118:119], v[230:231]
    v_pk_fma_f32 v[252:253], v[118:119], v[214:215], s[76:77]
    v_exp_f32 v254, v254 clamp
    v_exp_f32 v255, v255 clamp
    v_max_f32 v252, s76, v252
    s_add_u32 s58, s22, 81920
    buffer_load_dwordx4 a[84:87], v3, s[4:7], s58 offen sc1
    v_max_f32 v253, s76, v253
    v_pk_add_f32 v[252:253], v[252:253], v[254:255]
    v_cvt_pk_bf16_f32 v147, v252, v253
    v_pk_mul_f32 v[250:251], v[120:121], v[232:233]
    v_pk_fma_f32 v[248:249], v[120:121], v[216:217], s[76:77]
    v_exp_f32 v250, v250 clamp
    v_exp_f32 v251, v251 clamp
    v_max_f32 v248, s76, v248
    v_max_f32 v249, s76, v249
    v_pk_add_f32 v[248:249], v[248:249], v[250:251]
    v_cvt_pk_bf16_f32 v148, v248, v249
    v_pk_mul_f32 v[254:255], v[122:123], v[234:235]
    v_pk_fma_f32 v[252:253], v[122:123], v[218:219], s[76:77]
    v_exp_f32 v254, v254 clamp
    v_exp_f32 v255, v255 clamp
    v_max_f32 v252, s76, v252
    s_add_u32 s58, s22, 86016
    buffer_load_dwordx4 a[88:91], v3, s[4:7], s58 offen sc1
    v_max_f32 v253, s76, v253
    v_pk_add_f32 v[252:253], v[252:253], v[254:255]
    v_cvt_pk_bf16_f32 v149, v252, v253
    v_pk_mul_f32 v[250:251], v[124:125], v[236:237]
    v_pk_fma_f32 v[248:249], v[124:125], v[220:221], s[76:77]
    v_exp_f32 v250, v250 clamp
    v_exp_f32 v251, v251 clamp
    v_max_f32 v248, s76, v248
    v_max_f32 v249, s76, v249
    v_pk_add_f32 v[248:249], v[248:249], v[250:251]
    v_cvt_pk_bf16_f32 v150, v248, v249
    v_pk_mul_f32 v[254:255], v[126:127], v[238:239]
    v_pk_fma_f32 v[252:253], v[126:127], v[222:223], s[76:77]
    v_exp_f32 v254, v254 clamp
    v_exp_f32 v255, v255 clamp
    v_max_f32 v252, s76, v252
    s_add_u32 s58, s22, 90112
    buffer_load_dwordx4 a[92:95], v3, s[4:7], s58 offen sc1
    v_max_f32 v253, s76, v253
    v_pk_add_f32 v[252:253], v[252:253], v[254:255]
    v_cvt_pk_bf16_f32 v151, v252, v253
    ds_write_b64 v18, v[144:145] offset:0
    ds_write_b64 v18, v[146:147] offset:16
    ds_write_b64 v18, v[148:149] offset:32
    ds_write_b64 v18, v[150:151] offset:48
    ds_read_b64_tr_b16 v[144:145], v20 offset:0
    ds_read_b64_tr_b16 v[146:147], v20 offset:288
    ds_read_b64_tr_b16 v[148:149], v20 offset:1152
    ds_read_b64_tr_b16 v[150:151], v20 offset:1440
    ds_read_b64_tr_b16 v[152:153], v21 offset:0
    ds_read_b64_tr_b16 v[154:155], v21 offset:288
    s_add_u32 s58, s22, 94208
    buffer_load_dwordx4 a[96:99], v3, s[4:7], s58 offen sc1
    s_add_u32 s58, s22, 98304
    buffer_load_dwordx4 a[100:103], v3, s[4:7], s58 offen sc1
    s_mov_b32 s99, 0
Lkvsum_53:
    s_waitcnt vmcnt(12)
    v_mfma_f32_32x32x16_bf16 v[128:143], v[104:107], v[72:75], 0
    s_add_u32 s58, s22, 102400
    buffer_load_dwordx4 a[104:107], v3, s[4:7], s58 offen sc1
    v_max_u32 v112, v72, v74
    v_mfma_f32_32x32x16_bf16 v[128:143], v[104:107], v[76:79], v[128:143]
    s_add_u32 s58, s22, 106496
    buffer_load_dwordx4 a[108:111], v3, s[4:7], s58 offen sc1
    v_max3_u32 v112, v76, v78, v112
    s_waitcnt vmcnt(12)
    v_mfma_f32_32x32x16_bf16 v[128:143], v[104:107], v[80:83], v[128:143]
    s_add_u32 s58, s22, 110592
    buffer_load_dwordx4 a[112:115], v3, s[4:7], s58 offen sc1
    v_max3_u32 v112, v80, v82, v112
    v_mfma_f32_32x32x16_bf16 v[128:143], v[104:107], v[84:87], v[128:143]
    s_add_u32 s58, s22, 114688
    buffer_load_dwordx4 a[116:119], v3, s[4:7], s58 offen sc1
    v_max3_u32 v112, v84, v86, v112
    s_waitcnt vmcnt(12)
    v_mfma_f32_32x32x16_bf16 v[128:143], v[104:107], v[88:91], v[128:143]
    s_add_u32 s58, s22, 118784
    buffer_load_dwordx4 a[120:123], v3, s[4:7], s58 offen sc1
    v_max3_u32 v112, v88, v90, v112
    v_mfma_f32_32x32x16_bf16 v[128:143], v[104:107], v[92:95], v[128:143]
    s_add_u32 s58, s22, 122880
    buffer_load_dwordx4 a[124:127], v3, s[4:7], s58 offen sc1
    v_max3_u32 v112, v92, v94, v112
    s_waitcnt vmcnt(12)
    v_mfma_f32_32x32x16_bf16 v[128:143], v[104:107], v[96:99], v[128:143]
    s_add_u32 s58, s22, 126976
    buffer_load_dwordx4 a[128:131], v3, s[4:7], s58 offen sc1
    v_max3_u32 v112, v96, v98, v112
    v_mfma_f32_32x32x16_bf16 v[128:143], v[104:107], v[100:103], v[128:143]
    s_add_u32 s58, s22, 131072
    buffer_load_dwordx4 a[132:135], v3, s[4:7], s58 offen sc1
    v_max3_u32 v112, v100, v102, v112
    v_cmp_eq_u32 vcc, -1, v112
    s_nop 1
    s_and_b64 vcc, vcc, s[88:89]
    s_cbranch_scc1 Lkvre_54
Lkvre_54_b:
    s_nop 3
    v_cvt_pk_bf16_f32 v68, v128, v129
    v_cvt_pk_bf16_f32 v69, v130, v131
    s_mov_b64 exec, s[88:89]
    ds_write_b64 v15, v[68:69]
    s_mov_b64 exec, -1
    s_waitcnt lgkmcnt(0)
    s_barrier
    ds_read_b128 v[220:223], v17 offset:0
    ds_read_b128 v[224:227], v17 offset:32
    ds_read_b128 v[228:231], v17 offset:64
    ds_read_b128 v[208:211], v16 offset:0
    ds_read_b128 v[212:215], v16 offset:32
    ds_read_b128 v[216:219], v16 offset:64
    s_waitcnt lgkmcnt(5)
    v_mfma_f32_32x32x16_bf16 v[80:95], v[220:223], v[144:147], 0
    s_waitcnt lgkmcnt(4)
    v_mfma_f32_32x32x16_bf16 v[80:95], v[224:227], v[148:151], v[80:95]
    s_waitcnt lgkmcnt(3)
    v_mfma_f32_32x32x16_bf16 v[80:95], v[228:231], v[152:155], v[80:95]
    s_waitcnt lgkmcnt(2)
    v_mfma_f32_32x32x16_bf16 v[64:79], v[208:211], v[144:147], 0
    s_waitcnt lgkmcnt(1)
    v_mfma_f32_32x32x16_bf16 v[64:79], v[212:215], v[148:151], v[64:79]
    s_waitcnt lgkmcnt(0)
    v_mfma_f32_32x32x16_bf16 v[64:79], v[216:219], v[152:155], v[64:79]
    s_add_u32 s44, s17, s33
    s_nop 4
    v_add_f32 v232, s76, v88
    v_add_f32 v234, s76, v89
    v_rcp_f32 v232, v232
    v_rcp_f32 v234, v234
    v_pk_mul_f32 v[80:81], v[80:81], v[232:233] op_sel_hi:[1,0]
    v_pk_mul_f32 v[82:83], v[82:83], v[232:233] op_sel_hi:[1,0]
    v_pk_mul_f32 v[84:85], v[84:85], v[234:235] op_sel_hi:[1,0]
    v_pk_mul_f32 v[86:87], v[86:87], v[234:235] op_sel_hi:[1,0]
    v_cvt_pk_bf16_f32 v244, v80, v81
    v_cvt_pk_bf16_f32 v245, v82, v83
    v_cvt_pk_bf16_f32 v246, v84, v85
    v_cvt_pk_bf16_f32 v247, v86, v87
    s_mov_b32 exec_hi, 0
    buffer_store_dwordx4 v[244:247], v7, s[4:7], s44 offen offset:512 sc1
    s_mov_b64 exec, -1
    v_pk_mul_f32 v[64:65], v[64:65], v[232:233] op_sel_hi:[1,0]
    v_pk_mul_f32 v[66:67], v[66:67], v[232:233] op_sel_hi:[1,0]
    v_pk_mul_f32 v[68:69], v[68:69], v[232:233] op_sel_hi:[1,0]
    v_pk_mul_f32 v[70:71], v[70:71], v[232:233] op_sel_hi:[1,0]
    v_cvt_pk_bf16_f32 v236, v64, v65
    v_cvt_pk_bf16_f32 v237, v66, v67
    v_cvt_pk_bf16_f32 v238, v68, v69
    v_cvt_pk_bf16_f32 v239, v70, v71
    buffer_store_dwordx4 v[236:239], v7, s[4:7], s44 offen offset:0 sc1
    v_pk_mul_f32 v[72:73], v[72:73], v[234:235] op_sel_hi:[1,0]
    v_pk_mul_f32 v[74:75], v[74:75], v[234:235] op_sel_hi:[1,0]
    v_pk_mul_f32 v[76:77], v[76:77], v[234:235] op_sel_hi:[1,0]
    v_pk_mul_f32 v[78:79], v[78:79], v[234:235] op_sel_hi:[1,0]
    v_cvt_pk_bf16_f32 v240, v72, v73
    v_cvt_pk_bf16_f32 v241, v74, v75
    v_cvt_pk_bf16_f32 v242, v76, v77
    v_cvt_pk_bf16_f32 v243, v78, v79
    buffer_store_dwordx4 v[240:243], v7, s[4:7], s44 offen offset:768 sc1
    s_mul_i32 s57, s24, 256
    s_add_u32 s57, s57, s18
    s_add_u32 s57, s57, 32768
    s_atomic_add s62, s[12:13], s57
    s_add_u32 m0, s19, 135168
    s_add_u32 s59, s21, 98304
    buffer_load_dwordx4 v3, s[4:7], s59 offen offset:0 sc1 lds
    s_add_u32 s58, s22, 135168
    buffer_load_dwordx4 a[136:139], v3, s[4:7], s58 offen sc1
    s_add_u32 s58, s22, 139264
    buffer_load_dwordx4 a[140:143], v3, s[4:7], s58 offen sc1
    s_add_u32 s58, s22, 143360
    buffer_load_dwordx4 a[144:147], v3, s[4:7], s58 offen sc1
    s_add_u32 s58, s22, 147456
    buffer_load_dwordx4 a[148:151], v3, s[4:7], s58 offen sc1
    s_add_u32 s58, s22, 151552
    buffer_load_dwordx4 a[152:155], v3, s[4:7], s58 offen sc1
    s_add_u32 s58, s22, 155648
    buffer_load_dwordx4 a[156:159], v3, s[4:7], s58 offen sc1
    s_add_u32 m0, s86, 139264
    s_add_u32 s59, s22, 0
    buffer_load_dwordx4 v198, s[4:7], s59 offen offset:0 sc1 lds
    buffer_load_dwordx4 v198, s[4:7], s59 offen offset:1024 sc1 lds
    s_mul_i32 s56, s26, 256
    s_add_u32 s56, s56, s18
    s_add_u32 s56, s56, 32768
    s_mov_b32 s63, 0
    s_atomic_add s63, s[12:13], s56 glc
    s_waitcnt vmcnt(8)
    s_barrier
    ds_read_b128 v[64:67], v2 offset:36864
    ds_read_b128 v[68:71], v2 offset:37888
    ds_read_b128 v[72:75], v2 offset:38912
    ds_read_b128 v[76:79], v2 offset:39936
    ds_read_b128 v[80:83], v2 offset:40960
    ds_read_b128 v[84:87], v2 offset:41984
    ds_read_b128 v[88:91], v2 offset:43008
    ds_read_b128 v[92:95], v2 offset:44032
    ds_read_b128 v[96:99], v2 offset:45056
    ds_read_b128 v[100:103], v2 offset:46080
    ds_read_b128 v[104:107], v2 offset:47104
    ds_read_b128 v[108:111], v2 offset:48128
    ds_read_b128 v[112:115], v2 offset:49152
    ds_read_b128 v[116:119], v2 offset:50176
Lpoll_55:
    s_mov_b32 s55, 0
Lpoll_55_l:
    s_waitcnt lgkmcnt(0)
    s_bfe_u32 s63, s63, 524288
    s_cmp_ge_u32 s63, 16
    s_cbranch_scc1 Lok_56
    s_mov_b32 s63, 0
    s_atomic_add s63, s[12:13], s56 glc
    s_add_u32 s55, s55, 1
    s_cmp_lt_u32 s55, 400000
    s_cbranch_scc1 Lpoll_55_l
    s_waitcnt lgkmcnt(0)
Lok_56:
    s_add_u32 s70, s17, s29
    s_add_u32 s70, s70, 8388608
    buffer_load_dwordx4 a[0:3], v2, s[4:7], s70 offen offset:0 sc1
    buffer_load_dwordx4 a[4:7], v2, s[4:7], s70 offen offset:1024 sc1
    buffer_load_dwordx4 a[8:11], v2, s[4:7], s70 offen offset:2048 sc1
    buffer_load_dwordx4 a[12:15], v2, s[4:7], s70 offen offset:3072 sc1
    s_add_u32 s70, s70, 4096
    buffer_load_dwordx4 a[16:19], v2, s[4:7], s70 offen offset:0 sc1
    s_add_u32 s70, s70, 12288
    buffer_load_dwordx4 a[20:23], v2, s[4:7], s70 offen offset:0 sc1
    buffer_load_dwordx4 a[24:27], v2, s[4:7], s70 offen offset:1024 sc1
    buffer_load_dwordx4 a[28:31], v2, s[4:7], s70 offen offset:2048 sc1
    buffer_load_dwordx4 a[32:35], v2, s[4:7], s70 offen offset:3072 sc1
    s_waitcnt vmcnt(8)
    v_accvgpr_read_b32 v203, a0
    v_cmp_eq_u32 vcc, -1, v203
    s_nop 1
    s_cbranch_vccnz Lre_57
Lbk_58:
    s_waitcnt vmcnt(7)
    v_mfma_f32_16x16x32_bf16 v[32:35], v[64:67], a[0:3], v[32:35]
    ds_read_b128 v[120:123], v2 offset:51200
    s_add_u32 s70, s70, 4096
    buffer_load_dwordx4 a[36:39], v2, s[4:7], s70 offen offset:0 sc1
    v_accvgpr_read_b32 v203, a4
    v_mfma_f32_16x16x32_bf16 v[36:39], v[68:71], a[0:3], v[36:39]
    ds_read_b128 v[64:67], v2 offset:52224
    v_cmp_eq_u32 vcc, -1, v203
    v_mfma_f32_16x16x32_bf16 v[40:43], v[72:75], a[0:3], v[40:43]
    ds_read_b128 v[68:71], v2 offset:53248
    v_mfma_f32_16x16x32_bf16 v[44:47], v[76:79], a[0:3], v[44:47]
    ds_read_b128 v[72:75], v2 offset:54272
    s_cbranch_vccnz Lre_59
Lbk_60:
    v_mfma_f32_16x16x32_bf16 v[48:51], v[80:83], a[0:3], v[48:51]
    ds_read_b128 v[76:79], v2 offset:55296
    s_add_u32 s70, s70, 12288
    buffer_load_dwordx4 a[40:43], v2, s[4:7], s70 offen offset:0 sc1
    s_waitcnt vmcnt(8)
    v_mfma_f32_16x16x32_bf16 v[32:35], v[84:87], a[4:7], v[32:35]
    ds_read_b128 v[80:83], v2 offset:56320
    v_accvgpr_read_b32 v203, a8
    v_mfma_f32_16x16x32_bf16 v[36:39], v[88:91], a[4:7], v[36:39]
    ds_read_b128 v[84:87], v2 offset:57344
    v_cmp_eq_u32 vcc, -1, v203
    v_mfma_f32_16x16x32_bf16 v[40:43], v[92:95], a[4:7], v[40:43]
    ds_read_b128 v[88:91], v2 offset:58368
Lw_2:
    s_cbranch_execz Lw_3
    v_mfma_f32_16x16x32_bf16 v[44:47], v[96:99], a[4:7], v[44:47]
    ds_read_b128 v[92:95], v2 offset:59392
    buffer_load_dwordx4 a[44:47], v2, s[4:7], s70 offen offset:1024 sc1
    s_cbranch_vccnz Lre_61
Lbk_62:
    v_mfma_f32_16x16x32_bf16 v[48:51], v[100:103], a[4:7], v[48:51]
    ds_read_b128 v[96:99], v2 offset:60416
    s_waitcnt vmcnt(8) lgkmcnt(9)
    v_mfma_f32_16x16x32_bf16 v[32:35], v[104:107], a[8:11], v[32:35]
    ds_read_b128 v[100:103], v2 offset:61440
    v_accvgpr_read_b32 v203, a12
    v_mfma_f32_16x16x32_bf16 v[36:39], v[108:111], a[8:11], v[36:39]
    ds_read_b128 v[104:107], v2 offset:62464
    v_cmp_eq_u32 vcc, -1, v203
    v_mfma_f32_16x16x32_bf16 v[40:43], v[112:115], a[8:11], v[40:43]
    ds_read_b128 v[108:111], v2 offset:63488
    buffer_load_dwordx4 a[48:51], v2, s[4:7], s70 offen offset:2048 sc1
    v_mfma_f32_16x16x32_bf16 v[44:47], v[116:119], a[8:11], v[44:47]
    ds_read_b128 v[112:115], v2 offset:64512
    s_cbranch_vccnz Lre_63
Lbk_64:
    v_mfma_f32_16x16x32_bf16 v[48:51], v[120:123], a[8:11], v[48:51]
    ds_read_b128 v[116:119], v4 offset:0
    s_waitcnt vmcnt(8) lgkmcnt(9)
    v_mfma_f32_16x16x32_bf16 v[32:35], v[64:67], a[12:15], v[32:35]
    ds_read_b128 v[120:123], v4 offset:1024
    v_accvgpr_read_b32 v203, a16
    v_mfma_f32_16x16x32_bf16 v[36:39], v[68:71], a[12:15], v[36:39]
    ds_read_b128 v[64:67], v4 offset:2048
    buffer_load_dwordx4 a[52:55], v2, s[4:7], s70 offen offset:3072 sc1
    v_cmp_eq_u32 vcc, -1, v203
    v_mfma_f32_16x16x32_bf16 v[40:43], v[72:75], a[12:15], v[40:43]
    ds_read_b128 v[68:71], v4 offset:3072
    v_mfma_f32_16x16x32_bf16 v[44:47], v[76:79], a[12:15], v[44:47]
    ds_read_b128 v[72:75], v4 offset:4096
    s_cbranch_vccnz Lre_65
Lbk_66:
    v_mfma_f32_16x16x32_bf16 v[48:51], v[80:83], a[12:15], v[48:51]
    ds_read_b128 v[76:79], v4 offset:5120
    s_waitcnt vmcnt(8) lgkmcnt(9)
    v_mfma_f32_16x16x32_bf16 v[32:35], v[84:87], a[16:19], v[32:35]
    ds_read_b128 v[80:83], v4 offset:6144
    s_add_u32 s70, s70, 4096
    buffer_load_dwordx4 a[56:59], v2, s[4:7], s70 offen offset:0 sc1
    v_accvgpr_read_b32 v203, a20
    v_mfma_f32_16x16x32_bf16 v[36:39], v[88:91], a[16:19], v[36:39]
    ds_read_b128 v[84:87], v4 offset:7168
    v_cmp_eq_u32 vcc, -1, v203
    v_mfma_f32_16x16x32_bf16 v[40:43], v[92:95], a[16:19], v[40:43]
    ds_read_b128 v[88:91], v4 offset:8192
    v_mfma_f32_16x16x32_bf16 v[44:47], v[96:99], a[16:19], v[44:47]
    ds_read_b128 v[92:95], v4 offset:9216
    s_cbranch_vccnz Lre_67
Lbk_68:
    v_mfma_f32_16x16x32_bf16 v[48:51], v[100:103], a[16:19], v[48:51]
    ds_read_b128 v[96:99], v4 offset:10240
    s_add_u32 s70, s70, 12288
    buffer_load_dwordx4 a[60:63], v2, s[4:7], s70 offen offset:0 sc1
    s_waitcnt vmcnt(9) lgkmcnt(9)
    v_mfma_f32_16x16x32_bf16 v[32:35], v[104:107], a[20:23], v[32:35]
    ds_read_b128 v[100:103], v4 offset:11264
    v_accvgpr_read_b32 v203, a24
    v_mfma_f32_16x16x32_bf16 v[36:39], v[108:111], a[20:23], v[36:39]
    ds_read_b128 v[104:107], v4 offset:12288
    v_cmp_eq_u32 vcc, -1, v203
    v_mfma_f32_16x16x32_bf16 v[40:43], v[112:115], a[20:23], v[40:43]
    ds_read_b128 v[108:111], v4 offset:13312
    v_mfma_f32_16x16x32_bf16 v[44:47], v[116:119], a[20:23], v[44:47]
    ds_read_b128 v[112:115], v4 offset:14336
    buffer_load_dwordx4 a[64:67], v2, s[4:7], s70 offen offset:1024 sc1
    s_cbranch_vccnz Lre_69
Lbk_70:
    v_mfma_f32_16x16x32_bf16 v[48:51], v[120:123], a[20:23], v[48:51]
    ds_read_b128 v[116:119], v4 offset:15360
    s_waitcnt vmcnt(9) lgkmcnt(9)
    v_mfma_f32_16x16x32_bf16 v[32:35], v[64:67], a[24:27], v[32:35]
    ds_read_b128 v[120:123], v4 offset:16384
    v_accvgpr_read_b32 v203, a28
    v_mfma_f32_16x16x32_bf16 v[36:39], v[68:71], a[24:27], v[36:39]
    ds_read_b128 v[64:67], v4 offset:17408
    v_cmp_eq_u32 vcc, -1, v203
    v_mfma_f32_16x16x32_bf16 v[40:43], v[72:75], a[24:27], v[40:43]
    ds_read_b128 v[68:71], v4 offset:18432
    buffer_load_dwordx4 a[68:71], v2, s[4:7], s70 offen offset:2048 sc1
    v_mfma_f32_16x16x32_bf16 v[44:47], v[76:79], a[24:27], v[44:47]
    ds_read_b128 v[72:75], v4 offset:19456
    s_cbranch_vccnz Lre_71
Lbk_72:
    v_mfma_f32_16x16x32_bf16 v[48:51], v[80:83], a[24:27], v[48:51]
    ds_read_b128 v[76:79], v4 offset:20480
    s_waitcnt vmcnt(9) lgkmcnt(9)
    v_mfma_f32_16x16x32_bf16 v[32:35], v[84:87], a[28:31], v[32:35]
    ds_read_b128 v[80:83], v4 offset:21504
    v_accvgpr_read_b32 v203, a32
    v_mfma_f32_16x16x32_bf16 v[36:39], v[88:91], a[28:31], v[36:39]
    ds_read_b128 v[84:87], v4 offset:22528
    buffer_load_dwordx4 a[72:75], v2, s[4:7], s70 offen offset:3072 sc1
    v_cmp_eq_u32 vcc, -1, v203
    v_mfma_f32_16x16x32_bf16 v[40:43], v[92:95], a[28:31], v[40:43]
    ds_read_b128 v[88:91], v4 offset:23552
    v_mfma_f32_16x16x32_bf16 v[44:47], v[96:99], a[28:31], v[44:47]
    ds_read_b128 v[92:95], v4 offset:24576
    s_cbranch_vccnz Lre_73
Lbk_74:
    v_mfma_f32_16x16x32_bf16 v[48:51], v[100:103], a[28:31], v[48:51]
    ds_read_b128 v[96:99], v4 offset:25600
    s_waitcnt vmcnt(9) lgkmcnt(9)
    v_mfma_f32_16x16x32_bf16 v[32:35], v[104:107], a[32:35], v[32:35]
    ds_read_b128 v[100:103], v4 offset:26624
    s_add_u32 s70, s70, 4096
    buffer_load_dwordx4 a[76:79], v2, s[4:7], s70 offen offset:0 sc1
    v_accvgpr_read_b32 v203, a36
    v_mfma_f32_16x16x32_bf16 v[36:39], v[108:111], a[32:35], v[36:39]
    ds_read_b128 v[104:107], v4 offset:27648
    v_cmp_eq_u32 vcc, -1, v203
    v_mfma_f32_16x16x32_bf16 v[40:43], v[112:115], a[32:35], v[40:43]
    ds_read_b128 v[108:111], v4 offset:28672
    v_mfma_f32_16x16x32_bf16 v[44:47], v[116:119], a[32:35], v[44:47]
    ds_read_b128 v[112:115], v4 offset:29696
    s_cbranch_vccnz Lre_75
Lbk_76:
    v_mfma_f32_16x16x32_bf16 v[48:51], v[120:123], a[32:35], v[48:51]
    ds_read_b128 v[116:119], v4 offset:30720
    s_waitcnt vmcnt(9) lgkmcnt(9)
    v_mfma_f32_16x16x32_bf16 v[32:35], v[64:67], a[36:39], v[32:35]
    ds_read_b128 v[120:123], v4 offset:31744
    v_accvgpr_read_b32 v203, a40
    v_mfma_f32_16x16x32_bf16 v[36:39], v[68:71], a[36:39], v[36:39]
    ds_read_b128 v[64:67], v4 offset:32768
    v_cmp_eq_u32 vcc, -1, v203
    v_mfma_f32_16x16x32_bf16 v[40:43], v[72:75], a[36:39], v[40:43]
    ds_read_b128 v[68:71], v4 offset:33792
    v_mfma_f32_16x16x32_bf16 v[44:47], v[76:79], a[36:39], v[44:47]
    ds_read_b128 v[72:75], v4 offset:34816
    s_cbranch_vccnz Lre_77
Lbk_78:
    v_mfma_f32_16x16x32_bf16 v[48:51], v[80:83], a[36:39], v[48:51]
    ds_read_b128 v[76:79], v4 offset:35840
    s_waitcnt vmcnt(8) lgkmcnt(9)
    v_mfma_f32_16x16x32_bf16 v[32:35], v[84:87], a[40:43], v[32:35]
    ds_read_b128 v[80:83], v4 offset:36864
    buffer_load_dwordx4 v198, s[4:7], s59 offen offset:2048 sc1 lds
    v_accvgpr_read_b32 v203, a44
    v_mfma_f32_16x16x32_bf16 v[36:39], v[88:91], a[40:43], v[36:39]
    ds_read_b128 v[84:87], v4 offset:37888
    v_cmp_eq_u32 vcc, -1, v203
    v_mfma_f32_16x16x32_bf16 v[40:43], v[92:95], a[40:43], v[40:43]
    ds_read_b128 v[88:91], v4 offset:38912
    v_mfma_f32_16x16x32_bf16 v[44:47], v[96:99], a[40:43], v[44:47]
    ds_read_b128 v[92:95], v4 offset:39936
    s_cbranch_vccnz Lre_79
Lbk_80:
    v_mfma_f32_16x16x32_bf16 v[48:51], v[100:103], a[40:43], v[48:51]
    ds_read_b128 v[96:99], v4 offset:40960
    buffer_load_dwordx4 v198, s[4:7], s59 offen offset:3072 sc1 lds
    s_waitcnt vmcnt(9) lgkmcnt(9)
    v_mfma_f32_16x16x32_bf16 v[32:35], v[104:107], a[44:47], v[32:35]
    ds_read_b128 v[100:103], v4 offset:41984
    v_accvgpr_read_b32 v203, a48
    v_mfma_f32_16x16x32_bf16 v[36:39], v[108:111], a[44:47], v[36:39]
    ds_read_b128 v[104:107], v4 offset:43008
    v_cmp_eq_u32 vcc, -1, v203
    v_mfma_f32_16x16x32_bf16 v[40:43], v[112:115], a[44:47], v[40:43]
    ds_read_b128 v[108:111], v4 offset:44032
    v_mfma_f32_16x16x32_bf16 v[44:47], v[116:119], a[44:47], v[44:47]
    ds_read_b128 v[112:115], v4 offset:45056
    s_cbranch_vccnz Lre_81
Lbk_82:
    v_mfma_f32_16x16x32_bf16 v[48:51], v[120:123], a[44:47], v[48:51]
    ds_read_b128 v[116:119], v4 offset:46080
    s_add_u32 m0, s19, 155648
    s_add_u32 s59, s22, 16384
    buffer_load_dwordx4 v3, s[4:7], s59 offen offset:0 sc1 lds
    s_waitcnt vmcnt(9) lgkmcnt(9)
    v_mfma_f32_16x16x32_bf16 v[32:35], v[64:67], a[48:51], v[32:35]
    ds_read_b128 v[120:123], v4 offset:47104
    v_accvgpr_read_b32 v203, a52
    v_mfma_f32_16x16x32_bf16 v[36:39], v[68:71], a[48:51], v[36:39]
    ds_read_b128 v[64:67], v4 offset:48128
    v_cmp_eq_u32 vcc, -1, v203
    v_mfma_f32_16x16x32_bf16 v[40:43], v[72:75], a[48:51], v[40:43]
    ds_read_b128 v[68:71], v4 offset:49152
    v_mfma_f32_16x16x32_bf16 v[44:47], v[76:79], a[48:51], v[44:47]
    ds_read_b128 v[72:75], v4 offset:50176
    s_add_u32 m0, s86, 0
    s_add_u32 s59, s22, 20480
    buffer_load_dwordx4 v198, s[4:7], s59 offen offset:0 sc1 lds
    s_cbranch_vccnz Lre_83
Lbk_84:
    v_mfma_f32_16x16x32_bf16 v[48:51], v[80:83], a[48:51], v[48:51]
    ds_read_b128 v[76:79], v4 offset:51200
    s_waitcnt vmcnt(9) lgkmcnt(9)
    v_mfma_f32_16x16x32_bf16 v[32:35], v[84:87], a[52:55], v[32:35]
    ds_read_b128 v[80:83], v4 offset:52224
    v_accvgpr_read_b32 v203, a56
    v_mfma_f32_16x16x32_bf16 v[36:39], v[88:91], a[52:55], v[36:39]
    ds_read_b128 v[84:87], v4 offset:53248
    v_cmp_eq_u32 vcc, -1, v203
    v_mfma_f32_16x16x32_bf16 v[40:43], v[92:95], a[52:55], v[40:43]
    ds_read_b128 v[88:91], v4 offset:54272
    v_mfma_f32_16x16x32_bf16 v[44:47], v[96:99], a[52:55], v[44:47]
    ds_read_b128 v[92:95], v4 offset:55296
    buffer_load_dwordx4 v198, s[4:7], s59 offen offset:1024 sc1 lds
    s_cbranch_vccnz Lre_85
Lbk_86:
    v_mfma_f32_16x16x32_bf16 v[48:51], v[100:103], a[52:55], v[48:51]
    ds_read_b128 v[96:99], v4 offset:56320
    s_waitcnt vmcnt(9) lgkmcnt(9)
    v_mfma_f32_16x16x32_bf16 v[32:35], v[104:107], a[56:59], v[32:35]
    ds_read_b128 v[100:103], v4 offset:57344
    v_accvgpr_read_b32 v203, a60
    v_mfma_f32_16x16x32_bf16 v[36:39], v[108:111], a[56:59], v[36:39]
    ds_read_b128 v[104:107], v4 offset:58368
    v_cmp_eq_u32 vcc, -1, v203
    v_mfma_f32_16x16x32_bf16 v[40:43], v[112:115], a[56:59], v[40:43]
    ds_read_b128 v[108:111], v4 offset:59392
    buffer_load_dwordx4 v198, s[4:7], s59 offen offset:2048 sc1 lds
    v_mfma_f32_16x16x32_bf16 v[44:47], v[116:119], a[56:59], v[44:47]
    ds_read_b128 v[112:115], v4 offset:60416
    s_cbranch_vccnz Lre_87
Lbk_88:
    v_mfma_f32_16x16x32_bf16 v[48:51], v[120:123], a[56:59], v[48:51]
    ds_read_b128 v[116:119], v4 offset:61440
    s_waitcnt vmcnt(9) lgkmcnt(9)
    v_mfma_f32_16x16x32_bf16 v[32:35], v[64:67], a[60:63], v[32:35]
    ds_read_b128 v[120:123], v4 offset:62464
    v_accvgpr_read_b32 v203, a64
    v_mfma_f32_16x16x32_bf16 v[36:39], v[68:71], a[60:63], v[36:39]
    ds_read_b128 v[64:67], v4 offset:63488
    v_cmp_eq_u32 vcc, -1, v203
    v_mfma_f32_16x16x32_bf16 v[40:43], v[72:75], a[60:63], v[40:43]
    ds_read_b128 v[68:71], v4 offset:64512
    buffer_load_dwordx4 v198, s[4:7], s59 offen offset:3072 sc1 lds
    v_mfma_f32_16x16x32_bf16 v[44:47], v[76:79], a[60:63], v[44:47]
    ds_read_b128 v[72:75], v5 offset:0
    s_cbranch_vccnz Lre_89
Lbk_90:
    v_mfma_f32_16x16x32_bf16 v[48:51], v[80:83], a[60:63], v[48:51]
    ds_read_b128 v[76:79], v5 offset:1024
    s_waitcnt vmcnt(9) lgkmcnt(9)
    v_mfma_f32_16x16x32_bf16 v[32:35], v[84:87], a[64:67], v[32:35]
    ds_read_b128 v[80:83], v5 offset:2048
    v_accvgpr_read_b32 v203, a68
    v_mfma_f32_16x16x32_bf16 v[36:39], v[88:91], a[64:67], v[36:39]
    ds_read_b128 v[84:87], v5 offset:3072
    s_add_u32 m0, s86, 16384
    s_add_u32 s59, s22, 36864
    buffer_load_dwordx4 v198, s[4:7], s59 offen offset:0 sc1 lds
    v_cmp_eq_u32 vcc, -1, v203
    v_mfma_f32_16x16x32_bf16 v[40:43], v[92:95], a[64:67], v[40:43]
    ds_read_b128 v[88:91], v5 offset:4096
    v_mfma_f32_16x16x32_bf16 v[44:47], v[96:99], a[64:67], v[44:47]
    ds_read_b128 v[92:95], v5 offset:5120
    s_cbranch_vccnz Lre_91
Lbk_92:
    v_mfma_f32_16x16x32_bf16 v[48:51], v[100:103], a[64:67], v[48:51]
    ds_read_b128 v[96:99], v5 offset:6144
    s_waitcnt vmcnt(9) lgkmcnt(9)
    v_mfma_f32_16x16x32_bf16 v[32:35], v[104:107], a[68:71], v[32:35]
    ds_read_b128 v[100:103], v5 offset:7168
    v_accvgpr_read_b32 v203, a72
    v_mfma_f32_16x16x32_bf16 v[36:39], v[108:111], a[68:71], v[36:39]
    buffer_load_dwordx4 v198, s[4:7], s59 offen offset:1024 sc1 lds
    v_cmp_eq_u32 vcc, -1, v203
    v_mfma_f32_16x16x32_bf16 v[40:43], v[112:115], a[68:71], v[40:43]
    v_mfma_f32_16x16x32_bf16 v[44:47], v[116:119], a[68:71], v[44:47]
    s_cbranch_vccnz Lre_93
Lbk_94:
    v_mfma_f32_16x16x32_bf16 v[48:51], v[120:123], a[68:71], v[48:51]
    s_waitcnt vmcnt(9) lgkmcnt(5)
    v_mfma_f32_16x16x32_bf16 v[32:35], v[64:67], a[72:75], v[32:35]
    buffer_load_dwordx4 v198, s[4:7], s59 offen offset:2048 sc1 lds
    v_accvgpr_read_b32 v203, a76
    v_mfma_f32_16x16x32_bf16 v[36:39], v[68:71], a[72:75], v[36:39]
    v_cmp_eq_u32 vcc, -1, v203
    v_mfma_f32_16x16x32_bf16 v[40:43], v[72:75], a[72:75], v[40:43]
    v_mfma_f32_16x16x32_bf16 v[44:47], v[76:79], a[72:75], v[44:47]
    s_cbranch_vccnz Lre_95
Lbk_96:
    v_mfma_f32_16x16x32_bf16 v[48:51], v[80:83], a[72:75], v[48:51]
    s_waitcnt lgkmcnt(0)
    v_mfma_f32_16x16x32_bf16 v[32:35], v[84:87], a[76:79], v[32:35]
    buffer_load_dwordx4 v198, s[4:7], s59 offen offset:3072 sc1 lds
    v_mfma_f32_16x16x32_bf16 v[36:39], v[88:91], a[76:79], v[36:39]
    v_mfma_f32_16x16x32_bf16 v[40:43], v[92:95], a[76:79], v[40:43]
    v_mfma_f32_16x16x32_bf16 v[44:47], v[96:99], a[76:79], v[44:47]
    v_mfma_f32_16x16x32_bf16 v[48:51], v[100:103], a[76:79], v[48:51]
    s_add_u32 m0, s19, 32768
    s_add_u32 s59, s22, 53248
    buffer_load_dwordx4 v3, s[4:7], s59 offen offset:0 sc1 lds
    s_add_u32 s44, s17, s31
    s_add_u32 s44, s44, 4194304
    v_cvt_pk_bf16_f32 v208, v32, v33
    v_cvt_pk_bf16_f32 v209, v34, v35
    v_cvt_pk_bf16_f32 v210, v36, v37
    v_cvt_pk_bf16_f32 v211, v38, v39
    buffer_store_dwordx4 v[208:211], v9, s[4:7], s44 offen sc1
    v_cvt_pk_bf16_f32 v216, v48, v49
    v_cvt_pk_bf16_f32 v220, v48, v49
    v_cvt_pk_bf16_f32 v217, v50, v51
    v_cvt_pk_bf16_f32 v221, v50, v51
    v_cvt_pk_bf16_f32 v212, v40, v41
    v_cvt_pk_bf16_f32 v213, v42, v43
    v_cvt_pk_bf16_f32 v214, v44, v45
    v_cvt_pk_bf16_f32 v215, v46, v47
    buffer_store_dwordx4 v[212:215], v9, s[4:7], s44 offen offset:2048 sc1
    v_permlane16_swap_b32 v220, v218
    v_permlane16_swap_b32 v221, v219
    s_mov_b32 exec_lo, 0xffff
    s_mov_b32 exec_hi, 0xffff
    buffer_store_dwordx4 v[216:219], v10, s[4:7], s44 offen sc1
    s_mov_b64 exec, -1
    s_mul_i32 s57, s26, 256
    s_add_u32 s57, s57, s18
    s_add_u32 s57, s57, 49152
    s_atomic_add s62, s[12:13], s57
    v_lshlrev_b32 v32, 16, v208
    v_and_b32 v33, 0xffff0000, v208
    v_lshlrev_b32 v34, 16, v209
    v_and_b32 v35, 0xffff0000, v209
    v_lshlrev_b32 v36, 16, v210
    v_and_b32 v37, 0xffff0000, v210
    v_lshlrev_b32 v38, 16, v211
    v_and_b32 v39, 0xffff0000, v211
    v_lshlrev_b32 v40, 16, v212
    v_and_b32 v41, 0xffff0000, v212
    v_lshlrev_b32 v42, 16, v213
    v_and_b32 v43, 0xffff0000, v213
    v_lshlrev_b32 v44, 16, v214
    v_and_b32 v45, 0xffff0000, v214
    v_lshlrev_b32 v46, 16, v215
    v_and_b32 v47, 0xffff0000, v215
    v_lshlrev_b32 v48, 16, v216
    v_and_b32 v49, 0xffff0000, v216
    v_lshlrev_b32 v50, 16, v217
    v_and_b32 v51, 0xffff0000, v217
    v_pk_add_f32 v[224:225], v[32:33], v[34:35]
    v_pk_add_f32 v[226:227], v[36:37], v[38:39]
    v_pk_add_f32 v[224:225], v[224:225], v[40:41]
    v_pk_add_f32 v[226:227], v[226:227], v[42:43]
    v_pk_add_f32 v[224:225], v[224:225], v[44:45]
    v_pk_add_f32 v[226:227], v[226:227], v[46:47]
    v_pk_add_f32 v[224:225], v[224:225], v[48:49]
    v_pk_add_f32 v[226:227], v[226:227], v[50:51]
    v_pk_add_f32 v[224:225], v[224:225], v[226:227]
    v_add_f32 v224, v224, v225
    v_mov_b32 v225, v224
    s_nop 1
    v_permlane16_swap_b32 v224, v225
    v_add_f32 v224, v224, v225
    v_mov_b32 v225, v224
    s_nop 1
    v_permlane32_swap_b32 v224, v225
    v_add_f32 v224, v224, v225
    v_mul_f32 v224, 1011666125, v224
    v_pk_add_f32 v[232:233], v[32:33], v[224:225] op_sel_hi:[1,0] neg_lo:[0,1] neg_hi:[0,1]
    v_pk_mul_f32 v[228:229], v[232:233], v[232:233]
    v_pk_add_f32 v[234:235], v[34:35], v[224:225] op_sel_hi:[1,0] neg_lo:[0,1] neg_hi:[0,1]
    v_pk_mul_f32 v[230:231], v[234:235], v[234:235]
    v_pk_add_f32 v[236:237], v[36:37], v[224:225] op_sel_hi:[1,0] neg_lo:[0,1] neg_hi:[0,1]
    v_pk_fma_f32 v[228:229], v[236:237], v[236:237], v[228:229]
    v_pk_add_f32 v[238:239], v[38:39], v[224:225] op_sel_hi:[1,0] neg_lo:[0,1] neg_hi:[0,1]
    v_pk_fma_f32 v[230:231], v[238:239], v[238:239], v[230:231]
    v_pk_add_f32 v[232:233], v[40:41], v[224:225] op_sel_hi:[1,0] neg_lo:[0,1] neg_hi:[0,1]
    v_pk_fma_f32 v[228:229], v[232:233], v[232:233], v[228:229]
    v_pk_add_f32 v[234:235], v[42:43], v[224:225] op_sel_hi:[1,0] neg_lo:[0,1] neg_hi:[0,1]
    v_pk_fma_f32 v[230:231], v[234:235], v[234:235], v[230:231]
    v_pk_add_f32 v[236:237], v[44:45], v[224:225] op_sel_hi:[1,0] neg_lo:[0,1] neg_hi:[0,1]
    v_pk_fma_f32 v[228:229], v[236:237], v[236:237], v[228:229]
    v_pk_add_f32 v[238:239], v[46:47], v[224:225] op_sel_hi:[1,0] neg_lo:[0,1] neg_hi:[0,1]
    v_pk_fma_f32 v[230:231], v[238:239], v[238:239], v[230:231]
    v_pk_add_f32 v[232:233], v[48:49], v[224:225] op_sel_hi:[1,0] neg_lo:[0,1] neg_hi:[0,1]
    v_pk_fma_f32 v[228:229], v[232:233], v[232:233], v[228:229]
    v_pk_add_f32 v[234:235], v[50:51], v[224:225] op_sel_hi:[1,0] neg_lo:[0,1] neg_hi:[0,1]
    v_pk_fma_f32 v[230:231], v[234:235], v[234:235], v[230:231]
    v_pk_add_f32 v[228:229], v[228:229], v[230:231]
    v_add_f32 v225, v228, v229
    v_mov_b32 v226, v225
    s_nop 1
    v_permlane16_swap_b32 v225, v226
    v_add_f32 v225, v225, v226
    v_mov_b32 v226, v225
    s_nop 1
    v_permlane32_swap_b32 v225, v226
    v_add_f32 v225, v225, v226
    s_add_u32 s44, s17, s32
    s_add_u32 s44, s44, 21102592
    s_mov_b64 exec, 0xffff
    buffer_store_dwordx2 v[224:225], v29, s[4:7], s44 offen sc1
    s_mov_b64 exec, -1
    s_waitcnt vmcnt(9)
    s_barrier
    s_add_u32 m0, s86, 36864
    s_add_u32 s59, s22, 57344
    buffer_load_dwordx4 v198, s[4:7], s59 offen offset:0 sc1 lds
    buffer_load_dwordx4 v198, s[4:7], s59 offen offset:1024 sc1 lds
    buffer_load_dwordx4 v198, s[4:7], s59 offen offset:2048 sc1 lds
    s_mul_i32 s56, s24, 256
    s_add_u32 s56, s56, s18
    s_add_u32 s56, s56, 49152
    s_mov_b32 s63, 0
    s_atomic_add s63, s[12:13], s56 glc
    buffer_load_dwordx4 v198, s[4:7], s59 offen offset:3072 sc1 lds
    s_add_u32 m0, s19, 53248
    s_add_u32 s59, s22, 73728
    buffer_load_dwordx4 v3, s[4:7], s59 offen offset:0 sc1 lds
    ds_write_b128 v3, a[80:83] offset:57344
    ds_write_b128 v3, a[84:87] offset:61440
    ds_write_b128 v199, a[88:91] offset:0
    ds_write_b128 v199, a[92:95] offset:4096
    ds_read_b128 v[160:163], v5 offset:8192
    ds_read_b128 v[164:167], v5 offset:9216
    ds_read_b128 v[168:171], v5 offset:10240
    ds_read_b128 v[172:175], v5 offset:11264
    ds_read_b128 v[176:179], v5 offset:12288
    ds_read_b128 v[180:183], v5 offset:13312
    ds_read_b128 v[184:187], v5 offset:14336
    ds_read_b128 v[188:191], v5 offset:15360
Lpoll_97:
    s_mov_b32 s55, 0
Lpoll_97_l:
    s_waitcnt lgkmcnt(0)
    s_bfe_u32 s63, s63, 524288
    s_cmp_ge_u32 s63, 16
    s_cbranch_scc1 Lok_98
    s_mov_b32 s63, 0
    s_atomic_add s63, s[12:13], s56 glc
    s_add_u32 s55, s55, 1
    s_cmp_lt_u32 s55, 400000
    s_cbranch_scc1 Lpoll_97_l
    s_waitcnt lgkmcnt(0)
Lok_98:
    s_add_u32 s70, s17, s27
    s_add_u32 s70, s70, 4194304
    buffer_load_dwordx4 a[0:3], v2, s[4:7], s70 offen offset:0 sc1
    buffer_load_dwordx4 a[4:7], v2, s[4:7], s70 offen offset:1024 sc1
    buffer_load_dwordx4 a[8:11], v2, s[4:7], s70 offen offset:2048 sc1
    buffer_load_dwordx4 a[12:15], v2, s[4:7], s70 offen offset:3072 sc1
    s_add_u32 s70, s70, 4096
    buffer_load_dwordx4 a[16:19], v2, s[4:7], s70 offen offset:0 sc1
    s_add_u32 s70, s70, 12288
    buffer_load_dwordx4 a[20:23], v2, s[4:7], s70 offen offset:0 sc1
    buffer_load_dwordx4 a[24:27], v2, s[4:7], s70 offen offset:1024 sc1
    buffer_load_dwordx4 a[28:31], v2, s[4:7], s70 offen offset:2048 sc1
    buffer_load_dwordx4 a[32:35], v2, s[4:7], s70 offen offset:3072 sc1
    s_add_u32 s70, s70, 4096
    buffer_load_dwordx4 a[36:39], v2, s[4:7], s70 offen offset:0 sc1
    s_waitcnt vmcnt(15)
    s_mul_i32 s57, s26, 256
    s_add_u32 s57, s57, s18
    s_add_u32 s57, s57, 49152
    s_atomic_add s42, s[12:13], s57
    ds_write_b128 v199, a[96:99] offset:8192
    ds_write_b128 v199, a[100:103] offset:12288
    ds_write_b128 v199, a[104:107] offset:16384
    ds_write_b128 v199, a[108:111] offset:20480
    ds_write_b128 v199, a[112:115] offset:24576
    ds_write_b128 v199, a[116:119] offset:28672
    ds_write_b128 v199, a[120:123] offset:32768
    s_mul_i32 s53, s26, 256
    s_add_u32 s53, s53, s18
    s_add_u32 s53, s53, 49152
    s_branch L_join
L_top:
Lw_3:
    s_cbranch_execz Lw_4
    ds_read_b128 v[160:163], v2 offset:0
    ds_read_b128 v[164:167], v2 offset:1024
    ds_read_b128 v[168:171], v2 offset:2048
    ds_read_b128 v[172:175], v2 offset:3072
    ds_read_b128 v[176:179], v2 offset:4096
    ds_read_b128 v[180:183], v2 offset:5120
    ds_read_b128 v[184:187], v2 offset:6144
    ds_read_b128 v[188:191], v2 offset:7168
Lpoll_99:
    s_mov_b32 s55, 0
Lpoll_99_l:
    s_waitcnt lgkmcnt(0)
    s_bfe_u32 s63, s63, 524288
    s_cmp_ge_u32 s63, 16
    s_cbranch_scc1 Lok_100
    s_mov_b32 s63, 0
    s_atomic_add s63, s[12:13], s56 glc
    s_add_u32 s55, s55, 1
    s_cmp_lt_u32 s55, 400000
    s_cbranch_scc1 Lpoll_99_l
    s_waitcnt lgkmcnt(0)
Lok_100:
    s_add_u32 s70, s17, s27
    buffer_load_dwordx4 a[0:3], v2, s[4:7], s70 offen offset:0 sc1
    buffer_load_dwordx4 a[4:7], v2, s[4:7], s70 offen offset:1024 sc1
    buffer_load_dwordx4 a[8:11], v2, s[4:7], s70 offen offset:2048 sc1
    buffer_load_dwordx4 a[12:15], v2, s[4:7], s70 offen offset:3072 sc1
    s_add_u32 s70, s70, 4096
    buffer_load_dwordx4 a[16:19], v2, s[4:7], s70 offen offset:0 sc1
    s_add_u32 s70, s70, 12288
    buffer_load_dwordx4 a[20:23], v2, s[4:7], s70 offen offset:0 sc1
    buffer_load_dwordx4 a[24:27], v2, s[4:7], s70 offen offset:1024 sc1
    buffer_load_dwordx4 a[28:31], v2, s[4:7], s70 offen offset:2048 sc1
    buffer_load_dwordx4 a[32:35], v2, s[4:7], s70 offen offset:3072 sc1
    s_add_u32 s70, s70, 4096
    buffer_load_dwordx4 a[36:39], v2, s[4:7], s70 offen offset:0 sc1
    s_waitcnt vmcnt(10)
    s_mul_i32 s57, s26, 256
    s_add_u32 s57, s57, s18
    s_atomic_add s42, s[12:13], s57
    ds_write_b128 v199, a[184:187] offset:8192
    ds_write_b128 v199, a[188:191] offset:12288
    ds_write_b128 v199, a[192:195] offset:16384
    ds_write_b128 v199, a[196:199] offset:20480
    ds_write_b128 v199, a[200:203] offset:24576
    ds_write_b128 v199, a[204:207] offset:28672
    ds_write_b128 v199, a[208:211] offset:32768
    ds_write_b128 v199, a[212:215] offset:36864
    s_mul_i32 s53, s26, 256
    s_add_u32 s53, s53, s18
    s_waitcnt vmcnt(9)
    v_accvgpr_read_b32 v203, a0
    v_cmp_eq_u32 vcc, -1, v203
    s_nop 1
    s_cbranch_vccnz Lre_101
Lbk_102:
    s_waitcnt vmcnt(8)
    v_mfma_f32_32x32x16_bf16 v[64:79], a[0:3], v[160:163], 0
    ds_read_b128 v[192:195], v2 offset:8192
    s_add_u32 s70, s70, 12288
    buffer_load_dwordx4 a[40:43], v2, s[4:7], s70 offen offset:0 sc1
    v_accvgpr_read_b32 v203, a4
    v_cmp_eq_u32 vcc, -1, v203
    v_mfma_f32_32x32x16_bf16 v[80:95], a[0:3], v[164:167], 0
    ds_read_b128 v[160:163], v2 offset:9216
    s_cbranch_vccnz Lre_103
Lbk_104:
    v_mfma_f32_32x32x16_bf16 v[96:111], a[0:3], v[168:171], 0
    ds_read_b128 v[164:167], v2 offset:10240
    s_waitcnt vmcnt(8)
    v_mfma_f32_32x32x16_bf16 v[64:79], a[4:7], v[172:175], v[64:79]
    ds_read_b128 v[168:171], v2 offset:11264
    buffer_load_dwordx4 a[44:47], v2, s[4:7], s70 offen offset:1024 sc1
    v_accvgpr_read_b32 v203, a8
    v_cmp_eq_u32 vcc, -1, v203
    v_mfma_f32_32x32x16_bf16 v[80:95], a[4:7], v[176:179], v[80:95]
    ds_read_b128 v[172:175], v2 offset:12288
    s_cbranch_vccnz Lre_105
Lbk_106:
    ds_write_b128 v199, a[216:219] offset:40960
    v_mfma_f32_32x32x16_bf16 v[96:111], a[4:7], v[180:183], v[96:111]
    ds_read_b128 v[176:179], v2 offset:13312
    buffer_load_dwordx4 a[48:51], v2, s[4:7], s70 offen offset:2048 sc1
    s_waitcnt vmcnt(9) lgkmcnt(6)
    v_mfma_f32_32x32x16_bf16 v[64:79], a[8:11], v[184:187], v[64:79]
    ds_read_b128 v[180:183], v2 offset:14336
    v_accvgpr_read_b32 v203, a12
    v_cmp_eq_u32 vcc, -1, v203
    v_mfma_f32_32x32x16_bf16 v[80:95], a[8:11], v[188:191], v[80:95]
    ds_read_b128 v[184:187], v2 offset:15360
    s_cbranch_vccnz Lre_107
Lbk_108:
    buffer_load_dwordx4 a[52:55], v2, s[4:7], s70 offen offset:3072 sc1
    v_mfma_f32_32x32x16_bf16 v[96:111], a[8:11], v[192:195], v[96:111]
    ds_read_b128 v[188:191], v2 offset:16384
    s_waitcnt vmcnt(9) lgkmcnt(6)
    v_mfma_f32_32x32x16_bf16 v[64:79], a[12:15], v[160:163], v[64:79]
    ds_read_b128 v[192:195], v2 offset:17408
    s_add_u32 s70, s70, 4096
    buffer_load_dwordx4 a[56:59], v2, s[4:7], s70 offen offset:0 sc1
    v_accvgpr_read_b32 v203, a16
    v_cmp_eq_u32 vcc, -1, v203
    v_mfma_f32_32x32x16_bf16 v[80:95], a[12:15], v[164:167], v[80:95]
    ds_read_b128 v[160:163], v2 offset:18432
    s_cbranch_vccnz Lre_109
Lbk_110:
    ds_write_b128 v199, a[220:223] offset:45056
    v_mfma_f32_32x32x16_bf16 v[96:111], a[12:15], v[168:171], v[96:111]
    ds_read_b128 v[164:167], v2 offset:19456
    s_add_u32 s70, s70, 12288
    buffer_load_dwordx4 a[60:63], v2, s[4:7], s70 offen offset:0 sc1
    s_waitcnt vmcnt(10) lgkmcnt(6)
    v_mfma_f32_32x32x16_bf16 v[64:79], a[16:19], v[172:175], v[64:79]
    ds_read_b128 v[168:171], v2 offset:20480
    v_accvgpr_read_b32 v203, a20
    v_cmp_eq_u32 vcc, -1, v203
    v_mfma_f32_32x32x16_bf16 v[80:95], a[16:19], v[176:179], v[80:95]
    ds_read_b128 v[172:175], v2 offset:21504
    s_cbranch_vccnz Lre_111
Lbk_112:
    v_mfma_f32_32x32x16_bf16 v[96:111], a[16:19], v[180:183], v[96:111]
    ds_read_b128 v[176:179], v2 offset:22528
    buffer_load_dwordx4 a[64:67], v2, s[4:7], s70 offen offset:1024 sc1
    s_waitcnt vmcnt(8) lgkmcnt(6)
    v_mfma_f32_32x32x16_bf16 v[64:79], a[20:23], v[184:187], v[64:79]
    ds_read_b128 v[180:183], v2 offset:23552
    v_accvgpr_read_b32 v203, a24
    v_accvgpr_read_b32 v23, a28
    v_accvgpr_read_b32 v30, a32
    v_max3_u32 v203, v23, v30, v203
    v_cmp_eq_u32 vcc, -1, v203
    v_mfma_f32_32x32x16_bf16 v[80:95], a[20:23], v[188:191], v[80:95]
    s_barrier
    ds_read_b128 v[184:187], v2 offset:24576
    s_cbranch_vccnz Lre_113
Lbk_114:
    buffer_load_dwordx4 a[68:71], v2, s[4:7], s70 offen offset:2048 sc1
    v_mfma_f32_32x32x16_bf16 v[96:111], a[20:23], v[192:195], v[96:111]
    ds_read_b128 v[188:191], v2 offset:25600
    ds_write_b128 v199, a[224:227] offset:49152
    s_waitcnt lgkmcnt(6)
    v_mfma_f32_32x32x16_bf16 v[64:79], a[24:27], v[160:163], v[64:79]
    ds_read_b128 v[192:195], v2 offset:26624
    buffer_load_dwordx4 a[72:75], v2, s[4:7], s70 offen offset:3072 sc1
    s_mul_i32 s56, s24, 256
    s_add_u32 s56, s56, s18
    s_mov_b32 s63, 0
    s_atomic_add s63, s[12:13], s56 glc
    v_mfma_f32_32x32x16_bf16 v[80:95], a[24:27], v[164:167], v[80:95]
    ds_read_b128 v[160:163], v2 offset:27648
    v_mfma_f32_32x32x16_bf16 v[96:111], a[24:27], v[168:171], v[96:111]
Lw_4:
    s_cbranch_execz Lw_5
    ds_read_b128 v[164:167], v2 offset:28672
    s_add_u32 s70, s70, 4096
    buffer_load_dwordx4 a[76:79], v2, s[4:7], s70 offen offset:0 sc1
    s_waitcnt lgkmcnt(6)
    v_mfma_f32_32x32x16_bf16 v[64:79], a[28:31], v[172:175], v[64:79]
    ds_read_b128 v[168:171], v2 offset:29696
    ds_write_b128 v199, a[228:231] offset:53248
    v_mfma_f32_32x32x16_bf16 v[80:95], a[28:31], v[176:179], v[80:95]
    ds_read_b128 v[172:175], v2 offset:30720
    s_add_u32 s70, s70, 12288
    buffer_load_dwordx4 a[80:83], v2, s[4:7], s70 offen offset:0 sc1
    v_mfma_f32_32x32x16_bf16 v[96:111], a[28:31], v[180:183], v[96:111]
    ds_read_b128 v[176:179], v2 offset:31744
    s_waitcnt vmcnt(9) lgkmcnt(6)
    v_mfma_f32_32x32x16_bf16 v[64:79], a[32:35], v[184:187], v[64:79]
    ds_read_b128 v[180:183], v2 offset:32768
    v_accvgpr_read_b32 v203, a36
    v_accvgpr_read_b32 v23, a40
    v_accvgpr_read_b32 v30, a44
    v_max3_u32 v203, v23, v30, v203
    v_cmp_eq_u32 vcc, -1, v203
    v_mfma_f32_32x32x16_bf16 v[80:95], a[32:35], v[188:191], v[80:95]
    ds_read_b128 v[184:187], v2 offset:33792
    s_cbranch_vccnz Lre_115
Lbk_116:
    buffer_load_dwordx4 a[84:87], v2, s[4:7], s70 offen offset:1024 sc1
    v_mfma_f32_32x32x16_bf16 v[96:111], a[32:35], v[192:195], v[96:111]
    ds_read_b128 v[188:191], v2 offset:34816
    s_waitcnt lgkmcnt(6)
    v_mfma_f32_32x32x16_bf16 v[64:79], a[36:39], v[160:163], v[64:79]
    ds_read_b128 v[192:195], v2 offset:35840
    buffer_load_dwordx4 a[88:91], v2, s[4:7], s70 offen offset:2048 sc1
    v_mfma_f32_32x32x16_bf16 v[80:95], a[36:39], v[164:167], v[80:95]
    ds_read_b128 v[160:163], v2 offset:36864
    ds_write_b128 v199, a[232:235] offset:57344
    v_mfma_f32_32x32x16_bf16 v[96:111], a[36:39], v[168:171], v[96:111]
    ds_read_b128 v[164:167], v2 offset:37888
    buffer_load_dwordx4 a[92:95], v2, s[4:7], s70 offen offset:3072 sc1
    s_waitcnt lgkmcnt(6)
    v_mfma_f32_32x32x16_bf16 v[64:79], a[40:43], v[172:175], v[64:79]
    ds_read_b128 v[168:171], v2 offset:38912
    v_mfma_f32_32x32x16_bf16 v[80:95], a[40:43], v[176:179], v[80:95]
    ds_read_b128 v[172:175], v2 offset:39936
    s_add_u32 s70, s70, 4096
    buffer_load_dwordx4 a[96:99], v2, s[4:7], s70 offen offset:0 sc1
    v_mfma_f32_32x32x16_bf16 v[96:111], a[40:43], v[180:183], v[96:111]
    ds_read_b128 v[176:179], v2 offset:40960
    s_waitcnt vmcnt(10) lgkmcnt(6)
    v_mfma_f32_32x32x16_bf16 v[64:79], a[44:47], v[184:187], v[64:79]
    ds_read_b128 v[180:183], v2 offset:41984
    s_add_u32 s70, s70, 12288
    buffer_load_dwordx4 a[100:103], v2, s[4:7], s70 offen offset:0 sc1
    v_accvgpr_read_b32 v203, a48
    v_accvgpr_read_b32 v23, a52
    v_accvgpr_read_b32 v30, a56
    v_max3_u32 v203, v23, v30, v203
    v_cmp_eq_u32 vcc, -1, v203
    v_mfma_f32_32x32x16_bf16 v[80:95], a[44:47], v[188:191], v[80:95]
    ds_read_b128 v[184:187], v2 offset:43008
    s_cbranch_vccnz Lre_117
Lbk_118:
    ds_write_b128 v199, a[236:239] offset:61440
    v_mfma_f32_32x32x16_bf16 v[96:111], a[44:47], v[192:195], v[96:111]
    ds_read_b128 v[188:191], v2 offset:44032
    s_waitcnt lgkmcnt(6)
    v_mfma_f32_32x32x16_bf16 v[64:79], a[48:51], v[160:163], v[64:79]
    ds_read_b128 v[192:195], v2 offset:45056
    buffer_load_dwordx4 a[104:107], v2, s[4:7], s70 offen offset:1024 sc1
    v_mfma_f32_32x32x16_bf16 v[80:95], a[48:51], v[164:167], v[80:95]
    ds_read_b128 v[160:163], v2 offset:46080
    ds_write_b128 v200, a[240:243] offset:0
    v_mfma_f32_32x32x16_bf16 v[96:111], a[48:51], v[168:171], v[96:111]
    ds_read_b128 v[164:167], v2 offset:47104
    buffer_load_dwordx4 a[108:111], v2, s[4:7], s70 offen offset:2048 sc1
Lpoll_119:
    s_mov_b32 s55, 0
Lpoll_119_l:
    s_waitcnt lgkmcnt(0)
    s_bfe_u32 s63, s63, 524296
    s_cmp_ge_u32 s63, 16
    s_cbranch_scc1 Lok_120
    s_mov_b32 s63, 0
    s_atomic_add s63, s[12:13], s56 glc
    s_add_u32 s55, s55, 1
    s_cmp_lt_u32 s55, 400000
    s_cbranch_scc1 Lpoll_119_l
    s_waitcnt lgkmcnt(0)
Lok_120:
    s_add_u32 s44, s17, s28
    s_add_u32 s44, s44, 20971520
    buffer_load_dwordx2 v[56:57], v6, s[4:7], s44 offen offset:0 sc1
    buffer_load_dwordx2 v[58:59], v6, s[4:7], s44 offen offset:256 sc1
    buffer_load_dwordx2 v[60:61], v6, s[4:7], s44 offen offset:512 sc1
    buffer_load_dwordx2 v[62:63], v6, s[4:7], s44 offen offset:768 sc1
    v_mfma_f32_32x32x16_bf16 v[64:79], a[52:55], v[172:175], v[64:79]
    ds_read_b128 v[168:171], v2 offset:48128
    v_mfma_f32_32x32x16_bf16 v[80:95], a[52:55], v[176:179], v[80:95]
    s_barrier
    ds_read_b128 v[172:175], v2 offset:49152
    buffer_load_dwordx4 a[112:115], v2, s[4:7], s70 offen offset:3072 sc1
    v_mfma_f32_32x32x16_bf16 v[96:111], a[52:55], v[180:183], v[96:111]
    ds_read_b128 v[176:179], v2 offset:50176
    s_waitcnt vmcnt(15)
    v_mfma_f32_32x32x16_bf16 v[64:79], a[56:59], v[184:187], v[64:79]
    ds_read_b128 v[180:183], v2 offset:51200
    s_add_u32 s70, s70, 4096
    buffer_load_dwordx4 a[116:119], v2, s[4:7], s70 offen offset:0 sc1
    v_accvgpr_read_b32 v203, a60
    v_accvgpr_read_b32 v23, a64
    v_accvgpr_read_b32 v30, a68
    v_max3_u32 v203, v23, v30, v203
    v_cmp_eq_u32 vcc, -1, v203
    v_mfma_f32_32x32x16_bf16 v[80:95], a[56:59], v[188:191], v[80:95]
    ds_read_b128 v[184:187], v2 offset:52224
    s_cbranch_vccnz Lre_121
Lbk_122:
    ds_write_b128 v200, a[244:247] offset:4096
    v_mfma_f32_32x32x16_bf16 v[96:111], a[56:59], v[192:195], v[96:111]
    ds_read_b128 v[188:191], v2 offset:53248
    s_waitcnt lgkmcnt(6)
    v_mfma_f32_32x32x16_bf16 v[64:79], a[60:63], v[160:163], v[64:79]
    ds_read_b128 v[192:195], v2 offset:54272
    s_add_u32 s70, s70, 12288
    buffer_load_dwordx4 a[120:123], v2, s[4:7], s70 offen offset:0 sc1
    v_mfma_f32_32x32x16_bf16 v[80:95], a[60:63], v[164:167], v[80:95]
    ds_read_b128 v[160:163], v2 offset:55296
    ds_write_b128 v200, a[248:251] offset:8192
    v_mfma_f32_32x32x16_bf16 v[96:111], a[60:63], v[168:171], v[96:111]
    ds_read_b128 v[164:167], v2 offset:56320
    buffer_load_dwordx4 a[124:127], v2, s[4:7], s70 offen offset:1024 sc1
    s_waitcnt lgkmcnt(7)
    v_mfma_f32_32x32x16_bf16 v[64:79], a[64:67], v[172:175], v[64:79]
    ds_read_b128 v[168:171], v2 offset:57344
    v_mfma_f32_32x32x16_bf16 v[80:95], a[64:67], v[176:179], v[80:95]
    ds_read_b128 v[172:175], v2 offset:58368
    buffer_load_dwordx4 a[128:131], v2, s[4:7], s70 offen offset:2048 sc1
    v_mfma_f32_32x32x16_bf16 v[96:111], a[64:67], v[180:183], v[96:111]
    ds_read_b128 v[176:179], v2 offset:59392
    v_mov_b32 v252, 0
    v_mov_b32 v253, 0
    v_mov_b32 v254, 0
    s_waitcnt vmcnt(16) lgkmcnt(6)
    v_mfma_f32_32x32x16_bf16 v[64:79], a[68:71], v[184:187], v[64:79]
    ds_read_b128 v[180:183], v2 offset:60416
    buffer_load_dwordx4 a[132:135], v2, s[4:7], s70 offen offset:3072 sc1
    v_mov_b32 v255, 0
    v_accvgpr_read_b32 v203, a72
    v_accvgpr_read_b32 v23, a76
    v_accvgpr_read_b32 v30, a80
    v_max3_u32 v203, v23, v30, v203
    v_cmp_eq_u32 vcc, -1, v203
    v_mfma_f32_32x32x16_bf16 v[80:95], a[68:71], v[188:191], v[80:95]
    ds_read_b128 v[184:187], v2 offset:61440
    s_cbranch_vccnz Lre_123
Lbk_124:
    ds_write_b128 v200, a[252:255] offset:12288
    v_mfma_f32_32x32x16_bf16 v[96:111], a[68:71], v[192:195], v[96:111]
    ds_read_b128 v[188:191], v2 offset:62464
    s_add_u32 s70, s70, 4096
    buffer_load_dwordx4 a[136:139], v2, s[4:7], s70 offen offset:0 sc1
    s_waitcnt lgkmcnt(6)
    v_mfma_f32_32x32x16_bf16 v[64:79], a[72:75], v[160:163], v[64:79]
    ds_read_b128 v[192:195], v2 offset:63488
    v_mfma_f32_32x32x16_bf16 v[80:95], a[72:75], v[164:167], v[80:95]
    ds_read_b128 v[160:163], v2 offset:64512
    v_mfma_f32_32x32x16_bf16 v[96:111], a[72:75], v[168:171], v[96:111]
    ds_read_b128 v[164:167], v4 offset:0
    s_add_u32 s70, s70, 12288
    buffer_load_dwordx4 a[140:143], v2, s[4:7], s70 offen offset:0 sc1
    s_waitcnt vmcnt(16) lgkmcnt(6)
    v_mfma_f32_32x32x16_bf16 v[64:79], a[76:79], v[172:175], v[64:79]
    ds_read_b128 v[168:171], v4 offset:1024
    v_accvgpr_read_b32 v203, a84
    v_accvgpr_read_b32 v23, a88
    v_accvgpr_read_b32 v30, a92
    v_max3_u32 v203, v23, v30, v203
    v_cmp_eq_u32 vcc, -1, v203
    v_mfma_f32_32x32x16_bf16 v[80:95], a[76:79], v[176:179], v[80:95]
    ds_read_b128 v[172:175], v4 offset:2048
    s_cbranch_vccnz Lre_125
Lbk_126:
    buffer_load_dwordx4 a[144:147], v2, s[4:7], s70 offen offset:1024 sc1
    v_mfma_f32_32x32x16_bf16 v[96:111], a[76:79], v[180:183], v[96:111]
    ds_read_b128 v[176:179], v4 offset:3072
    s_waitcnt lgkmcnt(4)
    v_mfma_f32_32x32x16_bf16 v[64:79], a[80:83], v[184:187], v[64:79]
    ds_read_b128 v[180:183], v4 offset:4096
    buffer_load_dwordx4 a[148:151], v2, s[4:7], s70 offen offset:2048 sc1
    v_mfma_f32_32x32x16_bf16 v[80:95], a[80:83], v[188:191], v[80:95]
    ds_read_b128 v[184:187], v4 offset:5120
    v_mfma_f32_32x32x16_bf16 v[64:79], a[84:87], v[192:195], v[64:79]
    ds_read_b128 v[188:191], v4 offset:6144
    buffer_load_dwordx4 a[152:155], v2, s[4:7], s70 offen offset:3072 sc1
    s_waitcnt vmcnt(11)
    v_add_f32 v248, v56, v58
    v_add_f32 v249, v60, v62
    v_mfma_f32_32x32x16_bf16 v[80:95], a[84:87], v[160:163], v[80:95]
    ds_read_b128 v[192:195], v4 offset:7168
    v_add_f32 v248, v248, v249
    v_mov_b32 v249, v248
    s_nop 1
    v_permlane32_swap_b32 v248, v249
    v_add_f32 v248, v248, v249
    s_waitcnt lgkmcnt(4)
    v_mfma_f32_32x32x16_bf16 v[64:79], a[88:91], v[164:167], v[64:79]
    s_barrier
    ds_read_b128 v[160:163], v4 offset:8192
    s_add_u32 s70, s70, 4096
    buffer_load_dwordx4 a[156:159], v2, s[4:7], s70 offen offset:0 sc1
    v_accvgpr_read_b32 v203, a96
    v_accvgpr_read_b32 v23, a100
    v_accvgpr_read_b32 v30, a104
    v_max3_u32 v203, v23, v30, v203
    v_cmp_eq_u32 vcc, -1, v203
    v_mfma_f32_32x32x16_bf16 v[80:95], a[88:91], v[168:171], v[80:95]
    ds_read_b128 v[164:167], v4 offset:9216
    s_cbranch_vccnz Lre_127
Lbk_128:
    v_mul_f32 v248, 3187671040, v248
    v_add_f32 v249, v56, v248
    v_mul_f32 v249, v249, v249
    v_mfma_f32_32x32x16_bf16 v[64:79], a[92:95], v[172:175], v[64:79]
    ds_read_b128 v[168:171], v4 offset:10240
    v_fmac_f32 v57, 1117782016, v249
    v_add_f32 v249, v58, v248
    v_mul_f32 v249, v249, v249
    v_fmac_f32 v59, 1117782016, v249
    ds_write_b128 v3, v[252:255] offset:21632
    v_mfma_f32_32x32x16_bf16 v[80:95], a[92:95], v[176:179], v[80:95]
    ds_read_b128 v[172:175], v4 offset:11264
    s_add_u32 m0, s84, 147456
    s_add_u32 s59, s20, 147456
    buffer_load_dwordx4 v196, s[4:7], s59 offen offset:0 sc1 lds
    v_add_f32 v249, v60, v248
    v_mul_f32 v249, v249, v249
    v_fmac_f32 v61, 1117782016, v249
    v_add_f32 v249, v62, v248
    s_waitcnt lgkmcnt(5)
    v_mfma_f32_32x32x16_bf16 v[64:79], a[96:99], v[180:183], v[64:79]
    ds_read_b128 v[176:179], v4 offset:12288
    v_mul_f32 v249, v249, v249
    v_fmac_f32 v63, 1117782016, v249
    v_add_f32 v249, v57, v59
    ds_write_b128 v3, v[252:255] offset:22656
    v_accvgpr_read_b32 v203, a108
    v_cmp_eq_u32 vcc, -1, v203
    v_mfma_f32_32x32x16_bf16 v[80:95], a[96:99], v[184:187], v[80:95]
    ds_read_b128 v[180:183], v4 offset:13312
    s_cbranch_vccnz Lre_129
Lbk_130:
    buffer_load_dwordx4 v196, s[4:7], s59 offen offset:1024 sc1 lds
    v_add_f32 v250, v61, v63
    v_add_f32 v249, v249, v250
    v_mov_b32 v250, v249
    v_mfma_f32_32x32x16_bf16 v[64:79], a[100:103], v[188:191], v[64:79]
    ds_read_b128 v[184:187], v4 offset:14336
    v_permlane32_swap_b32 v249, v250
    v_add_f32 v249, v249, v250
    v_mov_b32 v250, 925353388
    v_fmac_f32 v250, 986500301, v249
    v_mfma_f32_32x32x16_bf16 v[80:95], a[100:103], v[192:195], v[80:95]
    ds_read_b128 v[188:191], v4 offset:15360
    s_add_u32 m0, s19, 155648
    s_add_u32 s59, s20, 155648
    buffer_load_dwordx4 v3, s[4:7], s59 offen offset:0 sc1 lds
    v_rsq_f32 v56, v250
    v_cvt_pk_bf16_f32 v249, v248, v248
    v_and_b32 v249, 0xffff0000, v249
    v_sub_f32 v249, v248, v249
    s_waitcnt vmcnt(13) lgkmcnt(5)
    v_mfma_f32_32x32x16_bf16 v[64:79], a[104:107], v[160:163], v[64:79]
    ds_read_b128 v[192:195], v4 offset:16384
    v_cvt_pk_bf16_f32 v52, v248, v249
    v_mov_b32 v53, v52
    v_mov_b32 v54, v52
    v_mov_b32 v55, v52
    v_mfma_f32_32x32x16_bf16 v[80:95], a[104:107], v[164:167], v[80:95]
    ds_read_b128 v[160:163], v4 offset:17408
    s_add_u32 m0, s84, 0
    s_add_u32 s59, s20, 159744
    buffer_load_dwordx4 v196, s[4:7], s59 offen offset:0 sc1 lds
    v_mul_f32 v248, 1069066811, v56
    v_cndmask_b32 v248, v248, v56, s[96:97]
    ds_write_b32 v27, v248
    ds_read_b128 v[208:211], v28 offset:0
    v_mfma_f32_32x32x16_bf16 v[64:79], a[108:111], v[168:171], v[64:79]
    ds_read_b128 v[164:167], v4 offset:18432
    ds_read_b128 v[224:227], v28 offset:128
    ds_read_b128 v[212:215], v28 offset:32
    ds_read_b128 v[228:231], v28 offset:160
    ds_read_b128 v[216:219], v28 offset:64
    v_mfma_f32_32x32x16_bf16 v[80:95], a[108:111], v[172:175], v[80:95]
    ds_read_b128 v[168:171], v4 offset:19456
    buffer_load_dwordx4 v196, s[4:7], s59 offen offset:1024 sc1 lds
    ds_read_b128 v[232:235], v28 offset:192
    ds_read_b128 v[220:223], v28 offset:96
    ds_read_b128 v[236:239], v28 offset:224
    s_waitcnt vmcnt(13) lgkmcnt(13)
    v_mfma_f32_32x32x16_bf16 v[64:79], a[112:115], v[176:179], v[64:79]
    ds_read_b128 v[172:175], v4 offset:20480
    v_mfma_f32_32x32x16_bf16 v[80:95], a[112:115], v[180:183], v[80:95]
    ds_read_b128 v[176:179], v4 offset:21504
    v_mfma_f32_32x32x16_bf16 v[64:79], a[116:119], v[184:187], v[64:79]
    ds_read_b128 v[180:183], v4 offset:22528
    s_add_u32 m0, s84, 36864
    s_add_u32 s59, s21, 0
    buffer_load_dwordx4 v196, s[4:7], s59 offen offset:0 sc1 lds
    v_mfma_f32_32x32x16_bf16 v[80:95], a[116:119], v[188:191], v[80:95]
    ds_read_b128 v[184:187], v4 offset:23552
    s_waitcnt vmcnt(12) lgkmcnt(7)
    v_mfma_f32_32x32x16_bf16 v[64:79], a[120:123], v[192:195], v[64:79]
    ds_read_b128 v[188:191], v4 offset:24576
    buffer_load_dwordx4 v196, s[4:7], s59 offen offset:1024 sc1 lds
    v_mfma_f32_32x32x16_bf16 v[80:95], a[120:123], v[160:163], v[80:95]
    ds_read_b128 v[192:195], v4 offset:25600
    v_mfma_f32_32x32x16_bf16 v[64:79], a[124:127], v[164:167], v[64:79]
    ds_read_b128 v[160:163], v4 offset:26624
    s_add_u32 m0, s84, 45056
    s_add_u32 s59, s21, 8192
    buffer_load_dwordx4 v196, s[4:7], s59 offen offset:0 sc1 lds
    v_mfma_f32_32x32x16_bf16 v[80:95], a[124:127], v[168:171], v[80:95]
    ds_read_b128 v[164:167], v4 offset:27648
    s_waitcnt vmcnt(12) lgkmcnt(4)
    v_mfma_f32_32x32x16_bf16 v[64:79], a[128:131], v[172:175], v[64:79]
    ds_read_b128 v[168:171], v4 offset:28672
    buffer_load_dwordx4 v196, s[4:7], s59 offen offset:1024 sc1 lds
    v_mfma_f32_32x32x16_bf16 v[80:95], a[128:131], v[176:179], v[80:95]
    ds_read_b128 v[172:175], v4 offset:29696
    v_mfma_f32_32x32x16_bf16 v[64:79], a[132:135], v[180:183], v[64:79]
    ds_read_b128 v[176:179], v4 offset:30720
    s_add_u32 m0, s84, 53248
    s_add_u32 s59, s21, 16384
    buffer_load_dwordx4 v196, s[4:7], s59 offen offset:0 sc1 lds
    v_mfma_f32_32x32x16_bf16 v[80:95], a[132:135], v[184:187], v[80:95]
    ds_read_b128 v[180:183], v4 offset:31744
    s_waitcnt vmcnt(12) lgkmcnt(4)
    v_mfma_f32_32x32x16_bf16 v[64:79], a[136:139], v[188:191], v[64:79]
    s_barrier
    ds_read_b128 v[184:187], v4 offset:32768
    v_mfma_f32_32x32x16_bf16 v[80:95], a[136:139], v[192:195], v[80:95]
    ds_read_b128 v[188:191], v4 offset:33792
    buffer_load_dwordx4 v196, s[4:7], s59 offen offset:1024 sc1 lds
    v_mfma_f32_32x32x16_bf16 v[64:79], a[140:143], v[160:163], v[64:79]
    ds_read_b128 v[192:195], v4 offset:34816
    v_mfma_f32_32x32x16_bf16 v[80:95], a[140:143], v[164:167], v[80:95]
    ds_read_b128 v[160:163], v4 offset:35840
    s_add_u32 m0, s84, 61440
    s_add_u32 s59, s21, 24576
    buffer_load_dwordx4 v196, s[4:7], s59 offen offset:0 sc1 lds
    s_waitcnt vmcnt(12) lgkmcnt(4)
    v_mfma_f32_32x32x16_bf16 v[64:79], a[144:147], v[168:171], v[64:79]
    ds_read_b128 v[164:167], v4 offset:36864
    v_mfma_f32_32x32x16_bf16 v[80:95], a[144:147], v[172:175], v[80:95]
    ds_read_b128 v[168:171], v4 offset:37888
    buffer_load_dwordx4 v196, s[4:7], s59 offen offset:1024 sc1 lds
    v_mfma_f32_32x32x16_bf16 v[64:79], a[148:151], v[176:179], v[64:79]
    ds_read_b128 v[172:175], v4 offset:38912
    v_mfma_f32_32x32x16_bf16 v[80:95], a[148:151], v[180:183], v[80:95]
    ds_read_b128 v[176:179], v4 offset:39936
    s_add_u32 m0, s84, 69632
    s_add_u32 s59, s21, 32768
    buffer_load_dwordx4 v196, s[4:7], s59 offen offset:0 sc1 lds
    s_waitcnt lgkmcnt(4)
    v_mfma_f32_32x32x16_bf16 v[64:79], a[152:155], v[184:187], v[64:79]
    ds_read_b128 v[180:183], v4 offset:40960
    v_mfma_f32_32x32x16_bf16 v[80:95], a[152:155], v[188:191], v[80:95]
    ds_read_b128 v[184:187], v4 offset:41984
    buffer_load_dwordx4 v196, s[4:7], s59 offen offset:1024 sc1 lds
    v_mfma_f32_32x32x16_bf16 v[64:79], a[156:159], v[192:195], v[64:79]
    ds_read_b128 v[188:191], v4 offset:43008
    v_mfma_f32_32x32x16_bf16 v[80:95], a[156:159], v[160:163], v[80:95]
    ds_read_b128 v[192:195], v4 offset:44032
    s_waitcnt lgkmcnt(6)
    v_mfma_f32_32x32x16_bf16 v[64:79], v[52:55], v[164:167], v[64:79]
    ds_read_b128 v[160:163], v4 offset:45056
    s_add_u32 m0, s84, 77824
    s_add_u32 s59, s21, 40960
    buffer_load_dwordx4 v196, s[4:7], s59 offen offset:0 sc1 lds
    v_mfma_f32_32x32x16_bf16 v[80:95], v[52:55], v[168:171], v[80:95]
    ds_read_b128 v[164:167], v4 offset:46080
    s_add_u32 s54, s17, s38
    s_mov_b64 exec, s[60:61]
    buffer_store_dwordx2 v[204:205], v201, s[4:7], s54 offen sc1
    s_mov_b64 exec, -1
    s_waitcnt lgkmcnt(5)
    v_mfma_f32_32x32x16_bf16 v[96:111], a[80:83], v[172:175], v[96:111]
    ds_read_b128 v[168:171], v4 offset:47104
    v_mfma_f32_32x32x16_bf16 v[96:111], a[84:87], v[176:179], v[96:111]
    ds_read_b128 v[172:175], v4 offset:48128
    v_mul_f32 v112, v64, v224
    v_mul_f32 v113, v65, v225
    v_mul_f32 v114, v66, v226
    v_mul_f32 v115, v67, v227
    v_mul_f32 v116, v68, v228
    v_mfma_f32_32x32x16_bf16 v[96:111], a[88:91], v[180:183], v[96:111]
    ds_read_b128 v[176:179], v4 offset:49152
    v_exp_f32 v112, v112 clamp
    v_fma_f32 v64, v64, v208, s76
    v_fma_f32 v65, v65, v209, s76
    s_waitcnt lgkmcnt(5)
    v_mfma_f32_32x32x16_bf16 v[96:111], a[92:95], v[184:187], v[96:111]
    ds_read_b128 v[180:183], v4 offset:50176
    s_add_u32 s54, s17, s33
    buffer_store_dwordx4 v[204:207], v7, s[4:7], s54 offen sc1
    v_max_f32 v64, s76, v64
    v_mfma_f32_32x32x16_bf16 v[96:111], a[96:99], v[188:191], v[96:111]
    ds_read_b128 v[184:187], v4 offset:51200
    v_add_f32 v64, v64, v112
    v_exp_f32 v113, v113 clamp
    v_max_f32 v65, s76, v65
    v_fma_f32 v66, v66, v210, s76
    v_mfma_f32_32x32x16_bf16 v[96:111], a[100:103], v[192:195], v[96:111]
    ds_read_b128 v[188:191], v4 offset:52224
    v_add_f32 v65, v65, v113
    v_exp_f32 v114, v114 clamp
    v_max_f32 v66, s76, v66
    s_waitcnt lgkmcnt(5)
    v_mfma_f32_32x32x16_bf16 v[96:111], a[104:107], v[160:163], v[96:111]
    ds_read_b128 v[192:195], v4 offset:53248
    buffer_load_dwordx4 v196, s[4:7], s59 offen offset:1024 sc1 lds
    s_mov_b32 exec_hi, 0
    buffer_store_dwordx4 v[204:207], v7, s[4:7], s54 offen offset:512 sc1
    s_mov_b64 exec, -1
    v_cvt_pk_bf16_f32 v144, v64, v65
    v_mfma_f32_32x32x16_bf16 v[96:111], a[108:111], v[164:167], v[96:111]
    ds_read_b128 v[160:163], v4 offset:54272
    v_add_f32 v66, v66, v114
    v_exp_f32 v115, v115 clamp
    v_fma_f32 v67, v67, v211, s76
    v_fma_f32 v68, v68, v212, s76
    v_mfma_f32_32x32x16_bf16 v[96:111], a[112:115], v[168:171], v[96:111]
    ds_read_b128 v[164:167], v4 offset:55296
    v_max_f32 v67, s76, v67
    v_exp_f32 v116, v116 clamp
    v_max_f32 v68, s76, v68
    s_waitcnt lgkmcnt(5)
    v_mfma_f32_32x32x16_bf16 v[96:111], a[116:119], v[172:175], v[96:111]
    ds_read_b128 v[168:171], v4 offset:56320
    buffer_store_dwordx4 v[204:207], v7, s[4:7], s54 offen offset:768 sc1
    v_add_f32 v67, v67, v115
    v_mfma_f32_32x32x16_bf16 v[96:111], a[120:123], v[176:179], v[96:111]
    s_barrier
    ds_read_b128 v[172:175], v4 offset:57344
    v_cvt_pk_bf16_f32 v145, v66, v67
    v_add_f32 v68, v68, v116
    v_mul_f32 v117, v69, v229
    v_mfma_f32_32x32x16_bf16 v[96:111], a[124:127], v[180:183], v[96:111]
    ds_read_b128 v[176:179], v4 offset:58368
    v_exp_f32 v117, v117 clamp
    v_fma_f32 v69, v69, v213, s76
    v_mul_f32 v118, v70, v230
    s_waitcnt lgkmcnt(5)
    v_mfma_f32_32x32x16_bf16 v[96:111], a[128:131], v[184:187], v[96:111]
    ds_read_b128 v[180:183], v4 offset:59392
    v_max_f32 v69, s76, v69
    v_exp_f32 v118, v118 clamp
    v_fma_f32 v70, v70, v214, s76
    v_mul_f32 v119, v71, v231
    v_mfma_f32_32x32x16_bf16 v[96:111], a[132:135], v[188:191], v[96:111]
    v_add_f32 v69, v69, v117
    v_max_f32 v70, s76, v70
    v_exp_f32 v119, v119 clamp
    v_fma_f32 v71, v71, v215, s76
    v_mul_f32 v112, v72, v232
    v_mfma_f32_32x32x16_bf16 v[96:111], a[136:139], v[192:195], v[96:111]
    v_cvt_pk_bf16_f32 v146, v68, v69
    v_add_f32 v70, v70, v118
    v_max_f32 v71, s76, v71
    v_exp_f32 v112, v112 clamp
    s_waitcnt lgkmcnt(3)
    v_mfma_f32_32x32x16_bf16 v[96:111], a[140:143], v[160:163], v[96:111]
    v_add_f32 v71, v71, v119
    v_fma_f32 v72, v72, v216, s76
    v_mul_f32 v113, v73, v233
    v_mul_f32 v114, v74, v234
    v_mul_f32 v115, v75, v235
    v_mul_f32 v116, v76, v236
    v_mfma_f32_32x32x16_bf16 v[96:111], a[144:147], v[164:167], v[96:111]
    v_cvt_pk_bf16_f32 v147, v70, v71
    v_max_f32 v72, s76, v72
    v_exp_f32 v113, v113 clamp
    v_fma_f32 v73, v73, v217, s76
    v_fma_f32 v74, v74, v218, s76
    v_mfma_f32_32x32x16_bf16 v[96:111], a[148:151], v[168:171], v[96:111]
    v_add_f32 v72, v72, v112
    v_max_f32 v73, s76, v73
    v_exp_f32 v114, v114 clamp
    v_max_f32 v74, s76, v74
    s_waitcnt lgkmcnt(0)
    v_mfma_f32_32x32x16_bf16 v[96:111], a[152:155], v[172:175], v[96:111]
    v_add_f32 v73, v73, v113
    v_add_f32 v74, v74, v114
    v_exp_f32 v115, v115 clamp
    v_fma_f32 v75, v75, v219, s76
    v_fma_f32 v76, v76, v220, s76
    v_mfma_f32_32x32x16_bf16 v[96:111], a[156:159], v[176:179], v[96:111]
    v_cvt_pk_bf16_f32 v148, v72, v73
    v_max_f32 v75, s76, v75
    v_exp_f32 v116, v116 clamp
    v_max_f32 v76, s76, v76
    v_mul_f32 v117, v77, v237
    v_mfma_f32_32x32x16_bf16 v[96:111], v[52:55], v[180:183], v[96:111]
    v_add_f32 v75, v75, v115
    v_add_f32 v76, v76, v116
    v_exp_f32 v117, v117 clamp
    v_fma_f32 v77, v77, v221, s76
    v_mul_f32 v118, v78, v238
    v_cvt_pk_bf16_f32 v149, v74, v75
    v_max_f32 v77, s76, v77
    v_exp_f32 v118, v118 clamp
    v_fma_f32 v78, v78, v222, s76
    v_mul_f32 v119, v79, v239
    v_add_f32 v77, v77, v117
    v_max_f32 v78, s76, v78
    v_exp_f32 v119, v119 clamp
    v_fma_f32 v79, v79, v223, s76
    v_cvt_pk_bf16_f32 v150, v76, v77
    v_add_f32 v78, v78, v118
    v_max_f32 v79, s76, v79
    v_add_f32 v79, v79, v119
    v_cvt_pk_bf16_f32 v151, v78, v79
    v_pk_fma_f32 v[250:251], v[80:81], v[224:225], v[22:23] op_sel_hi:[1,1,0]
    s_add_u32 m0, s86, 86016
    s_add_u32 s59, s21, 49152
    buffer_load_dwordx4 v198, s[4:7], s59 offen offset:0 sc1 lds
    v_pk_fma_f32 v[248:249], v[80:81], v[208:209], v[24:25] op_sel_hi:[1,1,0]
    v_exp_f32 v250, v250 clamp
    v_exp_f32 v251, v251 clamp
    v_max_f32 v248, v26, v248
    v_max_f32 v249, v26, v249
    v_pk_add_f32 v[248:249], v[248:249], v[250:251]
    v_cvt_pk_bf16_f32 v152, v248, v249
    v_pk_fma_f32 v[254:255], v[82:83], v[226:227], v[22:23] op_sel_hi:[1,1,0]
    v_pk_fma_f32 v[252:253], v[82:83], v[210:211], v[24:25] op_sel_hi:[1,1,0]
    v_exp_f32 v254, v254 clamp
    v_exp_f32 v255, v255 clamp
    v_max_f32 v252, v26, v252
    v_max_f32 v253, v26, v253
    v_pk_add_f32 v[252:253], v[252:253], v[254:255]
    v_cvt_pk_bf16_f32 v153, v252, v253
    v_pk_fma_f32 v[250:251], v[84:85], v[228:229], v[22:23] op_sel_hi:[1,1,0]
    v_pk_fma_f32 v[248:249], v[84:85], v[212:213], v[24:25] op_sel_hi:[1,1,0]
    v_exp_f32 v250, v250 clamp
    v_exp_f32 v251, v251 clamp
    v_max_f32 v248, v26, v248
    v_max_f32 v249, v26, v249
    v_pk_add_f32 v[248:249], v[248:249], v[250:251]
    v_cvt_pk_bf16_f32 v154, v248, v249
    v_pk_fma_f32 v[254:255], v[86:87], v[230:231], v[22:23] op_sel_hi:[1,1,0]
    v_pk_fma_f32 v[252:253], v[86:87], v[214:215], v[24:25] op_sel_hi:[1,1,0]
    v_exp_f32 v254, v254 clamp
    v_exp_f32 v255, v255 clamp
    v_max_f32 v252, v26, v252
    v_max_f32 v253, v26, v253
    v_pk_add_f32 v[252:253], v[252:253], v[254:255]
    v_cvt_pk_bf16_f32 v155, v252, v253
    v_pk_fma_f32 v[250:251], v[88:89], v[232:233], v[22:23] op_sel_hi:[1,1,0]
    v_pk_fma_f32 v[248:249], v[88:89], v[216:217], v[24:25] op_sel_hi:[1,1,0]
    v_exp_f32 v250, v250 clamp
    v_exp_f32 v251, v251 clamp
    v_max_f32 v248, v26, v248
    v_max_f32 v249, v26, v249
    v_pk_add_f32 v[248:249], v[248:249], v[250:251]
    v_cvt_pk_bf16_f32 v156, v248, v249
    v_pk_fma_f32 v[254:255], v[90:91], v[234:235], v[22:23] op_sel_hi:[1,1,0]
    v_pk_fma_f32 v[252:253], v[90:91], v[218:219], v[24:25] op_sel_hi:[1,1,0]
    v_exp_f32 v254, v254 clamp
    v_exp_f32 v255, v255 clamp
    v_max_f32 v252, v26, v252
    v_max_f32 v253, v26, v253
    v_pk_add_f32 v[252:253], v[252:253], v[254:255]
    v_cvt_pk_bf16_f32 v157, v252, v253
    v_pk_fma_f32 v[250:251], v[92:93], v[236:237], v[22:23] op_sel_hi:[1,1,0]
    v_pk_fma_f32 v[248:249], v[92:93], v[220:221], v[24:25] op_sel_hi:[1,1,0]
    v_exp_f32 v250, v250 clamp
    v_exp_f32 v251, v251 clamp
    v_max_f32 v248, v26, v248
    v_max_f32 v249, v26, v249
    v_pk_add_f32 v[248:249], v[248:249], v[250:251]
    v_cvt_pk_bf16_f32 v158, v248, v249
    v_pk_fma_f32 v[254:255], v[94:95], v[238:239], v[22:23] op_sel_hi:[1,1,0]
    v_pk_fma_f32 v[252:253], v[94:95], v[222:223], v[24:25] op_sel_hi:[1,1,0]
    v_exp_f32 v254, v254 clamp
    v_exp_f32 v255, v255 clamp
    v_max_f32 v252, v26, v252
    v_max_f32 v253, v26, v253
    v_pk_add_f32 v[252:253], v[252:253], v[254:255]
    v_cvt_pk_bf16_f32 v159, v252, v253
    s_mov_b32 exec_lo, 0xff000000
    s_mov_b32 exec_hi, 0xff000000
    v_mov_b32 v152, 0x3f803f80
    v_mov_b32 v153, 0x3f803f80
    v_mov_b32 v154, 0x3f803f80
    v_mov_b32 v155, 0x3f803f80
    v_mov_b32 v156, 0x3f803f80
    v_mov_b32 v157, 0x3f803f80
    v_mov_b32 v158, 0x3f803f80
    v_mov_b32 v159, 0x3f803f80
    s_mov_b64 exec, -1
    v_mfma_f32_32x32x16_bf16 v[64:79], v[144:147], v[152:155], 0
    v_mul_f32 v96, v96, v208
    v_mul_f32 v97, v97, v209
    v_mul_f32 v98, v98, v210
    v_mul_f32 v99, v99, v211
Lw_5:
    s_cbranch_execz Lw_6
    v_cvt_pk_bf16_f32 v240, v96, v97
    v_cvt_pk_bf16_f32 v241, v98, v99
    v_mfma_f32_32x32x16_bf16 v[64:79], v[148:151], v[156:159], v[64:79]
    v_mul_f32 v100, v100, v212
    v_mul_f32 v101, v101, v213
    v_mul_f32 v102, v102, v214
    v_mul_f32 v103, v103, v215
    v_cvt_pk_bf16_f32 v242, v100, v101
    v_cvt_pk_bf16_f32 v243, v102, v103
    v_mfma_f32_32x32x16_bf16 v[128:143], v[152:155], v[152:155], 0
    v_mul_f32 v104, v104, v216
    v_mul_f32 v105, v105, v217
    v_mul_f32 v106, v106, v218
    v_mul_f32 v107, v107, v219
    v_cvt_pk_bf16_f32 v244, v104, v105
    v_cvt_pk_bf16_f32 v245, v106, v107
    v_mfma_f32_32x32x16_bf16 v[128:143], v[156:159], v[156:159], v[128:143]
    v_mul_f32 v108, v108, v220
    v_mul_f32 v109, v109, v221
    v_mul_f32 v110, v110, v222
    v_mul_f32 v111, v111, v223
    v_cvt_pk_bf16_f32 v246, v108, v109
    v_cvt_pk_bf16_f32 v247, v110, v111
    v_mfma_f32_32x32x16_bf16 v[80:95], v[144:147], v[240:243], 0
    s_mov_b32 exec_lo, 0x1000000
    s_mov_b32 exec_hi, 0x1000000
    ds_write_b128 v14, v[64:67] offset:0
    s_mov_b64 exec, -1
    v_mfma_f32_32x32x16_bf16 v[80:95], v[148:151], v[244:247], v[80:95]
    s_mov_b32 exec_lo, 0x1000000
    s_mov_b32 exec_hi, 0x1000000
    ds_write_b128 v14, v[68:71] offset:32
    s_mov_b64 exec, -1
    v_mfma_f32_32x32x16_bf16 v[96:111], v[152:155], v[240:243], 0
    s_mov_b32 exec_lo, 0x1000000
    s_mov_b32 exec_hi, 0x100ff00
    ds_write_b128 v14, v[72:75] offset:64
    s_mov_b64 exec, -1
    v_mfma_f32_32x32x16_bf16 v[96:111], v[156:159], v[244:247], v[96:111]
    s_mov_b32 exec_lo, 0x100ff00
    s_mov_b32 exec_hi, 0x100ff00
    ds_write_b128 v14, v[76:79] offset:96
    s_mov_b32 exec_lo, 0x100ff00
    s_mov_b32 exec_hi, 0x100ff00
    ds_write_b128 v14, v[128:131] offset:128
    s_mov_b32 exec_lo, 0xfffff
    s_mov_b32 exec_hi, 0xfffff
    ds_write_b128 v13, v[80:83] offset:0
    s_mov_b32 exec_lo, 0xfffff
    s_mov_b32 exec_hi, 0xfffff
    ds_write_b128 v13, v[84:87] offset:32
    s_mov_b32 exec_lo, 0xfffff
    s_mov_b32 exec_hi, 0xfff00000
    ds_write_b128 v13, v[88:91] offset:64
    s_mov_b32 exec_lo, 0xfff00000
    s_mov_b32 exec_hi, 0xfff00000
    ds_write_b128 v13, v[92:95] offset:96
    s_mov_b32 exec_lo, 0xfff00000
    s_mov_b32 exec_hi, 0xfff00000
    ds_write_b128 v13, v[96:99] offset:128
    s_mov_b64 exec, -1
    s_waitcnt lgkmcnt(0)
    s_waitcnt vmcnt(17)
    s_barrier
    ds_read_b128 v[64:67], v3 offset:8192
    ds_read_b128 v[68:71], v3 offset:11552
    ds_read_b128 v[72:75], v3 offset:14912
    ds_read_b128 v[76:79], v3 offset:18272
    s_add_u32 s44, s17, s38
    ds_read_b128 v[160:163], v4 offset:60416
    ds_read_b128 v[164:167], v4 offset:61440
    ds_read_b128 v[168:171], v4 offset:62464
    ds_read_b128 v[172:175], v4 offset:63488
    ds_read_b128 v[176:179], v4 offset:64512
    ds_read_b128 v[180:183], v5 offset:0
    ds_read_b128 v[184:187], v5 offset:1024
    ds_read_b128 v[188:191], v5 offset:2048
    s_waitcnt lgkmcnt(8)
    v_pk_add_f32 v[64:65], v[64:65], v[68:69]
    v_pk_add_f32 v[66:67], v[66:67], v[70:71]
    v_pk_add_f32 v[72:73], v[72:73], v[76:77]
    v_pk_add_f32 v[74:75], v[74:75], v[78:79]
    v_pk_add_f32 v[64:65], v[64:65], v[72:73]
    v_pk_add_f32 v[66:67], v[66:67], v[74:75]
    v_cvt_pk_bf16_f32 v68, v64, v65
    v_cvt_pk_bf16_f32 v69, v66, v67
    s_waitcnt vmcnt(5)
    s_mov_b64 exec, s[60:61]
    buffer_store_dwordx2 v[68:69], v201, s[4:7], s44 offen sc1
    s_mul_i32 s57, s41, 256
    s_add_u32 s57, s57, s18
    s_add_u32 s57, s57, 16384
    s_atomic_add s62, s[12:13], s57
    s_mov_b32 exec_lo, 0xff0000
    s_mov_b32 exec_hi, 0xff0000
    ds_write_b64 v19, v[152:153] offset:0
    ds_write_b64 v19, v[154:155] offset:16
    ds_write_b64 v19, v[156:157] offset:32
    ds_write_b64 v19, v[158:159] offset:48
    s_mov_b64 exec, -1
    s_waitcnt lgkmcnt(9)
    v_mfma_f32_32x32x16_bf16 v[112:127], a[0:3], v[160:163], 0
    ds_read_b128 v[192:195], v5 offset:3072
    buffer_load_dwordx4 v198, s[4:7], s59 offen offset:1024 sc1 lds
    v_mfma_f32_32x32x16_bf16 v[112:127], a[4:7], v[164:167], v[112:127]
    ds_read_b128 v[160:163], v5 offset:4096
    v_mfma_f32_32x32x16_bf16 v[112:127], a[8:11], v[168:171], v[112:127]
    ds_read_b128 v[164:167], v5 offset:5120
    s_add_u32 s54, s17, s31
    s_add_u32 s54, s54, 4194304
    buffer_store_dwordx4 v[204:207], v9, s[4:7], s54 offen sc1
    s_waitcnt lgkmcnt(9)
    v_mfma_f32_32x32x16_bf16 v[112:127], a[12:15], v[172:175], v[112:127]
    ds_read_b128 v[168:171], v5 offset:6144
    v_mfma_f32_32x32x16_bf16 v[112:127], a[16:19], v[176:179], v[112:127]
    ds_read_b128 v[172:175], v5 offset:7168
    v_and_b32 v108, 1, v1
    v_mfma_f32_32x32x16_bf16 v[112:127], a[20:23], v[180:183], v[112:127]
    ds_read_b128 v[176:179], v5 offset:8192
    buffer_store_dwordx4 v[204:207], v9, s[4:7], s54 offen offset:2048 sc1
    s_waitcnt lgkmcnt(5)
    v_mfma_f32_32x32x16_bf16 v[112:127], a[24:27], v[184:187], v[112:127]
    ds_read_b128 v[180:183], v5 offset:9216
    v_lshlrev_b32 v108, 4, v108
    v_mfma_f32_32x32x16_bf16 v[112:127], a[28:31], v[188:191], v[112:127]
    ds_read_b128 v[184:187], v5 offset:10240
    v_mov_b32 v109, 0x3f80
    v_mfma_f32_32x32x16_bf16 v[112:127], a[32:35], v[192:195], v[112:127]
    ds_read_b128 v[188:191], v5 offset:11264
    s_mov_b32 exec_lo, 0xffff
    s_mov_b32 exec_hi, 0xffff
    buffer_store_dwordx4 v[204:207], v10, s[4:7], s54 offen sc1
    s_mov_b64 exec, -1
    s_waitcnt lgkmcnt(5)
    v_mfma_f32_32x32x16_bf16 v[112:127], a[36:39], v[160:163], v[112:127]
    ds_read_b128 v[192:195], v5 offset:12288
    v_lshlrev_b32 v108, v108, v109
    v_mfma_f32_32x32x16_bf16 v[112:127], a[40:43], v[164:167], v[112:127]
    ds_read_b128 v[160:163], v5 offset:13312
    buffer_load_dwordx4 v198, s[4:7], s59 offen offset:2048 sc1 lds
    v_bfe_u32 v109, v1, 1, 4
    v_mfma_f32_32x32x16_bf16 v[112:127], a[44:47], v[168:171], v[112:127]
    ds_read_b128 v[164:167], v5 offset:14336
    v_cmp_eq_u32 vcc, 0, v109
    s_waitcnt lgkmcnt(5)
    v_mfma_f32_32x32x16_bf16 v[112:127], a[48:51], v[172:175], v[112:127]
    ds_read_b128 v[168:171], v5 offset:15360
    buffer_load_dwordx4 v198, s[4:7], s59 offen offset:3072 sc1 lds
    v_cndmask_b32 v104, 0, v108, vcc
    v_mfma_f32_32x32x16_bf16 v[112:127], a[52:55], v[176:179], v[112:127]
    ds_read_b128 v[172:175], v5 offset:16384
    v_cmp_eq_u32 vcc, 1, v109
    v_mfma_f32_32x32x16_bf16 v[112:127], a[56:59], v[180:183], v[112:127]
    ds_read_b128 v[176:179], v5 offset:17408
    v_cndmask_b32 v105, 0, v108, vcc
    s_waitcnt lgkmcnt(5)
    v_mfma_f32_32x32x16_bf16 v[112:127], a[60:63], v[184:187], v[112:127]
    ds_read_b128 v[180:183], v5 offset:18432
    s_add_u32 m0, s86, 102400
    s_add_u32 s59, s21, 65536
    buffer_load_dwordx4 v198, s[4:7], s59 offen offset:0 sc1 lds
    v_mfma_f32_32x32x16_bf16 v[112:127], a[64:67], v[188:191], v[112:127]
    s_barrier
    ds_read_b128 v[184:187], v5 offset:19456
    v_cmp_eq_u32 vcc, 2, v109
    v_mfma_f32_32x32x16_bf16 v[112:127], a[68:71], v[192:195], v[112:127]
    ds_read_b128 v[188:191], v5 offset:20480
    buffer_load_dwordx4 v198, s[4:7], s59 offen offset:1024 sc1 lds
    v_cndmask_b32 v106, 0, v108, vcc
    s_waitcnt lgkmcnt(5)
    v_mfma_f32_32x32x16_bf16 v[112:127], a[72:75], v[160:163], v[112:127]
    ds_read_b128 v[192:195], v5 offset:21504
    s_mul_i32 s56, s41, 256
    s_add_u32 s56, s56, s18
    s_add_u32 s56, s56, 16384
    s_mov_b32 s63, 0
    s_atomic_add s63, s[12:13], s56 glc
    v_mfma_f32_32x32x16_bf16 v[112:127], a[76:79], v[164:167], v[112:127]
    ds_read_b128 v[160:163], v5 offset:22528
    v_cmp_eq_u32 vcc, 3, v109
    v_mfma_f32_32x32x16_bf16 v[112:127], a[80:83], v[168:171], v[112:127]
    ds_read_b128 v[164:167], v5 offset:23552
    buffer_load_dwordx4 v198, s[4:7], s59 offen offset:2048 sc1 lds
    v_cndmask_b32 v107, 0, v108, vcc
    s_waitcnt lgkmcnt(5)
    v_mfma_f32_32x32x16_bf16 v[112:127], a[84:87], v[172:175], v[112:127]
    ds_read_b128 v[168:171], v5 offset:24576
    v_mfma_f32_32x32x16_bf16 v[112:127], a[88:91], v[176:179], v[112:127]
    ds_read_b128 v[172:175], v5 offset:25600
    buffer_load_dwordx4 v198, s[4:7], s59 offen offset:3072 sc1 lds
    v_mfma_f32_32x32x16_bf16 v[112:127], a[92:95], v[180:183], v[112:127]
    ds_read_b128 v[176:179], v5 offset:26624
    s_waitcnt lgkmcnt(5)
    v_mfma_f32_32x32x16_bf16 v[112:127], a[96:99], v[184:187], v[112:127]
    ds_read_b128 v[180:183], v5 offset:27648
    s_add_u32 m0, s86, 118784
    s_add_u32 s59, s21, 81920
    buffer_load_dwordx4 v198, s[4:7], s59 offen offset:0 sc1 lds
    v_mfma_f32_32x32x16_bf16 v[112:127], a[100:103], v[188:191], v[112:127]
    ds_read_b128 v[184:187], v2 offset:0
    v_mfma_f32_32x32x16_bf16 v[112:127], a[104:107], v[192:195], v[112:127]
    ds_read_b128 v[188:191], v2 offset:1024
    s_waitcnt lgkmcnt(5)
    v_mfma_f32_32x32x16_bf16 v[112:127], a[108:111], v[160:163], v[112:127]
    ds_read_b128 v[192:195], v2 offset:2048
    buffer_load_dwordx4 v198, s[4:7], s59 offen offset:1024 sc1 lds
    v_mfma_f32_32x32x16_bf16 v[112:127], a[112:115], v[164:167], v[112:127]
    ds_read_b128 v[160:163], v2 offset:3072
    v_mfma_f32_32x32x16_bf16 v[112:127], a[116:119], v[168:171], v[112:127]
    ds_read_b128 v[164:167], v2 offset:4096
    buffer_load_dwordx4 v198, s[4:7], s59 offen offset:2048 sc1 lds
    s_waitcnt lgkmcnt(5)
    v_mfma_f32_32x32x16_bf16 v[112:127], a[120:123], v[172:175], v[112:127]
    ds_read_b128 v[168:171], v2 offset:5120
    v_mfma_f32_32x32x16_bf16 v[112:127], a[124:127], v[176:179], v[112:127]
    ds_read_b128 v[172:175], v2 offset:6144
    v_mfma_f32_32x32x16_bf16 v[112:127], a[128:131], v[180:183], v[112:127]
    ds_read_b128 v[176:179], v2 offset:7168
    buffer_load_dwordx4 v198, s[4:7], s59 offen offset:3072 sc1 lds
    s_waitcnt lgkmcnt(5)
    v_mfma_f32_32x32x16_bf16 v[112:127], a[132:135], v[184:187], v[112:127]
    v_mfma_f32_32x32x16_bf16 v[112:127], a[136:139], v[188:191], v[112:127]
    s_add_u32 m0, s19, 135168
    s_add_u32 s59, s21, 98304
    buffer_load_dwordx4 v3, s[4:7], s59 offen offset:0 sc1 lds
    v_mfma_f32_32x32x16_bf16 v[112:127], a[140:143], v[192:195], v[112:127]
    s_waitcnt lgkmcnt(2)
    v_mfma_f32_32x32x16_bf16 v[112:127], a[144:147], v[160:163], v[112:127]
    s_add_u32 m0, s19, 139264
    s_add_u32 s59, s22, 0
    buffer_load_dwordx4 v3, s[4:7], s59 offen offset:0 sc1 lds
    v_mfma_f32_32x32x16_bf16 v[112:127], a[148:151], v[164:167], v[112:127]
    v_mfma_f32_32x32x16_bf16 v[112:127], a[152:155], v[168:171], v[112:127]
    s_waitcnt lgkmcnt(0)
    v_mfma_f32_32x32x16_bf16 v[112:127], a[156:159], v[172:175], v[112:127]
    v_mfma_f32_32x32x16_bf16 v[112:127], v[52:55], v[176:179], v[112:127]
Lpoll_131:
    s_mov_b32 s55, 0
Lpoll_131_l:
    s_waitcnt lgkmcnt(0)
    s_bfe_u32 s63, s63, 524288
    s_cmp_ge_u32 s63, 16
    s_cbranch_scc1 Lok_132
    s_mov_b32 s63, 0
    s_atomic_add s63, s[12:13], s56 glc
    s_add_u32 s55, s55, 1
    s_cmp_lt_u32 s55, 400000
    s_cbranch_scc1 Lpoll_131_l
    s_waitcnt lgkmcnt(0)
Lok_132:
    s_add_u32 s44, s17, s39
    s_mov_b64 exec, s[88:89]
    buffer_load_dwordx4 v[72:75], v202, s[4:7], s44 offen sc1
    s_add_u32 s44, s44, 3584
    buffer_load_dwordx4 v[76:79], v202, s[4:7], s44 offen sc1
    s_add_u32 s44, s44, 3584
    buffer_load_dwordx4 v[80:83], v202, s[4:7], s44 offen sc1
    s_add_u32 s44, s44, 3584
    buffer_load_dwordx4 v[84:87], v202, s[4:7], s44 offen sc1
    s_add_u32 s44, s44, 3584
    buffer_load_dwordx4 v[88:91], v202, s[4:7], s44 offen sc1
    s_add_u32 s44, s44, 3584
    buffer_load_dwordx4 v[92:95], v202, s[4:7], s44 offen sc1
    s_add_u32 s44, s44, 3584
    buffer_load_dwordx4 v[96:99], v202, s[4:7], s44 offen sc1
    s_add_u32 s44, s44, 3584
    buffer_load_dwordx4 v[100:103], v202, s[4:7], s44 offen sc1
    s_mov_b64 exec, -1
    v_pk_mul_f32 v[250:251], v[112:113], v[224:225]
    v_pk_fma_f32 v[248:249], v[112:113], v[208:209], s[76:77]
    v_exp_f32 v250, v250 clamp
    v_exp_f32 v251, v251 clamp
    v_max_f32 v248, s76, v248
    v_max_f32 v249, s76, v249
    v_pk_add_f32 v[248:249], v[248:249], v[250:251]
    v_cvt_pk_bf16_f32 v144, v248, v249
    v_pk_mul_f32 v[254:255], v[114:115], v[226:227]
    v_pk_fma_f32 v[252:253], v[114:115], v[210:211], s[76:77]
    v_exp_f32 v254, v254 clamp
    v_exp_f32 v255, v255 clamp
    v_max_f32 v252, s76, v252
    s_add_u32 s58, s22, 77824
    buffer_load_dwordx4 a[80:83], v3, s[4:7], s58 offen sc1
    v_max_f32 v253, s76, v253
    v_pk_add_f32 v[252:253], v[252:253], v[254:255]
    v_cvt_pk_bf16_f32 v145, v252, v253
    v_pk_mul_f32 v[250:251], v[116:117], v[228:229]
    v_pk_fma_f32 v[248:249], v[116:117], v[212:213], s[76:77]
    v_exp_f32 v250, v250 clamp
    v_exp_f32 v251, v251 clamp
    v_max_f32 v248, s76, v248
    v_max_f32 v249, s76, v249
    v_pk_add_f32 v[248:249], v[248:249], v[250:251]
    v_cvt_pk_bf16_f32 v146, v248, v249
    v_pk_mul_f32 v[254:255], v[118:119], v[230:231]
    v_pk_fma_f32 v[252:253], v[118:119], v[214:215], s[76:77]
    v_exp_f32 v254, v254 clamp
    v_exp_f32 v255, v255 clamp
    v_max_f32 v252, s76, v252
    s_add_u32 s58, s22, 81920
    buffer_load_dwordx4 a[84:87], v3, s[4:7], s58 offen sc1
    v_max_f32 v253, s76, v253
    v_pk_add_f32 v[252:253], v[252:253], v[254:255]
    v_cvt_pk_bf16_f32 v147, v252, v253
    v_pk_mul_f32 v[250:251], v[120:121], v[232:233]
    v_pk_fma_f32 v[248:249], v[120:121], v[216:217], s[76:77]
    v_exp_f32 v250, v250 clamp
    v_exp_f32 v251, v251 clamp
    v_max_f32 v248, s76, v248
    v_max_f32 v249, s76, v249
    v_pk_add_f32 v[248:249], v[248:249], v[250:251]
    v_cvt_pk_bf16_f32 v148, v248, v249
    v_pk_mul_f32 v[254:255], v[122:123], v[234:235]
    v_pk_fma_f32 v[252:253], v[122:123], v[218:219], s[76:77]
    v_exp_f32 v254, v254 clamp
    v_exp_f32 v255, v255 clamp
    v_max_f32 v252, s76, v252
    s_add_u32 s58, s22, 86016
    buffer_load_dwordx4 a[88:91], v3, s[4:7], s58 offen sc1
    v_max_f32 v253, s76, v253
    v_pk_add_f32 v[252:253], v[252:253], v[254:255]
    v_cvt_pk_bf16_f32 v149, v252, v253
    v_pk_mul_f32 v[250:251], v[124:125], v[236:237]
    v_pk_fma_f32 v[248:249], v[124:125], v[220:221], s[76:77]
    v_exp_f32 v250, v250 clamp
    v_exp_f32 v251, v251 clamp
    v_max_f32 v248, s76, v248
    v_max_f32 v249, s76, v249
    v_pk_add_f32 v[248:249], v[248:249], v[250:251]
    v_cvt_pk_bf16_f32 v150, v248, v249
    v_pk_mul_f32 v[254:255], v[126:127], v[238:239]
    v_pk_fma_f32 v[252:253], v[126:127], v[222:223], s[76:77]
    v_exp_f32 v254, v254 clamp
    v_exp_f32 v255, v255 clamp
    v_max_f32 v252, s76, v252
    s_add_u32 s58, s22, 90112
    buffer_load_dwordx4 a[92:95], v3, s[4:7], s58 offen sc1
    v_max_f32 v253, s76, v253
    v_pk_add_f32 v[252:253], v[252:253], v[254:255]
    v_cvt_pk_bf16_f32 v151, v252, v253
    ds_write_b64 v18, v[144:145] offset:0
    ds_write_b64 v18, v[146:147] offset:16
    ds_write_b64 v18, v[148:149] offset:32
    ds_write_b64 v18, v[150:151] offset:48
    ds_read_b64_tr_b16 v[144:145], v20 offset:0
    ds_read_b64_tr_b16 v[146:147], v20 offset:288
    ds_read_b64_tr_b16 v[148:149], v20 offset:1152
    ds_read_b64_tr_b16 v[150:151], v20 offset:1440
    ds_read_b64_tr_b16 v[152:153], v21 offset:0
    ds_read_b64_tr_b16 v[154:155], v21 offset:288
    s_add_u32 s58, s22, 94208
    buffer_load_dwordx4 a[96:99], v3, s[4:7], s58 offen sc1
    s_add_u32 s58, s22, 98304
    buffer_load_dwordx4 a[100:103], v3, s[4:7], s58 offen sc1
    s_mov_b32 s99, 0
Lkvsum_133:
    s_waitcnt vmcnt(12)
    v_mfma_f32_32x32x16_bf16 v[128:143], v[104:107], v[72:75], 0
    s_add_u32 s58, s22, 102400
    buffer_load_dwordx4 a[104:107], v3, s[4:7], s58 offen sc1
    v_max_u32 v112, v72, v74
    v_mfma_f32_32x32x16_bf16 v[128:143], v[104:107], v[76:79], v[128:143]
    s_add_u32 s58, s22, 106496
    buffer_load_dwordx4 a[108:111], v3, s[4:7], s58 offen sc1
    v_max3_u32 v112, v76, v78, v112
    s_waitcnt vmcnt(12)
    v_mfma_f32_32x32x16_bf16 v[128:143], v[104:107], v[80:83], v[128:143]
    s_add_u32 s58, s22, 110592
    buffer_load_dwordx4 a[112:115], v3, s[4:7], s58 offen sc1
    v_max3_u32 v112, v80, v82, v112
    v_mfma_f32_32x32x16_bf16 v[128:143], v[104:107], v[84:87], v[128:143]
    s_add_u32 s58, s22, 114688
    buffer_load_dwordx4 a[116:119], v3, s[4:7], s58 offen sc1
    v_max3_u32 v112, v84, v86, v112
    s_waitcnt vmcnt(12)
    v_mfma_f32_32x32x16_bf16 v[128:143], v[104:107], v[88:91], v[128:143]
    s_add_u32 s58, s22, 118784
    buffer_load_dwordx4 a[120:123], v3, s[4:7], s58 offen sc1
    v_max3_u32 v112, v88, v90, v112
    v_mfma_f32_32x32x16_bf16 v[128:143], v[104:107], v[92:95], v[128:143]
    s_add_u32 s58, s22, 122880
    buffer_load_dwordx4 a[124:127], v3, s[4:7], s58 offen sc1
    v_max3_u32 v112, v92, v94, v112
    s_waitcnt vmcnt(12)
    v_mfma_f32_32x32x16_bf16 v[128:143], v[104:107], v[96:99], v[128:143]
    s_add_u32 s58, s22, 126976
    buffer_load_dwordx4 a[128:131], v3, s[4:7], s58 offen sc1
    v_max3_u32 v112, v96, v98, v112
    v_mfma_f32_32x32x16_bf16 v[128:143], v[104:107], v[100:103], v[128:143]
    s_add_u32 s58, s22, 131072
    buffer_load_dwordx4 a[132:135], v3, s[4:7], s58 offen sc1
    v_max3_u32 v112, v100, v102, v112
    v_cmp_eq_u32 vcc, -1, v112
    s_nop 1
    s_and_b64 vcc, vcc, s[88:89]
    s_cbranch_scc1 Lkvre_134
Lkvre_134_b:
    s_nop 3
    v_cvt_pk_bf16_f32 v68, v128, v129
    v_cvt_pk_bf16_f32 v69, v130, v131
    s_mov_b64 exec, s[88:89]
    ds_write_b64 v15, v[68:69]
    s_mov_b64 exec, -1
    s_waitcnt lgkmcnt(0)
    s_barrier
    ds_read_b128 v[220:223], v17 offset:0
    ds_read_b128 v[224:227], v17 offset:32
    ds_read_b128 v[228:231], v17 offset:64
    ds_read_b128 v[208:211], v16 offset:0
    ds_read_b128 v[212:215], v16 offset:32
    ds_read_b128 v[216:219], v16 offset:64
    s_waitcnt lgkmcnt(5)
    v_mfma_f32_32x32x16_bf16 v[80:95], v[220:223], v[144:147], 0
    s_waitcnt lgkmcnt(4)
    v_mfma_f32_32x32x16_bf16 v[80:95], v[224:227], v[148:151], v[80:95]
    s_waitcnt lgkmcnt(3)
    v_mfma_f32_32x32x16_bf16 v[80:95], v[228:231], v[152:155], v[80:95]
    s_waitcnt lgkmcnt(2)
    v_mfma_f32_32x32x16_bf16 v[64:79], v[208:211], v[144:147], 0
    s_waitcnt lgkmcnt(1)
    v_mfma_f32_32x32x16_bf16 v[64:79], v[212:215], v[148:151], v[64:79]
    s_waitcnt lgkmcnt(0)
    v_mfma_f32_32x32x16_bf16 v[64:79], v[216:219], v[152:155], v[64:79]
    s_add_u32 s44, s17, s33
    s_nop 4
    v_add_f32 v232, s76, v88
    v_add_f32 v234, s76, v89
    v_rcp_f32 v232, v232
    v_rcp_f32 v234, v234
    v_pk_mul_f32 v[80:81], v[80:81], v[232:233] op_sel_hi:[1,0]
    v_pk_mul_f32 v[82:83], v[82:83], v[232:233] op_sel_hi:[1,0]
    v_pk_mul_f32 v[84:85], v[84:85], v[234:235] op_sel_hi:[1,0]
    v_pk_mul_f32 v[86:87], v[86:87], v[234:235] op_sel_hi:[1,0]
    v_cvt_pk_bf16_f32 v244, v80, v81
    v_cvt_pk_bf16_f32 v245, v82, v83
    v_cvt_pk_bf16_f32 v246, v84, v85
    v_cvt_pk_bf16_f32 v247, v86, v87
    s_mov_b32 exec_hi, 0
    buffer_store_dwordx4 v[244:247], v7, s[4:7], s44 offen offset:512 sc1
    s_mov_b64 exec, -1
    v_pk_mul_f32 v[64:65], v[64:65], v[232:233] op_sel_hi:[1,0]
    v_pk_mul_f32 v[66:67], v[66:67], v[232:233] op_sel_hi:[1,0]
    v_pk_mul_f32 v[68:69], v[68:69], v[232:233] op_sel_hi:[1,0]
    v_pk_mul_f32 v[70:71], v[70:71], v[232:233] op_sel_hi:[1,0]
    v_cvt_pk_bf16_f32 v236, v64, v65
    v_cvt_pk_bf16_f32 v237, v66, v67
    v_cvt_pk_bf16_f32 v238, v68, v69
    v_cvt_pk_bf16_f32 v239, v70, v71
    buffer_store_dwordx4 v[236:239], v7, s[4:7], s44 offen offset:0 sc1
    v_pk_mul_f32 v[72:73], v[72:73], v[234:235] op_sel_hi:[1,0]
    v_pk_mul_f32 v[74:75], v[74:75], v[234:235] op_sel_hi:[1,0]
    v_pk_mul_f32 v[76:77], v[76:77], v[234:235] op_sel_hi:[1,0]
    v_pk_mul_f32 v[78:79], v[78:79], v[234:235] op_sel_hi:[1,0]
    v_cvt_pk_bf16_f32 v240, v72, v73
    v_cvt_pk_bf16_f32 v241, v74, v75
    v_cvt_pk_bf16_f32 v242, v76, v77
    v_cvt_pk_bf16_f32 v243, v78, v79
    buffer_store_dwordx4 v[240:243], v7, s[4:7], s44 offen offset:768 sc1
    s_mul_i32 s57, s24, 256
    s_add_u32 s57, s57, s18
    s_add_u32 s57, s57, 32768
    s_atomic_add s62, s[12:13], s57
    s_add_u32 s58, s22, 135168
    buffer_load_dwordx4 a[136:139], v3, s[4:7], s58 offen sc1
    s_add_u32 s58, s22, 139264
    buffer_load_dwordx4 a[140:143], v3, s[4:7], s58 offen sc1
    s_add_u32 s58, s22, 143360
    buffer_load_dwordx4 a[144:147], v3, s[4:7], s58 offen sc1
    s_add_u32 s58, s22, 147456
    buffer_load_dwordx4 a[148:151], v3, s[4:7], s58 offen sc1
    s_add_u32 s58, s22, 151552
    buffer_load_dwordx4 a[152:155], v3, s[4:7], s58 offen sc1
    s_add_u32 s58, s22, 155648
    buffer_load_dwordx4 a[156:159], v3, s[4:7], s58 offen sc1
    s_add_u32 m0, s86, 143360
    s_add_u32 s59, s22, 4096
    buffer_load_dwordx4 v198, s[4:7], s59 offen offset:0 sc1 lds
    buffer_load_dwordx4 v198, s[4:7], s59 offen offset:1024 sc1 lds
    s_mul_i32 s56, s26, 256
    s_add_u32 s56, s56, s18
    s_add_u32 s56, s56, 32768
    s_mov_b32 s63, 0
    s_atomic_add s63, s[12:13], s56 glc
    s_barrier
    ds_read_b128 v[64:67], v2 offset:36864
    ds_read_b128 v[68:71], v2 offset:37888
    ds_read_b128 v[72:75], v2 offset:38912
    ds_read_b128 v[76:79], v2 offset:39936
    ds_read_b128 v[80:83], v2 offset:40960
    ds_read_b128 v[84:87], v2 offset:41984
    ds_read_b128 v[88:91], v2 offset:43008
    ds_read_b128 v[92:95], v2 offset:44032
    ds_read_b128 v[96:99], v2 offset:45056
    ds_read_b128 v[100:103], v2 offset:46080
    ds_read_b128 v[104:107], v2 offset:47104
    ds_read_b128 v[108:111], v2 offset:48128
    ds_read_b128 v[112:115], v2 offset:49152
    ds_read_b128 v[116:119], v2 offset:50176
Lpoll_135:
    s_mov_b32 s55, 0
Lpoll_135_l:
    s_waitcnt lgkmcnt(0)
    s_bfe_u32 s63, s63, 524288
    s_cmp_ge_u32 s63, 16
    s_cbranch_scc1 Lok_136
    s_mov_b32 s63, 0
    s_atomic_add s63, s[12:13], s56 glc
    s_add_u32 s55, s55, 1
    s_cmp_lt_u32 s55, 400000
    s_cbranch_scc1 Lpoll_135_l
    s_waitcnt lgkmcnt(0)
Lok_136:
    s_add_u32 s70, s17, s29
    s_add_u32 s70, s70, 8388608
    buffer_load_dwordx4 a[0:3], v2, s[4:7], s70 offen offset:0 sc1
    buffer_load_dwordx4 a[4:7], v2, s[4:7], s70 offen offset:1024 sc1
    buffer_load_dwordx4 a[8:11], v2, s[4:7], s70 offen offset:2048 sc1
    buffer_load_dwordx4 a[12:15], v2, s[4:7], s70 offen offset:3072 sc1
    s_add_u32 s70, s70, 4096
    buffer_load_dwordx4 a[16:19], v2, s[4:7], s70 offen offset:0 sc1
    s_add_u32 s70, s70, 12288
    buffer_load_dwordx4 a[20:23], v2, s[4:7], s70 offen offset:0 sc1
    buffer_load_dwordx4 a[24:27], v2, s[4:7], s70 offen offset:1024 sc1
    buffer_load_dwordx4 a[28:31], v2, s[4:7], s70 offen offset:2048 sc1
    buffer_load_dwordx4 a[32:35], v2, s[4:7], s70 offen offset:3072 sc1
    s_waitcnt vmcnt(8)
    v_accvgpr_read_b32 v203, a0
    v_cmp_eq_u32 vcc, -1, v203
    s_nop 1
    s_cbranch_vccnz Lre_137
Lbk_138:
    s_waitcnt vmcnt(7)
    v_mfma_f32_16x16x32_bf16 v[32:35], v[64:67], a[0:3], v[32:35]
    ds_read_b128 v[120:123], v2 offset:51200
    s_add_u32 s70, s70, 4096
    buffer_load_dwordx4 a[36:39], v2, s[4:7], s70 offen offset:0 sc1
    v_accvgpr_read_b32 v203, a4
    v_mfma_f32_16x16x32_bf16 v[36:39], v[68:71], a[0:3], v[36:39]
    ds_read_b128 v[64:67], v2 offset:52224
    v_cmp_eq_u32 vcc, -1, v203
    v_mfma_f32_16x16x32_bf16 v[40:43], v[72:75], a[0:3], v[40:43]
    ds_read_b128 v[68:71], v2 offset:53248
    v_mfma_f32_16x16x32_bf16 v[44:47], v[76:79], a[0:3], v[44:47]
    ds_read_b128 v[72:75], v2 offset:54272
    s_cbranch_vccnz Lre_139
Lbk_140:
    v_mfma_f32_16x16x32_bf16 v[48:51], v[80:83], a[0:3], v[48:51]
    ds_read_b128 v[76:79], v2 offset:55296
    s_add_u32 s70, s70, 12288
    buffer_load_dwordx4 a[40:43], v2, s[4:7], s70 offen offset:0 sc1
    s_waitcnt vmcnt(8)
    v_mfma_f32_16x16x32_bf16 v[32:35], v[84:87], a[4:7], v[32:35]
    ds_read_b128 v[80:83], v2 offset:56320
    v_accvgpr_read_b32 v203, a8
    v_mfma_f32_16x16x32_bf16 v[36:39], v[88:91], a[4:7], v[36:39]
    ds_read_b128 v[84:87], v2 offset:57344
    v_cmp_eq_u32 vcc, -1, v203
    v_mfma_f32_16x16x32_bf16 v[40:43], v[92:95], a[4:7], v[40:43]
    ds_read_b128 v[88:91], v2 offset:58368
    v_mfma_f32_16x16x32_bf16 v[44:47], v[96:99], a[4:7], v[44:47]
    ds_read_b128 v[92:95], v2 offset:59392
    buffer_load_dwordx4 a[44:47], v2, s[4:7], s70 offen offset:1024 sc1
    s_cbranch_vccnz Lre_141
Lbk_142:
    v_mfma_f32_16x16x32_bf16 v[48:51], v[100:103], a[4:7], v[48:51]
    ds_read_b128 v[96:99], v2 offset:60416
    s_waitcnt vmcnt(8) lgkmcnt(9)
    v_mfma_f32_16x16x32_bf16 v[32:35], v[104:107], a[8:11], v[32:35]
    ds_read_b128 v[100:103], v2 offset:61440
    v_accvgpr_read_b32 v203, a12
    v_mfma_f32_16x16x32_bf16 v[36:39], v[108:111], a[8:11], v[36:39]
    ds_read_b128 v[104:107], v2 offset:62464
    v_cmp_eq_u32 vcc, -1, v203
    v_mfma_f32_16x16x32_bf16 v[40:43], v[112:115], a[8:11], v[40:43]
    ds_read_b128 v[108:111], v2 offset:63488
    buffer_load_dwordx4 a[48:51], v2, s[4:7], s70 offen offset:2048 sc1
    v_mfma_f32_16x16x32_bf16 v[44:47], v[116:119], a[8:11], v[44:47]
    ds_read_b128 v[112:115], v2 offset:64512
    s_cbranch_vccnz Lre_143
Lbk_144:
    v_mfma_f32_16x16x32_bf16 v[48:51], v[120:123], a[8:11], v[48:51]
    ds_read_b128 v[116:119], v4 offset:0
    s_waitcnt vmcnt(8) lgkmcnt(9)
    v_mfma_f32_16x16x32_bf16 v[32:35], v[64:67], a[12:15], v[32:35]
    ds_read_b128 v[120:123], v4 offset:1024
    v_accvgpr_read_b32 v203, a16
    v_mfma_f32_16x16x32_bf16 v[36:39], v[68:71], a[12:15], v[36:39]
    ds_read_b128 v[64:67], v4 offset:2048
    buffer_load_dwordx4 a[52:55], v2, s[4:7], s70 offen offset:3072 sc1
    v_cmp_eq_u32 vcc, -1, v203
    v_mfma_f32_16x16x32_bf16 v[40:43], v[72:75], a[12:15], v[40:43]
    ds_read_b128 v[68:71], v4 offset:3072
    v_mfma_f32_16x16x32_bf16 v[44:47], v[76:79], a[12:15], v[44:47]
    ds_read_b128 v[72:75], v4 offset:4096
Lw_6:
    s_cbranch_execz Lw_7
    s_cbranch_vccnz Lre_145
Lbk_146:
    v_mfma_f32_16x16x32_bf16 v[48:51], v[80:83], a[12:15], v[48:51]
    ds_read_b128 v[76:79], v4 offset:5120
    s_waitcnt vmcnt(8) lgkmcnt(9)
    v_mfma_f32_16x16x32_bf16 v[32:35], v[84:87], a[16:19], v[32:35]
    ds_read_b128 v[80:83], v4 offset:6144
    s_add_u32 s70, s70, 4096
    buffer_load_dwordx4 a[56:59], v2, s[4:7], s70 offen offset:0 sc1
    v_accvgpr_read_b32 v203, a20
    v_mfma_f32_16x16x32_bf16 v[36:39], v[88:91], a[16:19], v[36:39]
    ds_read_b128 v[84:87], v4 offset:7168
    v_cmp_eq_u32 vcc, -1, v203
    v_mfma_f32_16x16x32_bf16 v[40:43], v[92:95], a[16:19], v[40:43]
    ds_read_b128 v[88:91], v4 offset:8192
    v_mfma_f32_16x16x32_bf16 v[44:47], v[96:99], a[16:19], v[44:47]
    ds_read_b128 v[92:95], v4 offset:9216
    s_cbranch_vccnz Lre_147
Lbk_148:
    v_mfma_f32_16x16x32_bf16 v[48:51], v[100:103], a[16:19], v[48:51]
    ds_read_b128 v[96:99], v4 offset:10240
    s_add_u32 s70, s70, 12288
    buffer_load_dwordx4 a[60:63], v2, s[4:7], s70 offen offset:0 sc1
    s_waitcnt vmcnt(9) lgkmcnt(9)
    v_mfma_f32_16x16x32_bf16 v[32:35], v[104:107], a[20:23], v[32:35]
    ds_read_b128 v[100:103], v4 offset:11264
    v_accvgpr_read_b32 v203, a24
    v_mfma_f32_16x16x32_bf16 v[36:39], v[108:111], a[20:23], v[36:39]
    ds_read_b128 v[104:107], v4 offset:12288
    v_cmp_eq_u32 vcc, -1, v203
    v_mfma_f32_16x16x32_bf16 v[40:43], v[112:115], a[20:23], v[40:43]
    ds_read_b128 v[108:111], v4 offset:13312
    v_mfma_f32_16x16x32_bf16 v[44:47], v[116:119], a[20:23], v[44:47]
    ds_read_b128 v[112:115], v4 offset:14336
    buffer_load_dwordx4 a[64:67], v2, s[4:7], s70 offen offset:1024 sc1
    s_cbranch_vccnz Lre_149
Lbk_150:
    v_mfma_f32_16x16x32_bf16 v[48:51], v[120:123], a[20:23], v[48:51]
    ds_read_b128 v[116:119], v4 offset:15360
    s_waitcnt vmcnt(9) lgkmcnt(9)
    v_mfma_f32_16x16x32_bf16 v[32:35], v[64:67], a[24:27], v[32:35]
    ds_read_b128 v[120:123], v4 offset:16384
    v_accvgpr_read_b32 v203, a28
    v_mfma_f32_16x16x32_bf16 v[36:39], v[68:71], a[24:27], v[36:39]
    ds_read_b128 v[64:67], v4 offset:17408
    v_cmp_eq_u32 vcc, -1, v203
    v_mfma_f32_16x16x32_bf16 v[40:43], v[72:75], a[24:27], v[40:43]
    ds_read_b128 v[68:71], v4 offset:18432
    buffer_load_dwordx4 a[68:71], v2, s[4:7], s70 offen offset:2048 sc1
    v_mfma_f32_16x16x32_bf16 v[44:47], v[76:79], a[24:27], v[44:47]
    ds_read_b128 v[72:75], v4 offset:19456
    s_cbranch_vccnz Lre_151
Lbk_152:
    v_mfma_f32_16x16x32_bf16 v[48:51], v[80:83], a[24:27], v[48:51]
    ds_read_b128 v[76:79], v4 offset:20480
    s_waitcnt vmcnt(9) lgkmcnt(9)
    v_mfma_f32_16x16x32_bf16 v[32:35], v[84:87], a[28:31], v[32:35]
    ds_read_b128 v[80:83], v4 offset:21504
    v_accvgpr_read_b32 v203, a32
    v_mfma_f32_16x16x32_bf16 v[36:39], v[88:91], a[28:31], v[36:39]
    ds_read_b128 v[84:87], v4 offset:22528
    buffer_load_dwordx4 a[72:75], v2, s[4:7], s70 offen offset:3072 sc1
    v_cmp_eq_u32 vcc, -1, v203
    v_mfma_f32_16x16x32_bf16 v[40:43], v[92:95], a[28:31], v[40:43]
    ds_read_b128 v[88:91], v4 offset:23552
    v_mfma_f32_16x16x32_bf16 v[44:47], v[96:99], a[28:31], v[44:47]
    ds_read_b128 v[92:95], v4 offset:24576
    s_cbranch_vccnz Lre_153
Lbk_154:
    v_mfma_f32_16x16x32_bf16 v[48:51], v[100:103], a[28:31], v[48:51]
    ds_read_b128 v[96:99], v4 offset:25600
    s_waitcnt vmcnt(9) lgkmcnt(9)
    v_mfma_f32_16x16x32_bf16 v[32:35], v[104:107], a[32:35], v[32:35]
    ds_read_b128 v[100:103], v4 offset:26624
    s_add_u32 s70, s70, 4096
    buffer_load_dwordx4 a[76:79], v2, s[4:7], s70 offen offset:0 sc1
    v_accvgpr_read_b32 v203, a36
    v_mfma_f32_16x16x32_bf16 v[36:39], v[108:111], a[32:35], v[36:39]
    ds_read_b128 v[104:107], v4 offset:27648
    v_cmp_eq_u32 vcc, -1, v203
    v_mfma_f32_16x16x32_bf16 v[40:43], v[112:115], a[32:35], v[40:43]
    ds_read_b128 v[108:111], v4 offset:28672
    v_mfma_f32_16x16x32_bf16 v[44:47], v[116:119], a[32:35], v[44:47]
    ds_read_b128 v[112:115], v4 offset:29696
    s_cbranch_vccnz Lre_155
Lbk_156:
    v_mfma_f32_16x16x32_bf16 v[48:51], v[120:123], a[32:35], v[48:51]
    ds_read_b128 v[116:119], v4 offset:30720
    s_waitcnt vmcnt(9) lgkmcnt(9)
    v_mfma_f32_16x16x32_bf16 v[32:35], v[64:67], a[36:39], v[32:35]
    ds_read_b128 v[120:123], v4 offset:31744
    v_accvgpr_read_b32 v203, a40
    v_mfma_f32_16x16x32_bf16 v[36:39], v[68:71], a[36:39], v[36:39]
    ds_read_b128 v[64:67], v4 offset:32768
    v_cmp_eq_u32 vcc, -1, v203
    v_mfma_f32_16x16x32_bf16 v[40:43], v[72:75], a[36:39], v[40:43]
    ds_read_b128 v[68:71], v4 offset:33792
    v_mfma_f32_16x16x32_bf16 v[44:47], v[76:79], a[36:39], v[44:47]
    ds_read_b128 v[72:75], v4 offset:34816
    s_cbranch_vccnz Lre_157
Lbk_158:
    v_mfma_f32_16x16x32_bf16 v[48:51], v[80:83], a[36:39], v[48:51]
    ds_read_b128 v[76:79], v4 offset:35840
    s_waitcnt vmcnt(8) lgkmcnt(9)
    v_mfma_f32_16x16x32_bf16 v[32:35], v[84:87], a[40:43], v[32:35]
    ds_read_b128 v[80:83], v4 offset:36864
    buffer_load_dwordx4 v198, s[4:7], s59 offen offset:2048 sc1 lds
    v_accvgpr_read_b32 v203, a44
    v_mfma_f32_16x16x32_bf16 v[36:39], v[88:91], a[40:43], v[36:39]
    ds_read_b128 v[84:87], v4 offset:37888
    v_cmp_eq_u32 vcc, -1, v203
    v_mfma_f32_16x16x32_bf16 v[40:43], v[92:95], a[40:43], v[40:43]
    ds_read_b128 v[88:91], v4 offset:38912
    v_mfma_f32_16x16x32_bf16 v[44:47], v[96:99], a[40:43], v[44:47]
    ds_read_b128 v[92:95], v4 offset:39936
    s_cbranch_vccnz Lre_159
Lbk_160:
    v_mfma_f32_16x16x32_bf16 v[48:51], v[100:103], a[40:43], v[48:51]
    ds_read_b128 v[96:99], v4 offset:40960
    buffer_load_dwordx4 v198, s[4:7], s59 offen offset:3072 sc1 lds
    s_waitcnt vmcnt(9) lgkmcnt(9)
    v_mfma_f32_16x16x32_bf16 v[32:35], v[104:107], a[44:47], v[32:35]
    ds_read_b128 v[100:103], v4 offset:41984
    v_accvgpr_read_b32 v203, a48
    v_mfma_f32_16x16x32_bf16 v[36:39], v[108:111], a[44:47], v[36:39]
    ds_read_b128 v[104:107], v4 offset:43008
    v_cmp_eq_u32 vcc, -1, v203
    v_mfma_f32_16x16x32_bf16 v[40:43], v[112:115], a[44:47], v[40:43]
    ds_read_b128 v[108:111], v4 offset:44032
    v_mfma_f32_16x16x32_bf16 v[44:47], v[116:119], a[44:47], v[44:47]
    ds_read_b128 v[112:115], v4 offset:45056
    s_cbranch_vccnz Lre_161
Lbk_162:
    v_mfma_f32_16x16x32_bf16 v[48:51], v[120:123], a[44:47], v[48:51]
    ds_read_b128 v[116:119], v4 offset:46080
    s_add_u32 m0, s86, 0
    s_add_u32 s59, s22, 20480
    buffer_load_dwordx4 v198, s[4:7], s59 offen offset:0 sc1 lds
    s_waitcnt vmcnt(9) lgkmcnt(9)
    v_mfma_f32_16x16x32_bf16 v[32:35], v[64:67], a[48:51], v[32:35]
    ds_read_b128 v[120:123], v4 offset:47104
    v_accvgpr_read_b32 v203, a52
    v_mfma_f32_16x16x32_bf16 v[36:39], v[68:71], a[48:51], v[36:39]
    ds_read_b128 v[64:67], v4 offset:48128
    v_cmp_eq_u32 vcc, -1, v203
    v_mfma_f32_16x16x32_bf16 v[40:43], v[72:75], a[48:51], v[40:43]
    ds_read_b128 v[68:71], v4 offset:49152
    v_mfma_f32_16x16x32_bf16 v[44:47], v[76:79], a[48:51], v[44:47]
    ds_read_b128 v[72:75], v4 offset:50176
    buffer_load_dwordx4 v198, s[4:7], s59 offen offset:1024 sc1 lds
    s_cbranch_vccnz Lre_163
Lbk_164:
    v_mfma_f32_16x16x32_bf16 v[48:51], v[80:83], a[48:51], v[48:51]
    ds_read_b128 v[76:79], v4 offset:51200
    s_waitcnt vmcnt(9) lgkmcnt(9)
    v_mfma_f32_16x16x32_bf16 v[32:35], v[84:87], a[52:55], v[32:35]
    ds_read_b128 v[80:83], v4 offset:52224
    v_accvgpr_read_b32 v203, a56
    v_mfma_f32_16x16x32_bf16 v[36:39], v[88:91], a[52:55], v[36:39]
    ds_read_b128 v[84:87], v4 offset:53248
    v_cmp_eq_u32 vcc, -1, v203
    v_mfma_f32_16x16x32_bf16 v[40:43], v[92:95], a[52:55], v[40:43]
    ds_read_b128 v[88:91], v4 offset:54272
    v_mfma_f32_16x16x32_bf16 v[44:47], v[96:99], a[52:55], v[44:47]
    ds_read_b128 v[92:95], v4 offset:55296
    buffer_load_dwordx4 v198, s[4:7], s59 offen offset:2048 sc1 lds
    s_cbranch_vccnz Lre_165
Lbk_166:
    v_mfma_f32_16x16x32_bf16 v[48:51], v[100:103], a[52:55], v[48:51]
    ds_read_b128 v[96:99], v4 offset:56320
    s_waitcnt vmcnt(9) lgkmcnt(9)
    v_mfma_f32_16x16x32_bf16 v[32:35], v[104:107], a[56:59], v[32:35]
    ds_read_b128 v[100:103], v4 offset:57344
    v_accvgpr_read_b32 v203, a60
    v_mfma_f32_16x16x32_bf16 v[36:39], v[108:111], a[56:59], v[36:39]
    ds_read_b128 v[104:107], v4 offset:58368
    v_cmp_eq_u32 vcc, -1, v203
    v_mfma_f32_16x16x32_bf16 v[40:43], v[112:115], a[56:59], v[40:43]
    ds_read_b128 v[108:111], v4 offset:59392
    buffer_load_dwordx4 v198, s[4:7], s59 offen offset:3072 sc1 lds
    v_mfma_f32_16x16x32_bf16 v[44:47], v[116:119], a[56:59], v[44:47]
    ds_read_b128 v[112:115], v4 offset:60416
    s_cbranch_vccnz Lre_167
Lbk_168:
    v_mfma_f32_16x16x32_bf16 v[48:51], v[120:123], a[56:59], v[48:51]
    ds_read_b128 v[116:119], v4 offset:61440
    s_waitcnt vmcnt(9) lgkmcnt(9)
    v_mfma_f32_16x16x32_bf16 v[32:35], v[64:67], a[60:63], v[32:35]
    ds_read_b128 v[120:123], v4 offset:62464
    v_accvgpr_read_b32 v203, a64
    v_mfma_f32_16x16x32_bf16 v[36:39], v[68:71], a[60:63], v[36:39]
    ds_read_b128 v[64:67], v4 offset:63488
    v_cmp_eq_u32 vcc, -1, v203
    v_mfma_f32_16x16x32_bf16 v[40:43], v[72:75], a[60:63], v[40:43]
    ds_read_b128 v[68:71], v4 offset:64512
    s_add_u32 m0, s86, 16384
    s_add_u32 s59, s22, 36864
    buffer_load_dwordx4 v198, s[4:7], s59 offen offset:0 sc1 lds
    v_mfma_f32_16x16x32_bf16 v[44:47], v[76:79], a[60:63], v[44:47]
    ds_read_b128 v[72:75], v5 offset:0
    s_cbranch_vccnz Lre_169
Lbk_170:
    v_mfma_f32_16x16x32_bf16 v[48:51], v[80:83], a[60:63], v[48:51]
    ds_read_b128 v[76:79], v5 offset:1024
    s_waitcnt vmcnt(9) lgkmcnt(9)
    v_mfma_f32_16x16x32_bf16 v[32:35], v[84:87], a[64:67], v[32:35]
    ds_read_b128 v[80:83], v5 offset:2048
    v_accvgpr_read_b32 v203, a68
    v_mfma_f32_16x16x32_bf16 v[36:39], v[88:91], a[64:67], v[36:39]
    ds_read_b128 v[84:87], v5 offset:3072
    buffer_load_dwordx4 v198, s[4:7], s59 offen offset:1024 sc1 lds
    v_cmp_eq_u32 vcc, -1, v203
    v_mfma_f32_16x16x32_bf16 v[40:43], v[92:95], a[64:67], v[40:43]
    ds_read_b128 v[88:91], v5 offset:4096
    v_mfma_f32_16x16x32_bf16 v[44:47], v[96:99], a[64:67], v[44:47]
    ds_read_b128 v[92:95], v5 offset:5120
    s_cbranch_vccnz Lre_171
Lbk_172:
    v_mfma_f32_16x16x32_bf16 v[48:51], v[100:103], a[64:67], v[48:51]
    ds_read_b128 v[96:99], v5 offset:6144
    s_waitcnt vmcnt(9) lgkmcnt(9)
    v_mfma_f32_16x16x32_bf16 v[32:35], v[104:107], a[68:71], v[32:35]
    ds_read_b128 v[100:103], v5 offset:7168
    v_accvgpr_read_b32 v203, a72
    v_mfma_f32_16x16x32_bf16 v[36:39], v[108:111], a[68:71], v[36:39]
    buffer_load_dwordx4 v198, s[4:7], s59 offen offset:2048 sc1 lds
    v_cmp_eq_u32 vcc, -1, v203
    v_mfma_f32_16x16x32_bf16 v[40:43], v[112:115], a[68:71], v[40:43]
    v_mfma_f32_16x16x32_bf16 v[44:47], v[116:119], a[68:71], v[44:47]
    s_cbranch_vccnz Lre_173
Lbk_174:
    v_mfma_f32_16x16x32_bf16 v[48:51], v[120:123], a[68:71], v[48:51]
    s_waitcnt vmcnt(9) lgkmcnt(5)
    v_mfma_f32_16x16x32_bf16 v[32:35], v[64:67], a[72:75], v[32:35]
    buffer_load_dwordx4 v198, s[4:7], s59 offen offset:3072 sc1 lds
    v_accvgpr_read_b32 v203, a76
    v_mfma_f32_16x16x32_bf16 v[36:39], v[68:71], a[72:75], v[36:39]
    v_cmp_eq_u32 vcc, -1, v203
    v_mfma_f32_16x16x32_bf16 v[40:43], v[72:75], a[72:75], v[40:43]
    v_mfma_f32_16x16x32_bf16 v[44:47], v[76:79], a[72:75], v[44:47]
    s_cbranch_vccnz Lre_175
Lbk_176:
    v_mfma_f32_16x16x32_bf16 v[48:51], v[80:83], a[72:75], v[48:51]
    s_waitcnt lgkmcnt(0)
    v_mfma_f32_16x16x32_bf16 v[32:35], v[84:87], a[76:79], v[32:35]
    s_add_u32 m0, s19, 32768
    s_add_u32 s59, s22, 53248
    buffer_load_dwordx4 v3, s[4:7], s59 offen offset:0 sc1 lds
    v_mfma_f32_16x16x32_bf16 v[36:39], v[88:91], a[76:79], v[36:39]
    v_mfma_f32_16x16x32_bf16 v[40:43], v[92:95], a[76:79], v[40:43]
    v_mfma_f32_16x16x32_bf16 v[44:47], v[96:99], a[76:79], v[44:47]
    v_mfma_f32_16x16x32_bf16 v[48:51], v[100:103], a[76:79], v[48:51]
    s_add_u32 s44, s17, s31
    s_add_u32 s44, s44, 4194304
    v_cvt_pk_bf16_f32 v208, v32, v33
    v_cvt_pk_bf16_f32 v209, v34, v35
    s_nop 0
    v_cvt_pk_bf16_f32 v210, v36, v37
    v_cvt_pk_bf16_f32 v211, v38, v39
    buffer_store_dwordx4 v[208:211], v9, s[4:7], s44 offen sc1
    v_cvt_pk_bf16_f32 v216, v48, v49
    v_cvt_pk_bf16_f32 v220, v48, v49
    v_cvt_pk_bf16_f32 v217, v50, v51
    v_cvt_pk_bf16_f32 v221, v50, v51
    v_cvt_pk_bf16_f32 v212, v40, v41
    v_cvt_pk_bf16_f32 v213, v42, v43
    v_cvt_pk_bf16_f32 v214, v44, v45
    v_cvt_pk_bf16_f32 v215, v46, v47
    buffer_store_dwordx4 v[212:215], v9, s[4:7], s44 offen offset:2048 sc1
    v_permlane16_swap_b32 v220, v218
    v_permlane16_swap_b32 v221, v219
    s_mov_b32 exec_lo, 0xffff
    s_mov_b32 exec_hi, 0xffff
    buffer_store_dwordx4 v[216:219], v10, s[4:7], s44 offen sc1
    s_mov_b64 exec, -1
    s_mul_i32 s57, s26, 256
    s_add_u32 s57, s57, s18
    s_add_u32 s57, s57, 49152
    s_atomic_add s62, s[12:13], s57
    v_lshlrev_b32 v32, 16, v208
    v_and_b32 v33, 0xffff0000, v208
    v_lshlrev_b32 v34, 16, v209
    v_and_b32 v35, 0xffff0000, v209
    v_lshlrev_b32 v36, 16, v210
    v_and_b32 v37, 0xffff0000, v210
    v_lshlrev_b32 v38, 16, v211
    v_and_b32 v39, 0xffff0000, v211
    v_lshlrev_b32 v40, 16, v212
    v_and_b32 v41, 0xffff0000, v212
    v_lshlrev_b32 v42, 16, v213
    v_and_b32 v43, 0xffff0000, v213
    v_lshlrev_b32 v44, 16, v214
    v_and_b32 v45, 0xffff0000, v214
    v_lshlrev_b32 v46, 16, v215
    v_and_b32 v47, 0xffff0000, v215
    v_lshlrev_b32 v48, 16, v216
    v_and_b32 v49, 0xffff0000, v216
    v_lshlrev_b32 v50, 16, v217
    v_and_b32 v51, 0xffff0000, v217
    v_pk_add_f32 v[224:225], v[32:33], v[34:35]
    v_pk_add_f32 v[226:227], v[36:37], v[38:39]
    v_pk_add_f32 v[224:225], v[224:225], v[40:41]
    v_pk_add_f32 v[226:227], v[226:227], v[42:43]
    v_pk_add_f32 v[224:225], v[224:225], v[44:45]
    v_pk_add_f32 v[226:227], v[226:227], v[46:47]
    v_pk_add_f32 v[224:225], v[224:225], v[48:49]
    v_pk_add_f32 v[226:227], v[226:227], v[50:51]
    v_pk_add_f32 v[224:225], v[224:225], v[226:227]
    v_add_f32 v224, v224, v225
    v_mov_b32 v225, v224
    s_nop 1
    v_permlane16_swap_b32 v224, v225
    v_add_f32 v224, v224, v225
    v_mov_b32 v225, v224
    s_nop 1
    v_permlane32_swap_b32 v224, v225
    v_add_f32 v224, v224, v225
    v_mul_f32 v224, 1011666125, v224
    v_pk_add_f32 v[232:233], v[32:33], v[224:225] op_sel_hi:[1,0] neg_lo:[0,1] neg_hi:[0,1]
    v_pk_mul_f32 v[228:229], v[232:233], v[232:233]
    v_pk_add_f32 v[234:235], v[34:35], v[224:225] op_sel_hi:[1,0] neg_lo:[0,1] neg_hi:[0,1]
    v_pk_mul_f32 v[230:231], v[234:235], v[234:235]
    v_pk_add_f32 v[236:237], v[36:37], v[224:225] op_sel_hi:[1,0] neg_lo:[0,1] neg_hi:[0,1]
    v_pk_fma_f32 v[228:229], v[236:237], v[236:237], v[228:229]
    v_pk_add_f32 v[238:239], v[38:39], v[224:225] op_sel_hi:[1,0] neg_lo:[0,1] neg_hi:[0,1]
    v_pk_fma_f32 v[230:231], v[238:239], v[238:239], v[230:231]
    v_pk_add_f32 v[232:233], v[40:41], v[224:225] op_sel_hi:[1,0] neg_lo:[0,1] neg_hi:[0,1]
    v_pk_fma_f32 v[228:229], v[232:233], v[232:233], v[228:229]
    v_pk_add_f32 v[234:235], v[42:43], v[224:225] op_sel_hi:[1,0] neg_lo:[0,1] neg_hi:[0,1]
    v_pk_fma_f32 v[230:231], v[234:235], v[234:235], v[230:231]
    v_pk_add_f32 v[236:237], v[44:45], v[224:225] op_sel_hi:[1,0] neg_lo:[0,1] neg_hi:[0,1]
    v_pk_fma_f32 v[228:229], v[236:237], v[236:237], v[228:229]
    v_pk_add_f32 v[238:239], v[46:47], v[224:225] op_sel_hi:[1,0] neg_lo:[0,1] neg_hi:[0,1]
    v_pk_fma_f32 v[230:231], v[238:239], v[238:239], v[230:231]
    v_pk_add_f32 v[232:233], v[48:49], v[224:225] op_sel_hi:[1,0] neg_lo:[0,1] neg_hi:[0,1]
    v_pk_fma_f32 v[228:229], v[232:233], v[232:233], v[228:229]
    v_pk_add_f32 v[234:235], v[50:51], v[224:225] op_sel_hi:[1,0] neg_lo:[0,1] neg_hi:[0,1]
    v_pk_fma_f32 v[230:231], v[234:235], v[234:235], v[230:231]
    v_pk_add_f32 v[228:229], v[228:229], v[230:231]
    v_add_f32 v225, v228, v229
    v_mov_b32 v226, v225
    s_nop 1
    v_permlane16_swap_b32 v225, v226
    v_add_f32 v225, v225, v226
    v_mov_b32 v226, v225
    s_nop 1
    v_permlane32_swap_b32 v225, v226
    v_add_f32 v225, v225, v226
    s_add_u32 s44, s17, s32
    s_add_u32 s44, s44, 21102592
    s_mov_b64 exec, 0xffff
    buffer_store_dwordx2 v[224:225], v29, s[4:7], s44 offen sc1
    s_mov_b64 exec, -1
    s_waitcnt vmcnt(9)
    s_barrier
    s_add_u32 m0, s86, 36864
    s_add_u32 s59, s22, 57344
    buffer_load_dwordx4 v198, s[4:7], s59 offen offset:0 sc1 lds
    buffer_load_dwordx4 v198, s[4:7], s59 offen offset:1024 sc1 lds
    buffer_load_dwordx4 v198, s[4:7], s59 offen offset:2048 sc1 lds
    s_mul_i32 s56, s24, 256
    s_add_u32 s56, s56, s18
    s_add_u32 s56, s56, 49152
    s_mov_b32 s63, 0
    s_atomic_add s63, s[12:13], s56 glc
    buffer_load_dwordx4 v198, s[4:7], s59 offen offset:3072 sc1 lds
    s_add_u32 m0, s19, 53248
    s_add_u32 s59, s22, 73728
    buffer_load_dwordx4 v3, s[4:7], s59 offen offset:0 sc1 lds
    ds_write_b128 v3, a[80:83] offset:57344
    ds_write_b128 v3, a[84:87] offset:61440
    ds_write_b128 v199, a[88:91] offset:0
    ds_write_b128 v199, a[92:95] offset:4096
    ds_read_b128 v[160:163], v5 offset:8192
    ds_read_b128 v[164:167], v5 offset:9216
    ds_read_b128 v[168:171], v5 offset:10240
    ds_read_b128 v[172:175], v5 offset:11264
    ds_read_b128 v[176:179], v5 offset:12288
    ds_read_b128 v[180:183], v5 offset:13312
    ds_read_b128 v[184:187], v5 offset:14336
    ds_read_b128 v[188:191], v5 offset:15360
Lpoll_177:
    s_mov_b32 s55, 0
Lpoll_177_l:
    s_waitcnt lgkmcnt(0)
    s_bfe_u32 s63, s63, 524288
    s_cmp_ge_u32 s63, 16
    s_cbranch_scc1 Lok_178
    s_mov_b32 s63, 0
    s_atomic_add s63, s[12:13], s56 glc
    s_add_u32 s55, s55, 1
    s_cmp_lt_u32 s55, 400000
    s_cbranch_scc1 Lpoll_177_l
    s_waitcnt lgkmcnt(0)
Lok_178:
    s_add_u32 s70, s17, s27
    s_add_u32 s70, s70, 4194304
    buffer_load_dwordx4 a[0:3], v2, s[4:7], s70 offen offset:0 sc1
    buffer_load_dwordx4 a[4:7], v2, s[4:7], s70 offen offset:1024 sc1
    buffer_load_dwordx4 a[8:11], v2, s[4:7], s70 offen offset:2048 sc1
    buffer_load_dwordx4 a[12:15], v2, s[4:7], s70 offen offset:3072 sc1
    s_add_u32 s70, s70, 4096
    buffer_load_dwordx4 a[16:19], v2, s[4:7], s70 offen offset:0 sc1
    s_add_u32 s70, s70, 12288
    buffer_load_dwordx4 a[20:23], v2, s[4:7], s70 offen offset:0 sc1
    buffer_load_dwordx4 a[24:27], v2, s[4:7], s70 offen offset:1024 sc1
    buffer_load_dwordx4 a[28:31], v2, s[4:7], s70 offen offset:2048 sc1
    buffer_load_dwordx4 a[32:35], v2, s[4:7], s70 offen offset:3072 sc1
    s_add_u32 s70, s70, 4096
    buffer_load_dwordx4 a[36:39], v2, s[4:7], s70 offen offset:0 sc1
    s_waitcnt vmcnt(15)
    s_mul_i32 s57, s26, 256
    s_add_u32 s57, s57, s18
    s_add_u32 s57, s57, 49152
    s_atomic_add s42, s[12:13], s57
    ds_write_b128 v199, a[96:99] offset:8192
    ds_write_b128 v199, a[100:103] offset:12288
    ds_write_b128 v199, a[104:107] offset:16384
    ds_write_b128 v199, a[108:111] offset:20480
    ds_write_b128 v199, a[112:115] offset:24576
    ds_write_b128 v199, a[116:119] offset:28672
    ds_write_b128 v199, a[120:123] offset:32768
    s_mul_i32 s53, s26, 256
    s_add_u32 s53, s53, s18
    s_add_u32 s53, s53, 49152
L_join:
Lw_7:
    s_cbranch_execz Lw_8
    s_waitcnt vmcnt(9)
    v_accvgpr_read_b32 v203, a0
    v_cmp_eq_u32 vcc, -1, v203
    s_nop 1
    s_cbranch_vccnz Lre_179
Lbk_180:
    s_waitcnt vmcnt(8)
    v_mfma_f32_32x32x16_bf16 v[64:79], v[160:163], a[0:3], 0
    ds_read_b128 v[192:195], v5 offset:16384
    s_add_u32 s70, s70, 12288
    buffer_load_dwordx4 a[40:43], v2, s[4:7], s70 offen offset:0 sc1
    v_accvgpr_read_b32 v203, a4
    v_cmp_eq_u32 vcc, -1, v203
    v_mfma_f32_32x32x16_bf16 v[80:95], v[164:167], a[0:3], 0
    ds_read_b128 v[160:163], v5 offset:17408
    s_cbranch_vccnz Lre_181
Lbk_182:
    v_mfma_f32_32x32x16_bf16 v[96:111], v[168:171], a[0:3], 0
    ds_read_b128 v[164:167], v5 offset:18432
    buffer_load_dwordx4 a[44:47], v2, s[4:7], s70 offen offset:1024 sc1
    s_waitcnt vmcnt(9)
    v_mfma_f32_32x32x16_bf16 v[64:79], v[172:175], a[4:7], v[64:79]
    ds_read_b128 v[168:171], v5 offset:19456
    ds_write_b128 v199, a[124:127] offset:36864
    v_accvgpr_read_b32 v203, a8
    v_cmp_eq_u32 vcc, -1, v203
    v_mfma_f32_32x32x16_bf16 v[80:95], v[176:179], a[4:7], v[80:95]
    ds_read_b128 v[172:175], v5 offset:20480
    s_cbranch_vccnz Lre_183
Lbk_184:
    buffer_load_dwordx4 a[48:51], v2, s[4:7], s70 offen offset:2048 sc1
    v_mfma_f32_32x32x16_bf16 v[96:111], v[180:183], a[4:7], v[96:111]
    ds_read_b128 v[176:179], v5 offset:21504
    s_waitcnt vmcnt(9) lgkmcnt(6)
    v_mfma_f32_32x32x16_bf16 v[64:79], v[184:187], a[8:11], v[64:79]
    ds_read_b128 v[180:183], v5 offset:22528
    buffer_load_dwordx4 a[52:55], v2, s[4:7], s70 offen offset:3072 sc1
    v_accvgpr_read_b32 v203, a12
    v_cmp_eq_u32 vcc, -1, v203
    v_mfma_f32_32x32x16_bf16 v[80:95], v[188:191], a[8:11], v[80:95]
    ds_read_b128 v[184:187], v5 offset:23552
    s_cbranch_vccnz Lre_185
Lbk_186:
    v_mfma_f32_32x32x16_bf16 v[96:111], v[192:195], a[8:11], v[96:111]
    ds_read_b128 v[188:191], v5 offset:24576
    s_waitcnt vmcnt(9) lgkmcnt(6)
    v_mfma_f32_32x32x16_bf16 v[64:79], v[160:163], a[12:15], v[64:79]
    ds_read_b128 v[192:195], v5 offset:25600
    s_add_u32 s70, s70, 4096
    buffer_load_dwordx4 a[56:59], v2, s[4:7], s70 offen offset:0 sc1
    v_accvgpr_read_b32 v203, a16
    v_cmp_eq_u32 vcc, -1, v203
    v_mfma_f32_32x32x16_bf16 v[80:95], v[164:167], a[12:15], v[80:95]
    ds_read_b128 v[160:163], v5 offset:26624
    s_cbranch_vccnz Lre_187
Lbk_188:
    ds_write_b128 v199, a[128:131] offset:40960
    v_mfma_f32_32x32x16_bf16 v[96:111], v[168:171], a[12:15], v[96:111]
    ds_read_b128 v[164:167], v5 offset:27648
    s_add_u32 s70, s70, 12288
    buffer_load_dwordx4 a[60:63], v2, s[4:7], s70 offen offset:0 sc1
    s_waitcnt vmcnt(10) lgkmcnt(6)
    v_mfma_f32_32x32x16_bf16 v[64:79], v[172:175], a[16:19], v[64:79]
    ds_read_b128 v[168:171], v2 offset:0
    v_accvgpr_read_b32 v203, a20
    v_cmp_eq_u32 vcc, -1, v203
    v_mfma_f32_32x32x16_bf16 v[80:95], v[176:179], a[16:19], v[80:95]
    ds_read_b128 v[172:175], v2 offset:1024
    s_cbranch_vccnz Lre_189
Lbk_190:
    buffer_load_dwordx4 a[64:67], v2, s[4:7], s70 offen offset:1024 sc1
    v_mfma_f32_32x32x16_bf16 v[96:111], v[180:183], a[16:19], v[96:111]
    ds_read_b128 v[176:179], v2 offset:2048
    s_waitcnt vmcnt(8) lgkmcnt(6)
    v_mfma_f32_32x32x16_bf16 v[64:79], v[184:187], a[20:23], v[64:79]
    ds_read_b128 v[180:183], v2 offset:3072
    v_accvgpr_read_b32 v203, a24
    v_accvgpr_read_b32 v23, a28
    v_accvgpr_read_b32 v30, a32
    v_max3_u32 v203, v23, v30, v203
    v_cmp_eq_u32 vcc, -1, v203
    v_mfma_f32_32x32x16_bf16 v[80:95], v[188:191], a[20:23], v[80:95]
    s_barrier
    ds_read_b128 v[184:187], v2 offset:4096
    s_cbranch_vccnz Lre_191
Lbk_192:
    buffer_load_dwordx4 a[68:71], v2, s[4:7], s70 offen offset:2048 sc1
    v_mfma_f32_32x32x16_bf16 v[96:111], v[192:195], a[20:23], v[96:111]
    ds_read_b128 v[188:191], v2 offset:5120
    ds_write_b128 v199, a[132:135] offset:45056
    s_waitcnt lgkmcnt(6)
    v_mfma_f32_32x32x16_bf16 v[64:79], v[160:163], a[24:27], v[64:79]
    ds_read_b128 v[192:195], v2 offset:6144
    buffer_load_dwordx4 a[72:75], v2, s[4:7], s70 offen offset:3072 sc1
    s_mul_i32 s56, s24, 256
    s_add_u32 s56, s56, s18
    s_add_u32 s56, s56, 49152
    s_mov_b32 s63, 0
    s_atomic_add s63, s[12:13], s56 glc
    v_mfma_f32_32x32x16_bf16 v[80:95], v[164:167], a[24:27], v[80:95]
    ds_read_b128 v[160:163], v2 offset:7168
    v_mfma_f32_32x32x16_bf16 v[96:111], v[168:171], a[24:27], v[96:111]
    ds_read_b128 v[164:167], v2 offset:8192
    s_add_u32 s70, s70, 4096
    buffer_load_dwordx4 a[76:79], v2, s[4:7], s70 offen offset:0 sc1
    s_waitcnt lgkmcnt(6)
    v_mfma_f32_32x32x16_bf16 v[64:79], v[172:175], a[28:31], v[64:79]
    ds_read_b128 v[168:171], v2 offset:9216
    ds_write_b128 v199, a[136:139] offset:49152
    v_mfma_f32_32x32x16_bf16 v[80:95], v[176:179], a[28:31], v[80:95]
    ds_read_b128 v[172:175], v2 offset:10240
    v_mfma_f32_32x32x16_bf16 v[96:111], v[180:183], a[28:31], v[96:111]
    ds_read_b128 v[176:179], v2 offset:11264
    s_add_u32 s70, s70, 12288
    buffer_load_dwordx4 a[80:83], v2, s[4:7], s70 offen offset:0 sc1
    s_waitcnt vmcnt(9) lgkmcnt(6)
    v_mfma_f32_32x32x16_bf16 v[64:79], v[184:187], a[32:35], v[64:79]
    ds_read_b128 v[180:183], v2 offset:12288
    v_accvgpr_read_b32 v203, a36
    v_accvgpr_read_b32 v23, a40
    v_accvgpr_read_b32 v30, a44
    v_max3_u32 v203, v23, v30, v203
    v_cmp_eq_u32 vcc, -1, v203
    v_mfma_f32_32x32x16_bf16 v[80:95], v[188:191], a[32:35], v[80:95]
    ds_read_b128 v[184:187], v2 offset:13312
    s_cbranch_vccnz Lre_193
Lbk_194:
    buffer_load_dwordx4 a[84:87], v2, s[4:7], s70 offen offset:1024 sc1
    v_mfma_f32_32x32x16_bf16 v[96:111], v[192:195], a[32:35], v[96:111]
    ds_read_b128 v[188:191], v2 offset:14336
    s_waitcnt lgkmcnt(6)
    v_mfma_f32_32x32x16_bf16 v[64:79], v[160:163], a[36:39], v[64:79]
    ds_read_b128 v[192:195], v2 offset:15360
    buffer_load_dwordx4 a[88:91], v2, s[4:7], s70 offen offset:2048 sc1
    v_mfma_f32_32x32x16_bf16 v[80:95], v[164:167], a[36:39], v[80:95]
    ds_read_b128 v[160:163], v2 offset:16384
    ds_write_b128 v199, a[140:143] offset:53248
    v_mfma_f32_32x32x16_bf16 v[96:111], v[168:171], a[36:39], v[96:111]
    ds_read_b128 v[164:167], v2 offset:17408
    buffer_load_dwordx4 a[92:95], v2, s[4:7], s70 offen offset:3072 sc1
    s_waitcnt lgkmcnt(6)
    v_mfma_f32_32x32x16_bf16 v[64:79], v[172:175], a[40:43], v[64:79]
    ds_read_b128 v[168:171], v2 offset:18432
    v_mfma_f32_32x32x16_bf16 v[80:95], v[176:179], a[40:43], v[80:95]
    ds_read_b128 v[172:175], v2 offset:19456
    ds_write_b128 v199, a[144:147] offset:57344
    v_mfma_f32_32x32x16_bf16 v[96:111], v[180:183], a[40:43], v[96:111]
    ds_read_b128 v[176:179], v2 offset:20480
    s_add_u32 s70, s70, 4096
    buffer_load_dwordx4 a[96:99], v2, s[4:7], s70 offen offset:0 sc1
    s_waitcnt vmcnt(10) lgkmcnt(7)
    v_mfma_f32_32x32x16_bf16 v[64:79], v[184:187], a[44:47], v[64:79]
    ds_read_b128 v[180:183], v2 offset:21504
    v_accvgpr_read_b32 v203, a48
    v_accvgpr_read_b32 v23, a52
    v_accvgpr_read_b32 v30, a56
    v_max3_u32 v203, v23, v30, v203
    v_cmp_eq_u32 vcc, -1, v203
    v_mfma_f32_32x32x16_bf16 v[80:95], v[188:191], a[44:47], v[80:95]
    ds_read_b128 v[184:187], v2 offset:22528
    s_cbranch_vccnz Lre_195
Lbk_196:
    s_add_u32 s70, s70, 12288
    buffer_load_dwordx4 a[100:103], v2, s[4:7], s70 offen offset:0 sc1
    v_mfma_f32_32x32x16_bf16 v[96:111], v[192:195], a[44:47], v[96:111]
    ds_read_b128 v[188:191], v2 offset:23552
    s_waitcnt lgkmcnt(6)
    v_mfma_f32_32x32x16_bf16 v[64:79], v[160:163], a[48:51], v[64:79]
    ds_read_b128 v[192:195], v2 offset:24576
    buffer_load_dwordx4 a[104:107], v2, s[4:7], s70 offen offset:1024 sc1
    v_mfma_f32_32x32x16_bf16 v[80:95], v[164:167], a[48:51], v[80:95]
    ds_read_b128 v[160:163], v2 offset:25600
    ds_write_b128 v199, a[148:151] offset:61440
    v_mfma_f32_32x32x16_bf16 v[96:111], v[168:171], a[48:51], v[96:111]
    ds_read_b128 v[164:167], v2 offset:26624
Lpoll_197:
    s_mov_b32 s55, 0
Lpoll_197_l:
    s_waitcnt lgkmcnt(0)
    s_bfe_u32 s63, s63, 524296
    s_cmp_ge_u32 s63, 16
    s_cbranch_scc1 Lok_198
    s_mov_b32 s63, 0
    s_atomic_add s63, s[12:13], s56 glc
    s_add_u32 s55, s55, 1
    s_cmp_lt_u32 s55, 400000
    s_cbranch_scc1 Lpoll_197_l
Lw_8:
    s_cbranch_execz Lw_9
    s_waitcnt lgkmcnt(0)
Lok_198:
    s_add_u32 s44, s17, s28
    s_add_u32 s44, s44, 21102592
    buffer_load_dwordx2 v[56:57], v6, s[4:7], s44 offen offset:0 sc1
    buffer_load_dwordx2 v[58:59], v6, s[4:7], s44 offen offset:256 sc1
    buffer_load_dwordx2 v[60:61], v6, s[4:7], s44 offen offset:512 sc1
    buffer_load_dwordx2 v[62:63], v6, s[4:7], s44 offen offset:768 sc1
    v_mfma_f32_32x32x16_bf16 v[64:79], v[172:175], a[52:55], v[64:79]
    ds_read_b128 v[168:171], v2 offset:27648
    buffer_load_dwordx4 a[108:111], v2, s[4:7], s70 offen offset:2048 sc1
    v_mfma_f32_32x32x16_bf16 v[80:95], v[176:179], a[52:55], v[80:95]
    s_barrier
    ds_read_b128 v[172:175], v2 offset:28672
    v_mfma_f32_32x32x16_bf16 v[96:111], v[180:183], a[52:55], v[96:111]
    ds_read_b128 v[176:179], v2 offset:29696
    buffer_load_dwordx4 a[112:115], v2, s[4:7], s70 offen offset:3072 sc1
    s_waitcnt vmcnt(15)
    v_mfma_f32_32x32x16_bf16 v[64:79], v[184:187], a[56:59], v[64:79]
    ds_read_b128 v[180:183], v2 offset:30720
    v_accvgpr_read_b32 v203, a60
    v_accvgpr_read_b32 v23, a64
    v_accvgpr_read_b32 v30, a68
    v_max3_u32 v203, v23, v30, v203
    v_cmp_eq_u32 vcc, -1, v203
    v_mfma_f32_32x32x16_bf16 v[80:95], v[188:191], a[56:59], v[80:95]
    ds_read_b128 v[184:187], v2 offset:31744
    s_cbranch_vccnz Lre_199
Lbk_200:
    s_add_u32 s70, s70, 4096
    buffer_load_dwordx4 a[116:119], v2, s[4:7], s70 offen offset:0 sc1
    v_mfma_f32_32x32x16_bf16 v[96:111], v[192:195], a[56:59], v[96:111]
    ds_read_b128 v[188:191], v2 offset:32768
    ds_write_b128 v200, a[152:155] offset:0
    s_waitcnt lgkmcnt(6)
    v_mfma_f32_32x32x16_bf16 v[64:79], v[160:163], a[60:63], v[64:79]
    ds_read_b128 v[192:195], v2 offset:33792
    v_mfma_f32_32x32x16_bf16 v[80:95], v[164:167], a[60:63], v[80:95]
    ds_read_b128 v[160:163], v2 offset:34816
    s_add_u32 s70, s70, 12288
    buffer_load_dwordx4 a[120:123], v2, s[4:7], s70 offen offset:0 sc1
    v_mfma_f32_32x32x16_bf16 v[96:111], v[168:171], a[60:63], v[96:111]
    ds_read_b128 v[164:167], v2 offset:35840
    s_waitcnt lgkmcnt(6)
    v_mfma_f32_32x32x16_bf16 v[64:79], v[172:175], a[64:67], v[64:79]
    ds_read_b128 v[168:171], v2 offset:36864
    buffer_load_dwordx4 a[124:127], v2, s[4:7], s70 offen offset:1024 sc1
    v_mfma_f32_32x32x16_bf16 v[80:95], v[176:179], a[64:67], v[80:95]
    ds_read_b128 v[172:175], v2 offset:37888
    ds_write_b128 v200, a[156:159] offset:4096
    v_mfma_f32_32x32x16_bf16 v[96:111], v[180:183], a[64:67], v[96:111]
    ds_read_b128 v[176:179], v2 offset:38912
    buffer_load_dwordx4 a[128:131], v2, s[4:7], s70 offen offset:2048 sc1
    s_waitcnt vmcnt(16) lgkmcnt(6)
    v_mfma_f32_32x32x16_bf16 v[64:79], v[184:187], a[68:71], v[64:79]
    ds_read_b128 v[180:183], v2 offset:39936
    v_accvgpr_read_b32 v203, a72
    v_accvgpr_read_b32 v23, a76
    v_accvgpr_read_b32 v30, a80
    v_max3_u32 v203, v23, v30, v203
    v_cmp_eq_u32 vcc, -1, v203
    v_mfma_f32_32x32x16_bf16 v[80:95], v[188:191], a[68:71], v[80:95]
    ds_read_b128 v[184:187], v2 offset:40960
    s_cbranch_vccnz Lre_201
Lbk_202:
    buffer_load_dwordx4 a[132:135], v2, s[4:7], s70 offen offset:3072 sc1
    v_mfma_f32_32x32x16_bf16 v[96:111], v[192:195], a[68:71], v[96:111]
    ds_read_b128 v[188:191], v2 offset:41984
    s_waitcnt lgkmcnt(6)
    v_mfma_f32_32x32x16_bf16 v[64:79], v[160:163], a[72:75], v[64:79]
    ds_read_b128 v[192:195], v2 offset:43008
    v_mfma_f32_32x32x16_bf16 v[80:95], v[164:167], a[72:75], v[80:95]
    ds_read_b128 v[160:163], v2 offset:44032
    s_add_u32 s70, s70, 4096
    buffer_load_dwordx4 a[136:139], v2, s[4:7], s70 offen offset:0 sc1
    v_mfma_f32_32x32x16_bf16 v[96:111], v[168:171], a[72:75], v[96:111]
    ds_read_b128 v[164:167], v2 offset:45056
    s_waitcnt vmcnt(15) lgkmcnt(5)
    v_mfma_f32_32x32x16_bf16 v[64:79], v[172:175], a[76:79], v[64:79]
    ds_read_b128 v[168:171], v2 offset:46080
    s_add_u32 s70, s70, 12288
    buffer_load_dwordx4 a[140:143], v2, s[4:7], s70 offen offset:0 sc1
    v_accvgpr_read_b32 v203, a84
    v_accvgpr_read_b32 v23, a88
    v_accvgpr_read_b32 v30, a92
    v_max3_u32 v203, v23, v30, v203
    v_cmp_eq_u32 vcc, -1, v203
    v_mfma_f32_32x32x16_bf16 v[80:95], v[176:179], a[76:79], v[80:95]
    ds_read_b128 v[172:175], v2 offset:47104
    s_cbranch_vccnz Lre_203
Lbk_204:
    v_mfma_f32_32x32x16_bf16 v[96:111], v[180:183], a[76:79], v[96:111]
    ds_read_b128 v[176:179], v2 offset:48128
    buffer_load_dwordx4 a[144:147], v2, s[4:7], s70 offen offset:1024 sc1
    s_waitcnt lgkmcnt(4)
    v_mfma_f32_32x32x16_bf16 v[64:79], v[184:187], a[80:83], v[64:79]
    ds_read_b128 v[180:183], v2 offset:49152
    v_mfma_f32_32x32x16_bf16 v[80:95], v[188:191], a[80:83], v[80:95]
    ds_read_b128 v[184:187], v2 offset:50176
    v_mfma_f32_32x32x16_bf16 v[64:79], v[192:195], a[84:87], v[64:79]
    ds_read_b128 v[188:191], v2 offset:51200
    buffer_load_dwordx4 a[148:151], v2, s[4:7], s70 offen offset:2048 sc1
    s_waitcnt vmcnt(11)
    v_add_f32 v248, v56, v58
    v_add_f32 v249, v60, v62
    v_mfma_f32_32x32x16_bf16 v[80:95], v[160:163], a[84:87], v[80:95]
    ds_read_b128 v[192:195], v2 offset:52224
    v_add_f32 v248, v248, v249
    v_mov_b32 v249, v248
    s_nop 1
    v_permlane32_swap_b32 v248, v249
    v_add_f32 v248, v248, v249
    s_waitcnt lgkmcnt(4)
    v_mfma_f32_32x32x16_bf16 v[64:79], v[164:167], a[88:91], v[64:79]
    s_barrier
    ds_read_b128 v[160:163], v2 offset:53248
    buffer_load_dwordx4 a[152:155], v2, s[4:7], s70 offen offset:3072 sc1
    v_accvgpr_read_b32 v203, a96
    v_accvgpr_read_b32 v23, a100
    v_accvgpr_read_b32 v30, a104
    v_max3_u32 v203, v23, v30, v203
    v_cmp_eq_u32 vcc, -1, v203
    v_mfma_f32_32x32x16_bf16 v[80:95], v[168:171], a[88:91], v[80:95]
    ds_read_b128 v[164:167], v2 offset:54272
    s_cbranch_vccnz Lre_205
Lbk_206:
    v_mul_f32 v248, 3187671040, v248
    v_add_f32 v249, v56, v248
    v_mul_f32 v249, v249, v249
    v_mfma_f32_32x32x16_bf16 v[64:79], v[172:175], a[92:95], v[64:79]
    ds_read_b128 v[168:171], v2 offset:55296
    s_add_u32 s70, s70, 4096
    buffer_load_dwordx4 a[156:159], v2, s[4:7], s70 offen offset:0 sc1
    v_fmac_f32 v57, 1117782016, v249
    v_add_f32 v249, v58, v248
    v_mul_f32 v249, v249, v249
    v_mfma_f32_32x32x16_bf16 v[80:95], v[176:179], a[92:95], v[80:95]
    ds_read_b128 v[172:175], v2 offset:56320
    v_fmac_f32 v59, 1117782016, v249
    v_add_f32 v249, v60, v248
    v_mul_f32 v249, v249, v249
    v_fmac_f32 v61, 1117782016, v249
    s_waitcnt vmcnt(12) lgkmcnt(4)
    v_mfma_f32_32x32x16_bf16 v[64:79], v[180:183], a[96:99], v[64:79]
    ds_read_b128 v[176:179], v2 offset:57344
    v_add_f32 v249, v62, v248
    v_mul_f32 v249, v249, v249
    v_fmac_f32 v63, 1117782016, v249
    v_add_f32 v249, v57, v59
    v_mfma_f32_32x32x16_bf16 v[80:95], v[184:187], a[96:99], v[80:95]
    ds_read_b128 v[180:183], v2 offset:58368
    s_add_u32 m0, s86, 139264
    s_add_u32 s59, s22, 159744
    buffer_load_dwordx4 v198, s[4:7], s59 offen offset:0 sc1 lds
    v_mfma_f32_32x32x16_bf16 v[64:79], v[188:191], a[100:103], v[64:79]
    ds_read_b128 v[184:187], v2 offset:59392
    v_add_f32 v250, v61, v63
    v_add_f32 v249, v249, v250
    v_mov_b32 v250, v249
    s_nop 1
    v_permlane32_swap_b32 v249, v250
    v_mfma_f32_32x32x16_bf16 v[80:95], v[192:195], a[100:103], v[80:95]
    ds_read_b128 v[188:191], v2 offset:60416
    v_add_f32 v249, v249, v250
    v_mov_b32 v250, 925353388
    v_fmac_f32 v250, 986500301, v249
    v_rsq_f32 v56, v250
    s_waitcnt vmcnt(11) lgkmcnt(4)
    v_mfma_f32_32x32x16_bf16 v[64:79], v[160:163], a[104:107], v[64:79]
    ds_read_b128 v[192:195], v2 offset:61440
    buffer_load_dwordx4 v198, s[4:7], s59 offen offset:1024 sc1 lds
    v_cvt_pk_bf16_f32 v249, v248, v248
    v_and_b32 v249, 0xffff0000, v249
    v_mfma_f32_32x32x16_bf16 v[80:95], v[164:167], a[104:107], v[80:95]
    ds_read_b128 v[160:163], v2 offset:62464
    v_sub_f32 v249, v248, v249
    v_cvt_pk_bf16_f32 v52, v248, v249
    v_mov_b32 v53, v52
    v_mov_b32 v54, v52
    v_mfma_f32_32x32x16_bf16 v[64:79], v[168:171], a[108:111], v[64:79]
    ds_read_b128 v[164:167], v2 offset:63488
    buffer_load_dwordx4 v198, s[4:7], s59 offen offset:2048 sc1 lds
    v_mov_b32 v55, v52
    v_mul_f32 v58, 3216550459, v56
    v_mfma_f32_32x32x16_bf16 v[80:95], v[172:175], a[108:111], v[80:95]
    ds_read_b128 v[168:171], v2 offset:64512
    v_mov_b32 v60, v250
    s_waitcnt vmcnt(11) lgkmcnt(4)
    v_mfma_f32_32x32x16_bf16 v[64:79], v[176:179], a[112:115], v[64:79]
    ds_read_b128 v[172:175], v4 offset:0
    buffer_load_dwordx4 v198, s[4:7], s59 offen offset:3072 sc1 lds
    v_mfma_f32_32x32x16_bf16 v[80:95], v[180:183], a[112:115], v[80:95]
    ds_read_b128 v[176:179], v4 offset:1024
    v_mfma_f32_32x32x16_bf16 v[64:79], v[184:187], a[116:119], v[64:79]
    ds_read_b128 v[180:183], v4 offset:2048
    v_mfma_f32_32x32x16_bf16 v[80:95], v[188:191], a[116:119], v[80:95]
    ds_read_b128 v[184:187], v4 offset:3072
    s_add_u32 m0, s19, 155648
    s_add_u32 s59, s22, 176128
    buffer_load_dwordx4 v3, s[4:7], s59 offen offset:0 sc1 lds
    s_waitcnt vmcnt(11) lgkmcnt(4)
    v_mfma_f32_32x32x16_bf16 v[64:79], v[192:195], a[120:123], v[64:79]
    ds_read_b128 v[188:191], v4 offset:4096
    v_mfma_f32_32x32x16_bf16 v[80:95], v[160:163], a[120:123], v[80:95]
    ds_read_b128 v[192:195], v4 offset:5120
    s_add_u32 m0, s86, 0
    s_add_u32 s59, s22, 180224
    buffer_load_dwordx4 v198, s[4:7], s59 offen offset:0 sc1 lds
    v_mfma_f32_32x32x16_bf16 v[64:79], v[164:167], a[124:127], v[64:79]
    ds_read_b128 v[160:163], v4 offset:6144
    v_mfma_f32_32x32x16_bf16 v[80:95], v[168:171], a[124:127], v[80:95]
    ds_read_b128 v[164:167], v4 offset:7168
    buffer_load_dwordx4 v198, s[4:7], s59 offen offset:1024 sc1 lds
    s_waitcnt vmcnt(11) lgkmcnt(4)
    v_mfma_f32_32x32x16_bf16 v[64:79], v[172:175], a[128:131], v[64:79]
    ds_read_b128 v[168:171], v4 offset:8192
    v_mfma_f32_32x32x16_bf16 v[80:95], v[176:179], a[128:131], v[80:95]
    ds_read_b128 v[172:175], v4 offset:9216
    v_mfma_f32_32x32x16_bf16 v[64:79], v[180:183], a[132:135], v[64:79]
    ds_read_b128 v[176:179], v4 offset:10240
    buffer_load_dwordx4 v198, s[4:7], s59 offen offset:2048 sc1 lds
    v_mfma_f32_32x32x16_bf16 v[80:95], v[184:187], a[132:135], v[80:95]
    ds_read_b128 v[180:183], v4 offset:11264
    s_waitcnt vmcnt(10) lgkmcnt(4)
    v_mfma_f32_32x32x16_bf16 v[64:79], v[188:191], a[136:139], v[64:79]
    s_barrier
    ds_read_b128 v[184:187], v4 offset:12288
    buffer_load_dwordx4 v198, s[4:7], s59 offen offset:3072 sc1 lds
    v_mfma_f32_32x32x16_bf16 v[80:95], v[192:195], a[136:139], v[80:95]
    ds_read_b128 v[188:191], v4 offset:13312
    v_mfma_f32_32x32x16_bf16 v[64:79], v[160:163], a[140:143], v[64:79]
    ds_read_b128 v[192:195], v4 offset:14336
    s_add_u32 m0, s86, 16384
    s_add_u32 s59, s22, 196608
    buffer_load_dwordx4 v198, s[4:7], s59 offen offset:0 sc1 lds
    v_mfma_f32_32x32x16_bf16 v[80:95], v[164:167], a[140:143], v[80:95]
    ds_read_b128 v[160:163], v4 offset:15360
    s_waitcnt vmcnt(10) lgkmcnt(4)
    v_mfma_f32_32x32x16_bf16 v[64:79], v[168:171], a[144:147], v[64:79]
    ds_read_b128 v[164:167], v4 offset:16384
    buffer_load_dwordx4 v198, s[4:7], s59 offen offset:1024 sc1 lds
    v_mfma_f32_32x32x16_bf16 v[80:95], v[172:175], a[144:147], v[80:95]
    ds_read_b128 v[168:171], v4 offset:17408
    v_mfma_f32_32x32x16_bf16 v[64:79], v[176:179], a[148:151], v[64:79]
    ds_read_b128 v[172:175], v4 offset:18432
    v_mfma_f32_32x32x16_bf16 v[80:95], v[180:183], a[148:151], v[80:95]
    ds_read_b128 v[176:179], v4 offset:19456
    buffer_load_dwordx4 v198, s[4:7], s59 offen offset:2048 sc1 lds
    s_waitcnt lgkmcnt(4)
    v_mfma_f32_32x32x16_bf16 v[64:79], v[184:187], a[152:155], v[64:79]
    ds_read_b128 v[180:183], v4 offset:20480
    v_mfma_f32_32x32x16_bf16 v[80:95], v[188:191], a[152:155], v[80:95]
    ds_read_b128 v[184:187], v4 offset:21504
    buffer_load_dwordx4 v198, s[4:7], s59 offen offset:3072 sc1 lds
    v_mfma_f32_32x32x16_bf16 v[64:79], v[192:195], a[156:159], v[64:79]
    ds_read_b128 v[188:191], v4 offset:22528
    v_mfma_f32_32x32x16_bf16 v[80:95], v[160:163], a[156:159], v[80:95]
    ds_read_b128 v[192:195], v4 offset:23552
    s_add_u32 m0, s86, 32768
    s_add_u32 s59, s22, 212992
    buffer_load_dwordx4 v198, s[4:7], s59 offen offset:0 sc1 lds
    s_waitcnt lgkmcnt(6)
    v_mfma_f32_32x32x16_bf16 v[64:79], v[164:167], v[52:55], v[64:79]
    ds_read_b128 v[160:163], v4 offset:24576
    v_mfma_f32_32x32x16_bf16 v[80:95], v[168:171], v[52:55], v[80:95]
    ds_read_b128 v[164:167], v4 offset:25600
    s_waitcnt lgkmcnt(5)
    v_mfma_f32_32x32x16_bf16 v[96:111], v[172:175], a[80:83], v[96:111]
    ds_read_b128 v[168:171], v4 offset:26624
    buffer_load_dwordx4 v198, s[4:7], s59 offen offset:1024 sc1 lds
    s_nop 4
    v_mul_f32 v232, v64, v58
    v_mul_f32 v233, v65, v58
    v_mfma_f32_32x32x16_bf16 v[96:111], v[176:179], a[84:87], v[96:111]
    ds_read_b128 v[172:175], v4 offset:27648
    v_exp_f32 v232, v232
    v_mul_f32 v64, v64, v72
    v_exp_f32 v233, v233
    v_mfma_f32_32x32x16_bf16 v[96:111], v[180:183], a[88:91], v[96:111]
    ds_read_b128 v[176:179], v4 offset:28672
    v_fma_f32 v232, v232, v60, v60
    v_mul_f32 v65, v65, v73
    v_fma_f32 v233, v233, v60, v60
    v_mul_f32 v234, v66, v58
    s_waitcnt lgkmcnt(5)
    v_mfma_f32_32x32x16_bf16 v[96:111], v[184:187], a[92:95], v[96:111]
    ds_read_b128 v[180:183], v4 offset:29696
    buffer_load_dwordx4 v198, s[4:7], s59 offen offset:2048 sc1 lds
    v_rcp_f32 v232, v232
    v_mfma_f32_32x32x16_bf16 v[96:111], v[188:191], a[96:99], v[96:111]
    ds_read_b128 v[184:187], v4 offset:30720
    v_mul_f32 v64, v64, v232
    v_rcp_f32 v233, v233
    v_exp_f32 v234, v234
    v_mfma_f32_32x32x16_bf16 v[96:111], v[192:195], a[100:103], v[96:111]
    ds_read_b128 v[188:191], v4 offset:31744
    v_mul_f32 v65, v65, v233
    v_mul_f32 v66, v66, v74
    v_fma_f32 v234, v234, v60, v60
    v_mul_f32 v235, v67, v58
    s_waitcnt lgkmcnt(5)
    v_mfma_f32_32x32x16_bf16 v[96:111], v[160:163], a[104:107], v[96:111]
    ds_read_b128 v[192:195], v4 offset:32768
    v_cvt_pk_bf16_f32 v208, v64, v65
    v_rcp_f32 v234, v234
    v_exp_f32 v235, v235
    v_mfma_f32_32x32x16_bf16 v[96:111], v[164:167], a[108:111], v[96:111]
    ds_read_b128 v[160:163], v4 offset:33792
    buffer_load_dwordx4 v198, s[4:7], s59 offen offset:3072 sc1 lds
    v_mul_f32 v66, v66, v234
    v_mul_f32 v67, v67, v75
    v_mfma_f32_32x32x16_bf16 v[96:111], v[168:171], a[112:115], v[96:111]
    ds_read_b128 v[164:167], v4 offset:34816
    v_fma_f32 v235, v235, v60, v60
    v_mul_f32 v236, v68, v58
    v_mul_f32 v237, v69, v58
    v_mul_f32 v238, v70, v58
    s_waitcnt lgkmcnt(5)
    v_mfma_f32_32x32x16_bf16 v[96:111], v[172:175], a[116:119], v[96:111]
    ds_read_b128 v[168:171], v4 offset:35840
    v_rcp_f32 v235, v235
    v_exp_f32 v236, v236
    v_mul_f32 v68, v68, v76
    v_mfma_f32_32x32x16_bf16 v[96:111], v[176:179], a[120:123], v[96:111]
    s_barrier
    ds_read_b128 v[172:175], v4 offset:36864
    s_add_u32 m0, s86, 49152
    s_add_u32 s59, s22, 229376
    buffer_load_dwordx4 v198, s[4:7], s59 offen offset:0 sc1 lds
    v_mfma_f32_32x32x16_bf16 v[96:111], v[180:183], a[124:127], v[96:111]
    ds_read_b128 v[176:179], v4 offset:37888
    v_mul_f32 v67, v67, v235
    v_fma_f32 v236, v236, v60, v60
    v_exp_f32 v237, v237
    s_waitcnt lgkmcnt(5)
    v_mfma_f32_32x32x16_bf16 v[96:111], v[184:187], a[128:131], v[96:111]
    ds_read_b128 v[180:183], v4 offset:38912
    v_cvt_pk_bf16_f32 v209, v66, v67
    v_rcp_f32 v236, v236
    v_mul_f32 v69, v69, v77
    v_fma_f32 v237, v237, v60, v60
    v_mfma_f32_32x32x16_bf16 v[96:111], v[188:191], a[132:135], v[96:111]
    ds_read_b128 v[184:187], v4 offset:39936
    v_mul_f32 v68, v68, v236
    v_rcp_f32 v237, v237
    v_exp_f32 v238, v238
    v_mfma_f32_32x32x16_bf16 v[96:111], v[192:195], a[136:139], v[96:111]
    ds_read_b128 v[188:191], v4 offset:40960
    buffer_load_dwordx4 v198, s[4:7], s59 offen offset:1024 sc1 lds
    v_mul_f32 v69, v69, v237
    s_waitcnt lgkmcnt(5)
    v_mfma_f32_32x32x16_bf16 v[96:111], v[160:163], a[140:143], v[96:111]
    ds_read_b128 v[192:195], v4 offset:41984
    v_cvt_pk_bf16_f32 v210, v68, v69
    v_mul_f32 v70, v70, v78
    v_fma_f32 v238, v238, v60, v60
    v_mul_f32 v239, v71, v58
    v_mul_f32 v240, v80, v58
    v_mfma_f32_32x32x16_bf16 v[96:111], v[164:167], a[144:147], v[96:111]
    ds_read_b128 v[160:163], v4 offset:43008
    v_rcp_f32 v238, v238
    v_exp_f32 v239, v239
    v_mul_f32 v71, v71, v79
    v_mfma_f32_32x32x16_bf16 v[96:111], v[168:171], a[148:151], v[96:111]
    ds_read_b128 v[164:167], v4 offset:44032
    buffer_load_dwordx4 v198, s[4:7], s59 offen offset:2048 sc1 lds
    v_mul_f32 v70, v70, v238
    s_waitcnt lgkmcnt(5)
    v_mfma_f32_32x32x16_bf16 v[96:111], v[172:175], a[152:155], v[96:111]
    ds_read_b128 v[168:171], v4 offset:45056
    v_fma_f32 v239, v239, v60, v60
    v_exp_f32 v240, v240
    v_mul_f32 v80, v80, v88
    v_mul_f32 v241, v81, v58
    v_mfma_f32_32x32x16_bf16 v[96:111], v[176:179], a[156:159], v[96:111]
    ds_read_b128 v[172:175], v4 offset:46080
    v_rcp_f32 v239, v239
    v_fma_f32 v240, v240, v60, v60
    v_exp_f32 v241, v241
    v_mfma_f32_32x32x16_bf16 v[96:111], v[180:183], v[52:55], v[96:111]
    ds_read_b128 v[176:179], v4 offset:47104
    v_mul_f32 v71, v71, v239
    v_rcp_f32 v240, v240
    v_mul_f32 v81, v81, v89
    s_waitcnt lgkmcnt(5)
    v_mfma_f32_32x32x16_bf16 v[112:127], v[184:187], a[0:3], 0
    ds_read_b128 v[180:183], v4 offset:48128
    buffer_load_dwordx4 v198, s[4:7], s59 offen offset:3072 sc1 lds
    v_cvt_pk_bf16_f32 v211, v70, v71
    v_mul_f32 v80, v80, v240
    v_mfma_f32_32x32x16_bf16 v[112:127], v[188:191], a[4:7], v[112:127]
    ds_read_b128 v[184:187], v4 offset:49152
    s_add_u32 s45, s17, s34
    buffer_store_dwordx4 v[208:211], v8, s[4:7], s45 offen offset:0 sc1
    v_fma_f32 v241, v241, v60, v60
    v_mul_f32 v242, v82, v58
    v_mfma_f32_32x32x16_bf16 v[112:127], v[192:195], a[8:11], v[112:127]
    ds_read_b128 v[188:191], v4 offset:50176
    v_rcp_f32 v241, v241
    v_exp_f32 v242, v242
    s_waitcnt lgkmcnt(5)
    v_mfma_f32_32x32x16_bf16 v[112:127], v[160:163], a[12:15], v[112:127]
    ds_read_b128 v[192:195], v4 offset:51200
    v_mul_f32 v81, v81, v241
    v_mul_f32 v82, v82, v90
    v_fma_f32 v242, v242, v60, v60
    v_mul_f32 v243, v83, v58
    v_mul_f32 v244, v84, v58
    v_mfma_f32_32x32x16_bf16 v[112:127], v[164:167], a[16:19], v[112:127]
    ds_read_b128 v[160:163], v4 offset:52224
    v_cvt_pk_bf16_f32 v212, v80, v81
    v_rcp_f32 v242, v242
    v_exp_f32 v243, v243
    v_mfma_f32_32x32x16_bf16 v[112:127], v[168:171], a[20:23], v[112:127]
    ds_read_b128 v[164:167], v4 offset:53248
    v_mul_f32 v82, v82, v242
    v_mul_f32 v83, v83, v91
    v_fma_f32 v243, v243, v60, v60
    v_mul_f32 v84, v84, v92
    s_waitcnt lgkmcnt(5)
    v_mfma_f32_32x32x16_bf16 v[112:127], v[172:175], a[24:27], v[112:127]
    ds_read_b128 v[168:171], v4 offset:54272
    v_rcp_f32 v243, v243
    v_exp_f32 v244, v244
    v_mul_f32 v245, v85, v58
    v_mfma_f32_32x32x16_bf16 v[112:127], v[176:179], a[28:31], v[112:127]
    ds_read_b128 v[172:175], v4 offset:55296
    s_add_u32 m0, s84, 65536
    s_add_u32 s59, s22, 245760
    buffer_load_dwordx4 v196, s[4:7], s59 offen offset:0 sc1 lds
    v_mfma_f32_32x32x16_bf16 v[112:127], v[180:183], a[32:35], v[112:127]
    ds_read_b128 v[176:179], v4 offset:56320
    v_mul_f32 v83, v83, v243
    v_fma_f32 v244, v244, v60, v60
    v_exp_f32 v245, v245
    s_waitcnt lgkmcnt(5)
    v_mfma_f32_32x32x16_bf16 v[112:127], v[184:187], a[36:39], v[112:127]
    ds_read_b128 v[180:183], v4 offset:57344
    v_cvt_pk_bf16_f32 v213, v82, v83
    v_rcp_f32 v244, v244
    v_mul_f32 v85, v85, v93
    v_fma_f32 v245, v245, v60, v60
    v_mfma_f32_32x32x16_bf16 v[112:127], v[188:191], a[40:43], v[112:127]
    ds_read_b128 v[184:187], v4 offset:58368
    buffer_load_dwordx4 v196, s[4:7], s59 offen offset:1024 sc1 lds
    v_mul_f32 v84, v84, v244
    v_mul_f32 v246, v86, v58
    v_mfma_f32_32x32x16_bf16 v[112:127], v[192:195], a[44:47], v[112:127]
    ds_read_b128 v[188:191], v4 offset:59392
    v_rcp_f32 v245, v245
    v_exp_f32 v246, v246
    s_waitcnt lgkmcnt(5)
    v_mfma_f32_32x32x16_bf16 v[112:127], v[160:163], a[48:51], v[112:127]
    ds_read_b128 v[192:195], v4 offset:60416
    v_mul_f32 v85, v85, v245
    v_mul_f32 v86, v86, v94
    v_fma_f32 v246, v246, v60, v60
    v_mul_f32 v247, v87, v58
    v_mul_f32 v232, v96, v58
    v_mfma_f32_32x32x16_bf16 v[112:127], v[164:167], a[52:55], v[112:127]
    s_waitcnt vmcnt(20)
    s_barrier
    ds_read_b128 v[160:163], v4 offset:61440
    v_cvt_pk_bf16_f32 v214, v84, v85
    v_rcp_f32 v246, v246
    v_mfma_f32_32x32x16_bf16 v[112:127], v[168:171], a[56:59], v[112:127]
    ds_read_b128 v[164:167], v4 offset:62464
    s_add_u32 m0, s86, 73728
    s_add_u32 s59, s23, 0
    buffer_load_dwordx4 v198, s[4:7], s59 offen offset:0 sc1 lds
    s_waitcnt lgkmcnt(5)
    v_mfma_f32_32x32x16_bf16 v[112:127], v[172:175], a[60:63], v[112:127]
    ds_read_b128 v[168:171], v4 offset:63488
    v_mul_f32 v86, v86, v246
    v_exp_f32 v247, v247
    v_mul_f32 v87, v87, v95
    v_mul_f32 v96, v96, v104
    v_mfma_f32_32x32x16_bf16 v[112:127], v[176:179], a[64:67], v[112:127]
    ds_read_b128 v[172:175], v4 offset:64512
    v_fma_f32 v247, v247, v60, v60
    v_exp_f32 v232, v232
    v_mul_f32 v233, v97, v58
    v_mul_f32 v234, v98, v58
    v_mfma_f32_32x32x16_bf16 v[112:127], v[180:183], a[68:71], v[112:127]
    ds_read_b128 v[176:179], v5 offset:0
    buffer_load_dwordx4 v198, s[4:7], s59 offen offset:1024 sc1 lds
    v_fma_f32 v232, v232, v60, v60
    s_waitcnt lgkmcnt(5)
    v_mfma_f32_32x32x16_bf16 v[112:127], v[184:187], a[72:75], v[112:127]
    ds_read_b128 v[180:183], v5 offset:1024
    v_rcp_f32 v247, v247
    v_rcp_f32 v232, v232
    v_mul_f32 v97, v97, v105
    v_mfma_f32_32x32x16_bf16 v[112:127], v[188:191], a[76:79], v[112:127]
    ds_read_b128 v[184:187], v5 offset:2048
    buffer_load_dwordx4 v198, s[4:7], s59 offen offset:2048 sc1 lds
    v_mul_f32 v87, v87, v247
    v_mul_f32 v96, v96, v232
    v_mfma_f32_32x32x16_bf16 v[112:127], v[192:195], a[80:83], v[112:127]
    ds_read_b128 v[188:191], v5 offset:3072
    v_cvt_pk_bf16_f32 v215, v86, v87
    v_exp_f32 v233, v233
    v_mul_f32 v98, v98, v106
    s_waitcnt lgkmcnt(5)
    v_mfma_f32_32x32x16_bf16 v[112:127], v[160:163], a[84:87], v[112:127]
    ds_read_b128 v[192:195], v5 offset:4096
    s_add_u32 s45, s17, s34
    buffer_store_dwordx4 v[212:215], v8, s[4:7], s45 offen offset:512 sc1
    v_fma_f32 v233, v233, v60, v60
    v_mul_f32 v235, v99, v58
    v_mfma_f32_32x32x16_bf16 v[112:127], v[164:167], a[88:91], v[112:127]
    ds_read_b128 v[160:163], v5 offset:5120
    v_rcp_f32 v233, v233
    v_exp_f32 v234, v234
    v_mul_f32 v99, v99, v107
    v_mfma_f32_32x32x16_bf16 v[112:127], v[168:171], a[92:95], v[112:127]
    ds_read_b128 v[164:167], v5 offset:6144
    v_mul_f32 v97, v97, v233
    v_fma_f32 v234, v234, v60, v60
    v_exp_f32 v235, v235
    s_waitcnt lgkmcnt(5)
    v_mfma_f32_32x32x16_bf16 v[112:127], v[172:175], a[96:99], v[112:127]
    ds_read_b128 v[168:171], v5 offset:7168
    buffer_load_dwordx4 v198, s[4:7], s59 offen offset:3072 sc1 lds
    v_cvt_pk_bf16_f32 v216, v96, v97
    v_fma_f32 v235, v235, v60, v60
    v_mfma_f32_32x32x16_bf16 v[112:127], v[176:179], a[100:103], v[112:127]
    ds_read_b128 v[172:175], v5 offset:8192
    v_rcp_f32 v234, v234
    v_rcp_f32 v235, v235
    v_mul_f32 v236, v100, v58
    v_mfma_f32_32x32x16_bf16 v[112:127], v[180:183], a[104:107], v[112:127]
    ds_read_b128 v[176:179], v5 offset:9216
    s_add_u32 m0, s86, 90112
    s_add_u32 s59, s23, 16384
    buffer_load_dwordx4 v198, s[4:7], s59 offen offset:0 sc1 lds
    s_waitcnt lgkmcnt(5)
    v_mfma_f32_32x32x16_bf16 v[112:127], v[184:187], a[108:111], v[112:127]
    ds_read_b128 v[180:183], v5 offset:10240
    v_mul_f32 v98, v98, v234
    v_mul_f32 v99, v99, v235
    v_exp_f32 v236, v236
    v_mul_f32 v100, v100, v108
    v_mfma_f32_32x32x16_bf16 v[112:127], v[188:191], a[112:115], v[112:127]
    ds_read_b128 v[184:187], v5 offset:11264
    v_cvt_pk_bf16_f32 v217, v98, v99
    v_fma_f32 v236, v236, v60, v60
    v_mul_f32 v237, v101, v58
    v_mul_f32 v238, v102, v58
    v_mul_f32 v239, v103, v58
    v_mfma_f32_32x32x16_bf16 v[112:127], v[192:195], a[116:119], v[112:127]
    ds_read_b128 v[188:191], v5 offset:12288
    buffer_load_dwordx4 v198, s[4:7], s59 offen offset:1024 sc1 lds
    v_mul_f32 v101, v101, v109
    s_waitcnt lgkmcnt(5)
    v_mfma_f32_32x32x16_bf16 v[112:127], v[160:163], a[120:123], v[112:127]
    ds_read_b128 v[192:195], v5 offset:13312
    v_rcp_f32 v236, v236
    v_exp_f32 v237, v237
    v_mul_f32 v102, v102, v110
    v_mfma_f32_32x32x16_bf16 v[112:127], v[164:167], a[124:127], v[112:127]
    ds_read_b128 v[160:163], v5 offset:14336
    buffer_load_dwordx4 v198, s[4:7], s59 offen offset:2048 sc1 lds
    v_mul_f32 v100, v100, v236
    v_fma_f32 v237, v237, v60, v60
    v_mfma_f32_32x32x16_bf16 v[112:127], v[168:171], a[128:131], v[112:127]
    ds_read_b128 v[164:167], v5 offset:15360
    v_rcp_f32 v237, v237
    v_exp_f32 v238, v238
    s_waitcnt lgkmcnt(5)
    v_mfma_f32_32x32x16_bf16 v[112:127], v[172:175], a[132:135], v[112:127]
    ds_read_b128 v[168:171], v5 offset:16384
    buffer_load_dwordx4 v198, s[4:7], s59 offen offset:3072 sc1 lds
    v_mul_f32 v101, v101, v237
    v_fma_f32 v238, v238, v60, v60
    v_mfma_f32_32x32x16_bf16 v[112:127], v[176:179], a[136:139], v[112:127]
    ds_read_b128 v[172:175], v5 offset:17408
    v_cvt_pk_bf16_f32 v218, v100, v101
    v_rcp_f32 v238, v238
    v_exp_f32 v239, v239
    v_mfma_f32_32x32x16_bf16 v[112:127], v[180:183], a[140:143], v[112:127]
    ds_read_b128 v[176:179], v5 offset:18432
    v_mul_f32 v102, v102, v238
    v_mul_f32 v103, v103, v111
    v_fma_f32 v239, v239, v60, v60
    s_waitcnt lgkmcnt(5)
    v_mfma_f32_32x32x16_bf16 v[112:127], v[184:187], a[144:147], v[112:127]
    ds_read_b128 v[180:183], v5 offset:19456
    s_add_u32 m0, s85, 106496
    s_add_u32 s59, s23, 32768
    buffer_load_dwordx4 v197, s[4:7], s59 offen offset:0 sc1 lds
    v_mfma_f32_32x32x16_bf16 v[112:127], v[188:191], a[148:151], v[112:127]
    s_waitcnt vmcnt(25)
    s_barrier
    ds_read_b128 v[184:187], v5 offset:20480
    v_rcp_f32 v239, v239
    v_mfma_f32_32x32x16_bf16 v[112:127], v[192:195], a[152:155], v[112:127]
    ds_read_b128 v[188:191], v5 offset:21504
    buffer_load_dwordx4 v197, s[4:7], s59 offen offset:1024 sc1 lds
    v_mul_f32 v103, v103, v239
    s_waitcnt lgkmcnt(5)
    v_mfma_f32_32x32x16_bf16 v[112:127], v[160:163], a[156:159], v[112:127]
    ds_read_b128 v[192:195], v5 offset:22528
    v_cvt_pk_bf16_f32 v219, v102, v103
    v_mfma_f32_32x32x16_bf16 v[112:127], v[164:167], v[52:55], v[112:127]
    ds_read_b128 v[160:163], v5 offset:23552
    s_add_u32 s45, s17, s35
    buffer_store_dwordx4 v[216:219], v8, s[4:7], s45 offen offset:0 sc1
    v_mfma_f32_32x32x16_bf16 v[128:143], v[168:171], a[0:3], 0
    ds_read_b128 v[164:167], v5 offset:24576
    s_waitcnt lgkmcnt(5)
    v_mfma_f32_32x32x16_bf16 v[128:143], v[172:175], a[4:7], v[128:143]
    ds_read_b128 v[168:171], v5 offset:25600
    s_nop 3
    v_mul_f32 v240, v112, v58
    v_mul_f32 v241, v113, v58
    v_mul_f32 v242, v114, v58
    v_mul_f32 v243, v115, v58
    v_mul_f32 v244, v116, v58
    v_mfma_f32_32x32x16_bf16 v[128:143], v[176:179], a[8:11], v[128:143]
    ds_read_b128 v[172:175], v5 offset:26624
    s_waitcnt vmcnt(8)
    s_mul_i32 s57, s24, 256
    s_add_u32 s57, s57, s18
    s_add_u32 s57, s57, 65536
    s_atomic_add s62, s[12:13], s57
    v_mfma_f32_32x32x16_bf16 v[128:143], v[180:183], a[12:15], v[128:143]
Lw_9:
    s_cbranch_execz Lw_10
    ds_read_b128 v[176:179], v5 offset:27648
    buffer_load_dwordx4 v197, s[4:7], s59 offen offset:2048 sc1 lds
    v_mul_f32 v112, v112, v120
    s_waitcnt lgkmcnt(5)
    v_mfma_f32_32x32x16_bf16 v[128:143], v[184:187], a[16:19], v[128:143]
    ds_read_b128 v[180:183], v2 offset:0
    v_exp_f32 v240, v240
    v_exp_f32 v241, v241
    v_mul_f32 v113, v113, v121
    v_mfma_f32_32x32x16_bf16 v[128:143], v[188:191], a[20:23], v[128:143]
    ds_read_b128 v[184:187], v2 offset:1024
    s_add_u32 m0, s86, 118784
    s_add_u32 s59, s23, 45056
    buffer_load_dwordx4 v198, s[4:7], s59 offen offset:0 sc1 lds
    v_mfma_f32_32x32x16_bf16 v[128:143], v[192:195], a[24:27], v[128:143]
    ds_read_b128 v[188:191], v2 offset:2048
    v_fma_f32 v240, v240, v60, v60
    v_fma_f32 v241, v241, v60, v60
    v_exp_f32 v242, v242
    s_waitcnt lgkmcnt(5)
    v_mfma_f32_32x32x16_bf16 v[128:143], v[160:163], a[28:31], v[128:143]
    ds_read_b128 v[192:195], v2 offset:3072
    buffer_load_dwordx4 v198, s[4:7], s59 offen offset:1024 sc1 lds
    v_rcp_f32 v240, v240
    v_mfma_f32_32x32x16_bf16 v[128:143], v[164:167], a[32:35], v[128:143]
    ds_read_b128 v[160:163], v2 offset:4096
    v_mul_f32 v112, v112, v240
    v_rcp_f32 v241, v241
    v_mul_f32 v114, v114, v122
    v_fma_f32 v242, v242, v60, v60
    v_mfma_f32_32x32x16_bf16 v[128:143], v[168:171], a[36:39], v[128:143]
    ds_read_b128 v[164:167], v2 offset:5120
    buffer_load_dwordx4 v198, s[4:7], s59 offen offset:2048 sc1 lds
    v_mul_f32 v113, v113, v241
    s_waitcnt lgkmcnt(5)
    v_mfma_f32_32x32x16_bf16 v[128:143], v[172:175], a[40:43], v[128:143]
    ds_read_b128 v[168:171], v2 offset:6144
    v_cvt_pk_bf16_f32 v220, v112, v113
    v_rcp_f32 v242, v242
    v_exp_f32 v243, v243
    v_mfma_f32_32x32x16_bf16 v[128:143], v[176:179], a[44:47], v[128:143]
    ds_read_b128 v[172:175], v2 offset:7168
    v_mul_f32 v114, v114, v242
    v_mul_f32 v115, v115, v123
    v_fma_f32 v243, v243, v60, v60
    v_exp_f32 v244, v244
    v_mfma_f32_32x32x16_bf16 v[128:143], v[180:183], a[48:51], v[128:143]
    ds_read_b128 v[176:179], v2 offset:8192
    buffer_load_dwordx4 v198, s[4:7], s59 offen offset:3072 sc1 lds
    v_mul_f32 v116, v116, v124
    s_waitcnt lgkmcnt(5)
    v_mfma_f32_32x32x16_bf16 v[128:143], v[184:187], a[52:55], v[128:143]
    ds_read_b128 v[180:183], v2 offset:9216
    v_rcp_f32 v243, v243
    v_fma_f32 v244, v244, v60, v60
    v_mul_f32 v245, v117, v58
    v_mul_f32 v246, v118, v58
    v_mfma_f32_32x32x16_bf16 v[128:143], v[188:191], a[56:59], v[128:143]
    ds_read_b128 v[184:187], v2 offset:10240
    s_add_u32 m0, s84, 135168
    s_add_u32 s59, s23, 61440
    buffer_load_dwordx4 v196, s[4:7], s59 offen offset:0 sc1 lds
    v_mfma_f32_32x32x16_bf16 v[128:143], v[192:195], a[60:63], v[128:143]
    ds_read_b128 v[188:191], v2 offset:11264
    v_mul_f32 v115, v115, v243
    v_rcp_f32 v244, v244
    v_mul_f32 v117, v117, v125
    s_waitcnt lgkmcnt(5)
    v_mfma_f32_32x32x16_bf16 v[128:143], v[160:163], a[64:67], v[128:143]
    ds_read_b128 v[192:195], v2 offset:12288
    buffer_load_dwordx4 v196, s[4:7], s59 offen offset:1024 sc1 lds
    v_cvt_pk_bf16_f32 v221, v114, v115
    v_mul_f32 v116, v116, v244
    v_mfma_f32_32x32x16_bf16 v[128:143], v[164:167], a[68:71], v[128:143]
    ds_read_b128 v[160:163], v2 offset:13312
    v_exp_f32 v245, v245
    v_exp_f32 v246, v246
    v_mul_f32 v118, v118, v126
    v_mfma_f32_32x32x16_bf16 v[128:143], v[168:171], a[72:75], v[128:143]
    ds_read_b128 v[164:167], v2 offset:14336
    v_fma_f32 v245, v245, v60, v60
    v_fma_f32 v246, v246, v60, v60
    v_mul_f32 v247, v119, v58
    s_waitcnt lgkmcnt(5)
    v_mfma_f32_32x32x16_bf16 v[128:143], v[172:175], a[76:79], v[128:143]
    ds_read_b128 v[168:171], v2 offset:15360
    v_rcp_f32 v245, v245
    v_rcp_f32 v246, v246
    v_mul_f32 v119, v119, v127
    v_mfma_f32_32x32x16_bf16 v[128:143], v[176:179], a[80:83], v[128:143]
    s_barrier
    ds_read_b128 v[172:175], v2 offset:16384
    s_add_u32 m0, s86, 143360
    s_add_u32 s59, s23, 69632
    buffer_load_dwordx4 v198, s[4:7], s59 offen offset:0 sc1 lds
    v_mfma_f32_32x32x16_bf16 v[128:143], v[180:183], a[84:87], v[128:143]
    ds_read_b128 v[176:179], v2 offset:17408
    v_mul_f32 v117, v117, v245
    v_mul_f32 v118, v118, v246
    v_exp_f32 v247, v247
    s_waitcnt lgkmcnt(5)
    v_mfma_f32_32x32x16_bf16 v[128:143], v[184:187], a[88:91], v[128:143]
    ds_read_b128 v[180:183], v2 offset:18432
    buffer_load_dwordx4 v198, s[4:7], s59 offen offset:1024 sc1 lds
    v_cvt_pk_bf16_f32 v222, v116, v117
    v_fma_f32 v247, v247, v60, v60
    v_mfma_f32_32x32x16_bf16 v[128:143], v[188:191], a[92:95], v[128:143]
    ds_read_b128 v[184:187], v2 offset:19456
    v_rcp_f32 v247, v247
    v_mfma_f32_32x32x16_bf16 v[128:143], v[192:195], a[96:99], v[128:143]
    ds_read_b128 v[188:191], v2 offset:20480
    buffer_load_dwordx4 v198, s[4:7], s59 offen offset:2048 sc1 lds
    v_mul_f32 v119, v119, v247
    s_waitcnt lgkmcnt(5)
    v_mfma_f32_32x32x16_bf16 v[128:143], v[160:163], a[100:103], v[128:143]
    ds_read_b128 v[192:195], v2 offset:21504
    v_cvt_pk_bf16_f32 v223, v118, v119
    v_mfma_f32_32x32x16_bf16 v[128:143], v[164:167], a[104:107], v[128:143]
    ds_read_b128 v[160:163], v2 offset:22528
    s_mul_i32 s56, s26, 256
    s_add_u32 s56, s56, s18
    s_add_u32 s56, s56, 65536
    s_mov_b32 s63, 0
    s_atomic_add s63, s[12:13], s56 glc
    v_mfma_f32_32x32x16_bf16 v[128:143], v[168:171], a[108:111], v[128:143]
    ds_read_b128 v[164:167], v2 offset:23552
    s_add_u32 s45, s17, s35
    buffer_store_dwordx4 v[220:223], v8, s[4:7], s45 offen offset:512 sc1
    s_waitcnt lgkmcnt(5)
    v_mfma_f32_32x32x16_bf16 v[128:143], v[172:175], a[112:115], v[128:143]
    ds_read_b128 v[168:171], v2 offset:24576
    s_add_u32 s54, s17, s31
    s_add_u32 s54, s54, 25165824
    buffer_store_dwordx4 v[204:207], v9, s[64:67], s54 offen sc1
    v_mfma_f32_32x32x16_bf16 v[128:143], v[176:179], a[116:119], v[128:143]
    ds_read_b128 v[172:175], v2 offset:25600
    v_mfma_f32_32x32x16_bf16 v[128:143], v[180:183], a[120:123], v[128:143]
    ds_read_b128 v[176:179], v2 offset:26624
    s_waitcnt lgkmcnt(5)
    v_mfma_f32_32x32x16_bf16 v[128:143], v[184:187], a[124:127], v[128:143]
    ds_read_b128 v[180:183], v2 offset:27648
    buffer_store_dwordx4 v[204:207], v9, s[64:67], s54 offen offset:2048 sc1
    v_mfma_f32_32x32x16_bf16 v[128:143], v[188:191], a[128:131], v[128:143]
    ds_read_b128 v[184:187], v2 offset:28672
    v_mfma_f32_32x32x16_bf16 v[128:143], v[192:195], a[132:135], v[128:143]
    ds_read_b128 v[188:191], v2 offset:29696
    buffer_load_dwordx4 v198, s[4:7], s59 offen offset:3072 sc1 lds
    s_waitcnt lgkmcnt(5)
    v_mfma_f32_32x32x16_bf16 v[128:143], v[160:163], a[136:139], v[128:143]
    ds_read_b128 v[192:195], v2 offset:30720
    s_mov_b32 exec_lo, 0xffff
    s_mov_b32 exec_hi, 0xffff
    buffer_store_dwordx4 v[204:207], v10, s[64:67], s54 offen sc1
    s_mov_b64 exec, -1
    v_mfma_f32_32x32x16_bf16 v[128:143], v[164:167], a[140:143], v[128:143]
    ds_read_b128 v[160:163], v2 offset:31744
    v_mfma_f32_32x32x16_bf16 v[128:143], v[168:171], a[144:147], v[128:143]
    ds_read_b128 v[164:167], v2 offset:32768
    s_waitcnt lgkmcnt(5)
    v_mfma_f32_32x32x16_bf16 v[128:143], v[172:175], a[148:151], v[128:143]
    ds_read_b128 v[168:171], v2 offset:33792
    v_mfma_f32_32x32x16_bf16 v[128:143], v[176:179], a[152:155], v[128:143]
    ds_read_b128 v[172:175], v2 offset:34816
    s_add_u32 m0, s84, 0
    s_add_u32 s59, s23, 86016
    buffer_load_dwordx4 v196, s[4:7], s59 offen offset:0 sc1 lds
    v_mfma_f32_32x32x16_bf16 v[128:143], v[180:183], a[156:159], v[128:143]
    ds_read_b128 v[176:179], v2 offset:35840
    s_waitcnt lgkmcnt(5)
    v_mfma_f32_32x32x16_bf16 v[128:143], v[184:187], v[52:55], v[128:143]
    ds_read_b128 v[180:183], v2 offset:36864
    buffer_load_dwordx4 v196, s[4:7], s59 offen offset:1024 sc1 lds
    v_mfma_f32_32x32x16_bf16 v[144:159], v[188:191], a[0:3], 0
    ds_read_b128 v[184:187], v2 offset:37888
    v_mfma_f32_32x32x16_bf16 v[144:159], v[192:195], a[4:7], v[144:159]
    ds_read_b128 v[188:191], v2 offset:38912
    s_nop 5
    v_mul_f32 v232, v128, v58
    v_mul_f32 v233, v129, v58
    v_mul_f32 v234, v130, v58
    v_mul_f32 v235, v131, v58
    s_waitcnt lgkmcnt(5)
    v_mfma_f32_32x32x16_bf16 v[144:159], v[160:163], a[8:11], v[144:159]
    ds_read_b128 v[192:195], v2 offset:39936
    v_exp_f32 v232, v232
    v_mul_f32 v128, v128, v136
    v_exp_f32 v233, v233
    v_mfma_f32_32x32x16_bf16 v[144:159], v[164:167], a[12:15], v[144:159]
    s_barrier
    ds_read_b128 v[160:163], v2 offset:40960
    s_add_u32 m0, s86, 8192
    s_add_u32 s59, s23, 94208
    buffer_load_dwordx4 v198, s[4:7], s59 offen offset:0 sc1 lds
    v_mfma_f32_32x32x16_bf16 v[144:159], v[168:171], a[16:19], v[144:159]
    ds_read_b128 v[164:167], v2 offset:41984
    v_fma_f32 v232, v232, v60, v60
    v_mul_f32 v129, v129, v137
    v_fma_f32 v233, v233, v60, v60
    v_mul_f32 v130, v130, v138
    s_waitcnt lgkmcnt(5)
    v_mfma_f32_32x32x16_bf16 v[144:159], v[172:175], a[20:23], v[144:159]
    ds_read_b128 v[168:171], v2 offset:43008
    buffer_load_dwordx4 v198, s[4:7], s59 offen offset:1024 sc1 lds
    v_rcp_f32 v232, v232
    v_mfma_f32_32x32x16_bf16 v[144:159], v[176:179], a[24:27], v[144:159]
    ds_read_b128 v[172:175], v2 offset:44032
    v_mul_f32 v128, v128, v232
    v_rcp_f32 v233, v233
    v_exp_f32 v234, v234
    v_mfma_f32_32x32x16_bf16 v[144:159], v[180:183], a[28:31], v[144:159]
    ds_read_b128 v[176:179], v2 offset:45056
Lpoll_207:
    s_mov_b32 s55, 0
Lpoll_207_l:
    s_waitcnt lgkmcnt(0)
    s_bfe_u32 s63, s63, 524288
    s_cmp_ge_u32 s63, 16
    s_cbranch_scc1 Lok_208
    s_mov_b32 s63, 0
    s_atomic_add s63, s[12:13], s56 glc
    s_add_u32 s55, s55, 1
    s_cmp_lt_u32 s55, 400000
    s_cbranch_scc1 Lpoll_207_l
    s_waitcnt lgkmcnt(0)
Lok_208:
    s_waitcnt vmcnt(8)
    s_mul_i32 s57, s24, 256
    s_add_u32 s57, s57, s18
    s_add_u32 s57, s57, 81920
    s_atomic_add s62, s[12:13], s57
    v_mfma_f32_32x32x16_bf16 v[144:159], v[184:187], a[32:35], v[144:159]
    ds_read_b128 v[180:183], v2 offset:46080
    s_add_u32 s70, s17, s30
    s_add_u32 s70, s70, 12582912
    buffer_load_dwordx4 a[0:3], v2, s[4:7], s70 offen offset:0 sc1
    v_mul_f32 v129, v129, v233
    v_fma_f32 v234, v234, v60, v60
    v_mul_f32 v131, v131, v139
    v_mfma_f32_32x32x16_bf16 v[144:159], v[188:191], a[36:39], v[144:159]
    ds_read_b128 v[184:187], v2 offset:47104
    v_cvt_pk_bf16_f32 v224, v128, v129
    v_rcp_f32 v234, v234
    v_exp_f32 v235, v235
    v_mfma_f32_32x32x16_bf16 v[144:159], v[192:195], a[40:43], v[144:159]
    ds_read_b128 v[188:191], v2 offset:48128
    buffer_load_dwordx4 a[4:7], v2, s[4:7], s70 offen offset:1024 sc1
    v_mul_f32 v130, v130, v234
    v_fma_f32 v235, v235, v60, v60
    v_mfma_f32_32x32x16_bf16 v[144:159], v[160:163], a[44:47], v[144:159]
    ds_read_b128 v[192:195], v2 offset:49152
    v_rcp_f32 v235, v235
    v_mul_f32 v236, v132, v58
    v_mul_f32 v237, v133, v58
    v_mul_f32 v238, v134, v58
    v_mfma_f32_32x32x16_bf16 v[144:159], v[164:167], a[48:51], v[144:159]
    ds_read_b128 v[160:163], v2 offset:50176
    buffer_load_dwordx4 v198, s[4:7], s59 offen offset:2048 sc1 lds
    v_mul_f32 v131, v131, v235
    v_mul_f32 v132, v132, v140
    v_mfma_f32_32x32x16_bf16 v[144:159], v[168:171], a[52:55], v[144:159]
    ds_read_b128 v[164:167], v2 offset:51200
    buffer_load_dwordx4 a[8:11], v2, s[4:7], s70 offen offset:2048 sc1
    v_cvt_pk_bf16_f32 v225, v130, v131
    v_mul_f32 v133, v133, v141
    s_waitcnt lgkmcnt(5)
    v_mfma_f32_32x32x16_bf16 v[144:159], v[172:175], a[56:59], v[144:159]
    ds_read_b128 v[168:171], v2 offset:52224
    v_exp_f32 v236, v236
    v_exp_f32 v237, v237
    v_mul_f32 v134, v134, v142
    v_mfma_f32_32x32x16_bf16 v[144:159], v[176:179], a[60:63], v[144:159]
    ds_read_b128 v[172:175], v2 offset:53248
    buffer_load_dwordx4 a[12:15], v2, s[4:7], s70 offen offset:3072 sc1
    v_fma_f32 v236, v236, v60, v60
    v_fma_f32 v237, v237, v60, v60
    v_mul_f32 v239, v135, v58
    v_mfma_f32_32x32x16_bf16 v[144:159], v[180:183], a[64:67], v[144:159]
    ds_read_b128 v[176:179], v2 offset:54272
    v_rcp_f32 v236, v236
    v_rcp_f32 v237, v237
    s_waitcnt lgkmcnt(5)
    v_mfma_f32_32x32x16_bf16 v[144:159], v[184:187], a[68:71], v[144:159]
    ds_read_b128 v[180:183], v2 offset:55296
    v_mul_f32 v132, v132, v236
    v_mul_f32 v133, v133, v237
    v_exp_f32 v238, v238
    v_mul_f32 v135, v135, v143
    v_mfma_f32_32x32x16_bf16 v[144:159], v[188:191], a[72:75], v[144:159]
    ds_read_b128 v[184:187], v2 offset:56320
    s_add_u32 s70, s70, 4096
    buffer_load_dwordx4 a[16:19], v2, s[4:7], s70 offen offset:0 sc1
    v_cvt_pk_bf16_f32 v226, v132, v133
    v_fma_f32 v238, v238, v60, v60
    v_mfma_f32_32x32x16_bf16 v[144:159], v[192:195], a[76:79], v[144:159]
    ds_read_b128 v[188:191], v2 offset:57344
    v_rcp_f32 v238, v238
    v_exp_f32 v239, v239
    s_waitcnt lgkmcnt(5)
    v_mfma_f32_32x32x16_bf16 v[144:159], v[160:163], a[80:83], v[144:159]
    ds_read_b128 v[192:195], v2 offset:58368
    v_mul_f32 v134, v134, v238
    v_fma_f32 v239, v239, v60, v60
    v_mfma_f32_32x32x16_bf16 v[144:159], v[164:167], a[84:87], v[144:159]
    ds_read_b128 v[160:163], v2 offset:59392
    buffer_load_dwordx4 a[20:23], v2, s[4:7], s70 offen offset:1024 sc1
    v_rcp_f32 v239, v239
    v_mfma_f32_32x32x16_bf16 v[144:159], v[168:171], a[88:91], v[144:159]
    ds_read_b128 v[164:167], v2 offset:60416
    v_mul_f32 v135, v135, v239
    s_waitcnt lgkmcnt(5)
    v_mfma_f32_32x32x16_bf16 v[144:159], v[172:175], a[92:95], v[144:159]
    ds_read_b128 v[168:171], v2 offset:61440
    buffer_load_dwordx4 a[24:27], v2, s[4:7], s70 offen offset:2048 sc1
    v_cvt_pk_bf16_f32 v227, v134, v135
    v_mfma_f32_32x32x16_bf16 v[144:159], v[176:179], a[96:99], v[144:159]
    ds_read_b128 v[172:175], v2 offset:62464
    s_add_u32 s45, s17, s36
    buffer_store_dwordx4 v[224:227], v8, s[4:7], s45 offen offset:0 sc1
    v_mfma_f32_32x32x16_bf16 v[144:159], v[180:183], a[100:103], v[144:159]
    ds_read_b128 v[176:179], v2 offset:63488
    s_waitcnt lgkmcnt(5)
    v_mfma_f32_32x32x16_bf16 v[144:159], v[184:187], a[104:107], v[144:159]
    ds_read_b128 v[180:183], v2 offset:64512
    buffer_load_dwordx4 a[28:31], v2, s[4:7], s70 offen offset:3072 sc1
    v_mfma_f32_32x32x16_bf16 v[144:159], v[188:191], a[108:111], v[144:159]
    s_barrier
    ds_read_b128 v[184:187], v4 offset:0
    v_mfma_f32_32x32x16_bf16 v[144:159], v[192:195], a[112:115], v[144:159]
    ds_read_b128 v[188:191], v4 offset:1024
    s_add_u32 s70, s70, 12288
    buffer_load_dwordx4 a[32:35], v2, s[4:7], s70 offen offset:0 sc1
    s_waitcnt lgkmcnt(5)
    v_mfma_f32_32x32x16_bf16 v[144:159], v[160:163], a[116:119], v[144:159]
    ds_read_b128 v[192:195], v4 offset:2048
    v_mfma_f32_32x32x16_bf16 v[144:159], v[164:167], a[120:123], v[144:159]
    ds_read_b128 v[160:163], v4 offset:3072
    v_mfma_f32_32x32x16_bf16 v[144:159], v[168:171], a[124:127], v[144:159]
    ds_read_b128 v[164:167], v4 offset:4096
    buffer_load_dwordx4 a[36:39], v2, s[4:7], s70 offen offset:1024 sc1
    s_waitcnt lgkmcnt(5)
    v_mfma_f32_32x32x16_bf16 v[144:159], v[172:175], a[128:131], v[144:159]
    ds_read_b128 v[168:171], v4 offset:5120
    v_mfma_f32_32x32x16_bf16 v[144:159], v[176:179], a[132:135], v[144:159]
    v_mfma_f32_32x32x16_bf16 v[144:159], v[180:183], a[136:139], v[144:159]
    buffer_load_dwordx4 a[40:43], v2, s[4:7], s70 offen offset:2048 sc1
    s_waitcnt lgkmcnt(3)
    v_mfma_f32_32x32x16_bf16 v[144:159], v[184:187], a[140:143], v[144:159]
    v_mfma_f32_32x32x16_bf16 v[144:159], v[188:191], a[144:147], v[144:159]
    buffer_load_dwordx4 a[44:47], v2, s[4:7], s70 offen offset:3072 sc1
    v_mfma_f32_32x32x16_bf16 v[144:159], v[192:195], a[148:151], v[144:159]
    s_waitcnt lgkmcnt(0)
    v_mfma_f32_32x32x16_bf16 v[144:159], v[160:163], a[152:155], v[144:159]
    v_mfma_f32_32x32x16_bf16 v[144:159], v[164:167], a[156:159], v[144:159]
    s_add_u32 s70, s70, 4096
    buffer_load_dwordx4 a[48:51], v2, s[4:7], s70 offen offset:0 sc1
    v_mfma_f32_32x32x16_bf16 v[144:159], v[168:171], v[52:55], v[144:159]
    s_mul_i32 s56, s26, 256
    s_add_u32 s56, s56, s18
    s_add_u32 s56, s56, 81920
    s_mov_b32 s63, 0
    s_atomic_add s63, s[12:13], s56 glc
    s_barrier
    ds_read_b128 v[64:67], v4 offset:8192
    ds_read_b128 v[68:71], v4 offset:9216
    ds_read_b128 v[72:75], v4 offset:10240
    ds_read_b128 v[76:79], v4 offset:11264
    ds_read_b128 v[80:83], v4 offset:12288
    ds_read_b128 v[84:87], v4 offset:13312
    ds_read_b128 v[88:91], v4 offset:14336
    ds_read_b128 v[92:95], v4 offset:15360
    ds_read_b128 v[96:99], v4 offset:16384
    ds_read_b128 v[100:103], v4 offset:17408
    ds_read_b128 v[104:107], v4 offset:18432
    ds_read_b128 v[108:111], v4 offset:19456
    ds_read_b128 v[112:115], v4 offset:20480
    ds_read_b128 v[116:119], v4 offset:21504
    buffer_load_dwordx4 a[52:55], v2, s[4:7], s70 offen offset:1024 sc1
    v_mul_f32 v240, v144, v58
    v_mul_f32 v241, v145, v58
    v_mul_f32 v242, v146, v58
    v_mul_f32 v243, v147, v58
    v_mul_f32 v244, v148, v58
    v_mul_f32 v245, v149, v58
    v_exp_f32 v240, v240
    v_mul_f32 v144, v144, v152
    v_exp_f32 v241, v241
    v_mul_f32 v145, v145, v153
    v_exp_f32 v242, v242
    buffer_load_dwordx4 a[56:59], v2, s[4:7], s70 offen offset:2048 sc1
    v_fma_f32 v240, v240, v60, v60
    v_fma_f32 v241, v241, v60, v60
    v_mul_f32 v146, v146, v154
    v_fma_f32 v242, v242, v60, v60
    v_exp_f32 v243, v243
    v_rcp_f32 v240, v240
    v_rcp_f32 v241, v241
    v_rcp_f32 v242, v242
    v_mul_f32 v147, v147, v155
    v_fma_f32 v243, v243, v60, v60
    buffer_load_dwordx4 a[60:63], v2, s[4:7], s70 offen offset:3072 sc1
    v_mul_f32 v144, v144, v240
    v_mul_f32 v145, v145, v241
    v_mul_f32 v146, v146, v242
    v_rcp_f32 v243, v243
    v_mul_f32 v148, v148, v156
    v_cvt_pk_bf16_f32 v228, v144, v145
    v_mul_f32 v147, v147, v243
    v_exp_f32 v244, v244
    v_exp_f32 v245, v245
    v_mul_f32 v149, v149, v157
    v_mul_f32 v246, v150, v58
    v_cvt_pk_bf16_f32 v229, v146, v147
    v_fma_f32 v244, v244, v60, v60
    v_fma_f32 v245, v245, v60, v60
    v_exp_f32 v246, v246
    v_mul_f32 v150, v150, v158
    v_mul_f32 v247, v151, v58
    buffer_load_dwordx4 v198, s[4:7], s59 offen offset:3072 sc1 lds
    v_rcp_f32 v244, v244
    v_rcp_f32 v245, v245
    v_fma_f32 v246, v246, v60, v60
    v_mul_f32 v148, v148, v244
    v_mul_f32 v149, v149, v245
    v_rcp_f32 v246, v246
    v_exp_f32 v247, v247
    v_mul_f32 v151, v151, v159
    v_cvt_pk_bf16_f32 v230, v148, v149
    v_mul_f32 v150, v150, v246
    v_fma_f32 v247, v247, v60, v60
    s_add_u32 m0, s84, 24576
    s_add_u32 s59, s23, 110592
    buffer_load_dwordx4 v196, s[4:7], s59 offen offset:0 sc1 lds
    v_rcp_f32 v247, v247
    s_nop 0
    v_mul_f32 v151, v151, v247
    buffer_load_dwordx4 v196, s[4:7], s59 offen offset:1024 sc1 lds
    v_cvt_pk_bf16_f32 v231, v150, v151
    s_add_u32 s45, s17, s36
    s_add_u32 s45, s45, 16384
    buffer_store_dwordx4 v[228:231], v8, s[4:7], s45 offen offset:0 sc1
    s_waitcnt vmcnt(21) lgkmcnt(9)
    v_mfma_f32_16x16x32_bf16 v[32:35], v[64:67], a[0:3], v[32:35]
    ds_read_b128 v[120:123], v4 offset:22528
    s_waitcnt vmcnt(13)
    s_mul_i32 s57, s24, 256
    s_add_u32 s57, s57, s18
    s_add_u32 s57, s57, 98304
    s_atomic_add s62, s[12:13], s57
    v_mfma_f32_16x16x32_bf16 v[36:39], v[68:71], a[0:3], v[36:39]
    ds_read_b128 v[64:67], v4 offset:23552
    s_add_u32 m0, s84, 32768
    v_mfma_f32_16x16x32_bf16 v[40:43], v[72:75], a[0:3], v[40:43]
    ds_read_b128 v[68:71], v4 offset:24576
    s_add_u32 s59, s23, 118784
    v_mfma_f32_16x16x32_bf16 v[44:47], v[76:79], a[0:3], v[44:47]
    ds_read_b128 v[72:75], v4 offset:25600
    buffer_load_dwordx4 v196, s[4:7], s59 offen offset:0 sc1 lds
    v_mfma_f32_16x16x32_bf16 v[48:51], v[80:83], a[0:3], v[48:51]
    ds_read_b128 v[76:79], v4 offset:26624
    s_waitcnt lgkmcnt(9)
    v_mfma_f32_16x16x32_bf16 v[32:35], v[84:87], a[4:7], v[32:35]
    ds_read_b128 v[80:83], v4 offset:27648
    buffer_load_dwordx4 v196, s[4:7], s59 offen offset:1024 sc1 lds
    v_mfma_f32_16x16x32_bf16 v[36:39], v[88:91], a[4:7], v[36:39]
    s_barrier
    ds_read_b128 v[84:87], v4 offset:28672
    v_mfma_f32_16x16x32_bf16 v[40:43], v[92:95], a[4:7], v[40:43]
    ds_read_b128 v[88:91], v4 offset:29696
    s_add_u32 m0, s84, 40960
    v_mfma_f32_16x16x32_bf16 v[44:47], v[96:99], a[4:7], v[44:47]
    ds_read_b128 v[92:95], v4 offset:30720
    s_add_u32 s59, s23, 126976
    v_mfma_f32_16x16x32_bf16 v[48:51], v[100:103], a[4:7], v[48:51]
    ds_read_b128 v[96:99], v4 offset:31744
    s_waitcnt lgkmcnt(9)
    v_mfma_f32_16x16x32_bf16 v[32:35], v[104:107], a[8:11], v[32:35]
    ds_read_b128 v[100:103], v4 offset:32768
    buffer_load_dwordx4 v196, s[4:7], s59 offen offset:0 sc1 lds
    v_mfma_f32_16x16x32_bf16 v[36:39], v[108:111], a[8:11], v[36:39]
    ds_read_b128 v[104:107], v4 offset:33792
    v_mfma_f32_16x16x32_bf16 v[40:43], v[112:115], a[8:11], v[40:43]
    ds_read_b128 v[108:111], v4 offset:34816
    buffer_load_dwordx4 v196, s[4:7], s59 offen offset:1024 sc1 lds
    v_mfma_f32_16x16x32_bf16 v[44:47], v[116:119], a[8:11], v[44:47]
    ds_read_b128 v[112:115], v4 offset:35840
    s_add_u32 m0, s84, 49152
    v_mfma_f32_16x16x32_bf16 v[48:51], v[120:123], a[8:11], v[48:51]
    ds_read_b128 v[116:119], v4 offset:36864
    s_waitcnt lgkmcnt(9)
    v_mfma_f32_16x16x32_bf16 v[32:35], v[64:67], a[12:15], v[32:35]
    ds_read_b128 v[120:123], v4 offset:37888
    s_add_u32 s59, s23, 135168
    v_mfma_f32_16x16x32_bf16 v[36:39], v[68:71], a[12:15], v[36:39]
    ds_read_b128 v[64:67], v4 offset:38912
    buffer_load_dwordx4 v196, s[4:7], s59 offen offset:0 sc1 lds
    v_mfma_f32_16x16x32_bf16 v[40:43], v[72:75], a[12:15], v[40:43]
    ds_read_b128 v[68:71], v4 offset:39936
    v_mfma_f32_16x16x32_bf16 v[44:47], v[76:79], a[12:15], v[44:47]
    ds_read_b128 v[72:75], v4 offset:40960
    buffer_load_dwordx4 v196, s[4:7], s59 offen offset:1024 sc1 lds
    v_mfma_f32_16x16x32_bf16 v[48:51], v[80:83], a[12:15], v[48:51]
    ds_read_b128 v[76:79], v4 offset:41984
    s_waitcnt lgkmcnt(9)
    v_mfma_f32_16x16x32_bf16 v[32:35], v[84:87], a[16:19], v[32:35]
    ds_read_b128 v[80:83], v4 offset:43008
Lpoll_209:
    s_mov_b32 s55, 0
Lpoll_209_l:
    s_waitcnt lgkmcnt(0)
    s_bfe_u32 s63, s63, 524288
    s_cmp_ge_u32 s63, 16
    s_cbranch_scc1 Lok_210
    s_mov_b32 s63, 0
    s_atomic_add s63, s[12:13], s56 glc
    s_add_u32 s55, s55, 1
    s_cmp_lt_u32 s55, 400000
    s_cbranch_scc1 Lpoll_209_l
    s_waitcnt lgkmcnt(0)
Lok_210:
    v_mfma_f32_16x16x32_bf16 v[36:39], v[88:91], a[16:19], v[36:39]
    ds_read_b128 v[84:87], v4 offset:44032
    s_add_u32 s70, s70, 12288
    v_mfma_f32_16x16x32_bf16 v[40:43], v[92:95], a[16:19], v[40:43]
    ds_read_b128 v[88:91], v4 offset:45056
    buffer_load_dwordx4 a[64:67], v2, s[4:7], s70 offen offset:0 sc1
    v_mfma_f32_16x16x32_bf16 v[44:47], v[96:99], a[16:19], v[44:47]
    ds_read_b128 v[92:95], v4 offset:46080
    s_add_u32 m0, s84, 57344
    v_mfma_f32_16x16x32_bf16 v[48:51], v[100:103], a[16:19], v[48:51]
    ds_read_b128 v[96:99], v4 offset:47104
    v_mfma_f32_16x16x32_bf16 v[32:35], v[104:107], a[20:23], v[32:35]
    ds_read_b128 v[100:103], v4 offset:48128
    buffer_load_dwordx4 a[68:71], v2, s[4:7], s70 offen offset:1024 sc1
    v_mfma_f32_16x16x32_bf16 v[36:39], v[108:111], a[20:23], v[36:39]
    s_barrier
    ds_read_b128 v[104:107], v4 offset:49152
    v_mfma_f32_16x16x32_bf16 v[40:43], v[112:115], a[20:23], v[40:43]
    ds_read_b128 v[108:111], v4 offset:50176
    buffer_load_dwordx4 a[72:75], v2, s[4:7], s70 offen offset:2048 sc1
    v_mfma_f32_16x16x32_bf16 v[44:47], v[116:119], a[20:23], v[44:47]
    ds_read_b128 v[112:115], v4 offset:51200
    s_add_u32 s59, s23, 143360
    v_mfma_f32_16x16x32_bf16 v[48:51], v[120:123], a[20:23], v[48:51]
    ds_read_b128 v[116:119], v4 offset:52224
    v_mfma_f32_16x16x32_bf16 v[32:35], v[64:67], a[24:27], v[32:35]
    ds_read_b128 v[120:123], v4 offset:53248
    s_waitcnt vmcnt(9)
    s_mul_i32 s57, s24, 256
    s_add_u32 s57, s57, s18
    s_add_u32 s57, s57, 114688
    s_atomic_add s62, s[12:13], s57
    v_mfma_f32_16x16x32_bf16 v[36:39], v[68:71], a[24:27], v[36:39]
    ds_read_b128 v[64:67], v4 offset:54272
    buffer_load_dwordx4 a[76:79], v2, s[4:7], s70 offen offset:3072 sc1
    v_mfma_f32_16x16x32_bf16 v[40:43], v[72:75], a[24:27], v[40:43]
    ds_read_b128 v[68:71], v4 offset:55296
    s_add_u32 s70, s70, 4096
    v_mfma_f32_16x16x32_bf16 v[44:47], v[76:79], a[24:27], v[44:47]
    ds_read_b128 v[72:75], v4 offset:56320
    buffer_load_dwordx4 a[80:83], v2, s[4:7], s70 offen offset:0 sc1
    v_mfma_f32_16x16x32_bf16 v[48:51], v[80:83], a[24:27], v[48:51]
    ds_read_b128 v[76:79], v4 offset:57344
    s_waitcnt lgkmcnt(9)
    v_mfma_f32_16x16x32_bf16 v[32:35], v[84:87], a[28:31], v[32:35]
    ds_read_b128 v[80:83], v4 offset:58368
    v_mfma_f32_16x16x32_bf16 v[36:39], v[88:91], a[28:31], v[36:39]
    ds_read_b128 v[84:87], v4 offset:59392
    buffer_load_dwordx4 a[84:87], v2, s[4:7], s70 offen offset:1024 sc1
    v_mfma_f32_16x16x32_bf16 v[40:43], v[92:95], a[28:31], v[40:43]
    ds_read_b128 v[88:91], v4 offset:60416
    v_mfma_f32_16x16x32_bf16 v[44:47], v[96:99], a[28:31], v[44:47]
    ds_read_b128 v[92:95], v4 offset:61440
    v_mfma_f32_16x16x32_bf16 v[48:51], v[100:103], a[28:31], v[48:51]
    ds_read_b128 v[96:99], v4 offset:62464
    s_waitcnt lgkmcnt(9)
    v_mfma_f32_16x16x32_bf16 v[32:35], v[104:107], a[32:35], v[32:35]
    ds_read_b128 v[100:103], v4 offset:63488
    buffer_load_dwordx4 a[88:91], v2, s[4:7], s70 offen offset:2048 sc1
    v_mfma_f32_16x16x32_bf16 v[36:39], v[108:111], a[32:35], v[36:39]
    ds_read_b128 v[104:107], v4 offset:64512
    v_mfma_f32_16x16x32_bf16 v[40:43], v[112:115], a[32:35], v[40:43]
    ds_read_b128 v[108:111], v5 offset:0
    buffer_load_dwordx4 a[92:95], v2, s[4:7], s70 offen offset:3072 sc1
    v_mfma_f32_16x16x32_bf16 v[44:47], v[116:119], a[32:35], v[44:47]
    ds_read_b128 v[112:115], v5 offset:1024
    s_add_u32 s70, s70, 12288
    v_mfma_f32_16x16x32_bf16 v[48:51], v[120:123], a[32:35], v[48:51]
    ds_read_b128 v[116:119], v5 offset:2048
    s_waitcnt lgkmcnt(9)
    v_mfma_f32_16x16x32_bf16 v[32:35], v[64:67], a[36:39], v[32:35]
    ds_read_b128 v[120:123], v5 offset:3072
    buffer_load_dwordx4 a[96:99], v2, s[4:7], s70 offen offset:0 sc1
    v_mfma_f32_16x16x32_bf16 v[36:39], v[68:71], a[36:39], v[36:39]
    s_barrier
    ds_read_b128 v[64:67], v5 offset:4096
    v_mfma_f32_16x16x32_bf16 v[40:43], v[72:75], a[36:39], v[40:43]
    ds_read_b128 v[68:71], v5 offset:5120
    v_mfma_f32_16x16x32_bf16 v[44:47], v[76:79], a[36:39], v[44:47]
    ds_read_b128 v[72:75], v5 offset:6144
    buffer_load_dwordx4 a[100:103], v2, s[4:7], s70 offen offset:1024 sc1
    v_mfma_f32_16x16x32_bf16 v[48:51], v[80:83], a[36:39], v[48:51]
    ds_read_b128 v[76:79], v5 offset:7168
    s_waitcnt lgkmcnt(9)
    v_mfma_f32_16x16x32_bf16 v[32:35], v[84:87], a[40:43], v[32:35]
    ds_read_b128 v[80:83], v5 offset:8192
    buffer_load_dwordx4 v196, s[4:7], s59 offen offset:0 sc1 lds
    v_mfma_f32_16x16x32_bf16 v[36:39], v[88:91], a[40:43], v[36:39]
    ds_read_b128 v[84:87], v5 offset:9216
    v_mfma_f32_16x16x32_bf16 v[40:43], v[92:95], a[40:43], v[40:43]
    ds_read_b128 v[88:91], v5 offset:10240
    v_mfma_f32_16x16x32_bf16 v[44:47], v[96:99], a[40:43], v[44:47]
    ds_read_b128 v[92:95], v5 offset:11264
Lw_10:
    s_cbranch_execz Lw_11
    s_mul_i32 s56, s26, 256
    s_add_u32 s56, s56, s18
    s_add_u32 s56, s56, 98304
    s_mov_b32 s63, 0
    s_atomic_add s63, s[12:13], s56 glc
    v_mfma_f32_16x16x32_bf16 v[48:51], v[100:103], a[40:43], v[48:51]
    ds_read_b128 v[96:99], v5 offset:12288
    s_waitcnt lgkmcnt(9)
    v_mfma_f32_16x16x32_bf16 v[32:35], v[104:107], a[44:47], v[32:35]
    ds_read_b128 v[100:103], v5 offset:13312
    buffer_load_dwordx4 v196, s[4:7], s59 offen offset:1024 sc1 lds
    v_mfma_f32_16x16x32_bf16 v[36:39], v[108:111], a[44:47], v[36:39]
    ds_read_b128 v[104:107], v5 offset:14336
    s_add_u32 m0, s84, 65536
    v_mfma_f32_16x16x32_bf16 v[40:43], v[112:115], a[44:47], v[40:43]
    ds_read_b128 v[108:111], v5 offset:15360
    s_add_u32 s59, s23, 151552
    v_mfma_f32_16x16x32_bf16 v[44:47], v[116:119], a[44:47], v[44:47]
    ds_read_b128 v[112:115], v5 offset:16384
    buffer_load_dwordx4 v196, s[4:7], s59 offen offset:0 sc1 lds
    v_mfma_f32_16x16x32_bf16 v[48:51], v[120:123], a[44:47], v[48:51]
    ds_read_b128 v[116:119], v5 offset:17408
    s_waitcnt lgkmcnt(9)
    v_mfma_f32_16x16x32_bf16 v[32:35], v[64:67], a[48:51], v[32:35]
    ds_read_b128 v[120:123], v5 offset:18432
    buffer_load_dwordx4 v196, s[4:7], s59 offen offset:1024 sc1 lds
    v_mfma_f32_16x16x32_bf16 v[36:39], v[68:71], a[48:51], v[36:39]
    ds_read_b128 v[64:67], v5 offset:19456
    s_add_u32 m0, s84, 73728
    v_mfma_f32_16x16x32_bf16 v[40:43], v[72:75], a[48:51], v[40:43]
    ds_read_b128 v[68:71], v5 offset:20480
    s_add_u32 s59, s23, 159744
    v_mfma_f32_16x16x32_bf16 v[44:47], v[76:79], a[48:51], v[44:47]
    ds_read_b128 v[72:75], v5 offset:21504
    buffer_load_dwordx4 v196, s[4:7], s59 offen offset:0 sc1 lds
    v_mfma_f32_16x16x32_bf16 v[48:51], v[80:83], a[48:51], v[48:51]
    ds_read_b128 v[76:79], v5 offset:22528
    s_waitcnt lgkmcnt(9)
    v_mfma_f32_16x16x32_bf16 v[32:35], v[84:87], a[52:55], v[32:35]
    ds_read_b128 v[80:83], v5 offset:23552
    v_mfma_f32_16x16x32_bf16 v[36:39], v[88:91], a[52:55], v[36:39]
    s_barrier
    ds_read_b128 v[84:87], v5 offset:24576
    v_mfma_f32_16x16x32_bf16 v[40:43], v[92:95], a[52:55], v[40:43]
    ds_read_b128 v[88:91], v5 offset:25600
    buffer_load_dwordx4 v196, s[4:7], s59 offen offset:1024 sc1 lds
    v_mfma_f32_16x16x32_bf16 v[44:47], v[96:99], a[52:55], v[44:47]
    ds_read_b128 v[92:95], v5 offset:26624
    s_add_u32 m0, s84, 81920
    v_mfma_f32_16x16x32_bf16 v[48:51], v[100:103], a[52:55], v[48:51]
    ds_read_b128 v[96:99], v5 offset:27648
    s_waitcnt lgkmcnt(9)
    v_mfma_f32_16x16x32_bf16 v[32:35], v[104:107], a[56:59], v[32:35]
    ds_read_b128 v[100:103], v2 offset:0
    buffer_load_dwordx4 a[104:107], v2, s[4:7], s70 offen offset:2048 sc1
    v_mfma_f32_16x16x32_bf16 v[36:39], v[108:111], a[56:59], v[36:39]
    ds_read_b128 v[104:107], v2 offset:1024
    s_add_u32 s59, s23, 167936
    v_mfma_f32_16x16x32_bf16 v[40:43], v[112:115], a[56:59], v[40:43]
    ds_read_b128 v[108:111], v2 offset:2048
    buffer_load_dwordx4 a[108:111], v2, s[4:7], s70 offen offset:3072 sc1
    v_mfma_f32_16x16x32_bf16 v[44:47], v[116:119], a[56:59], v[44:47]
    ds_read_b128 v[112:115], v2 offset:3072
    s_add_u32 s70, s70, 4096
    v_mfma_f32_16x16x32_bf16 v[48:51], v[120:123], a[56:59], v[48:51]
    ds_read_b128 v[116:119], v2 offset:4096
    s_waitcnt lgkmcnt(9)
    v_mfma_f32_16x16x32_bf16 v[32:35], v[64:67], a[60:63], v[32:35]
    ds_read_b128 v[120:123], v2 offset:5120
    buffer_load_dwordx4 a[112:115], v2, s[4:7], s70 offen offset:0 sc1
    v_mfma_f32_16x16x32_bf16 v[36:39], v[68:71], a[60:63], v[36:39]
    ds_read_b128 v[64:67], v2 offset:6144
    v_mfma_f32_16x16x32_bf16 v[40:43], v[72:75], a[60:63], v[40:43]
    ds_read_b128 v[68:71], v2 offset:7168
    v_mfma_f32_16x16x32_bf16 v[44:47], v[76:79], a[60:63], v[44:47]
    ds_read_b128 v[72:75], v2 offset:8192
    buffer_load_dwordx4 a[116:119], v2, s[4:7], s70 offen offset:1024 sc1
    v_mfma_f32_16x16x32_bf16 v[48:51], v[80:83], a[60:63], v[48:51]
    ds_read_b128 v[76:79], v2 offset:9216
    s_waitcnt vmcnt(19) lgkmcnt(9)
    v_mfma_f32_16x16x32_bf16 v[32:35], v[84:87], a[64:67], v[32:35]
    ds_read_b128 v[80:83], v2 offset:10240
    buffer_load_dwordx4 v196, s[4:7], s59 offen offset:0 sc1 lds
    v_mfma_f32_16x16x32_bf16 v[36:39], v[88:91], a[64:67], v[36:39]
    ds_read_b128 v[84:87], v2 offset:11264
    v_mfma_f32_16x16x32_bf16 v[40:43], v[92:95], a[64:67], v[40:43]
    ds_read_b128 v[88:91], v2 offset:12288
    v_mfma_f32_16x16x32_bf16 v[44:47], v[96:99], a[64:67], v[44:47]
    ds_read_b128 v[92:95], v2 offset:13312
    buffer_load_dwordx4 v196, s[4:7], s59 offen offset:1024 sc1 lds
    v_mfma_f32_16x16x32_bf16 v[48:51], v[100:103], a[64:67], v[48:51]
    ds_read_b128 v[96:99], v2 offset:14336
    s_waitcnt vmcnt(20) lgkmcnt(9)
    v_mfma_f32_16x16x32_bf16 v[32:35], v[104:107], a[68:71], v[32:35]
    ds_read_b128 v[100:103], v2 offset:15360
    s_add_u32 m0, s84, 90112
    v_mfma_f32_16x16x32_bf16 v[36:39], v[108:111], a[68:71], v[36:39]
    s_barrier
    ds_read_b128 v[104:107], v2 offset:16384
    v_mfma_f32_16x16x32_bf16 v[40:43], v[112:115], a[68:71], v[40:43]
    ds_read_b128 v[108:111], v2 offset:17408
    s_add_u32 s59, s23, 176128
    v_mfma_f32_16x16x32_bf16 v[44:47], v[116:119], a[68:71], v[44:47]
    ds_read_b128 v[112:115], v2 offset:18432
    buffer_load_dwordx4 v196, s[4:7], s59 offen offset:0 sc1 lds
    v_mfma_f32_16x16x32_bf16 v[48:51], v[120:123], a[68:71], v[48:51]
    ds_read_b128 v[116:119], v2 offset:19456
    s_waitcnt vmcnt(20) lgkmcnt(9)
    v_mfma_f32_16x16x32_bf16 v[32:35], v[64:67], a[72:75], v[32:35]
    ds_read_b128 v[120:123], v2 offset:20480
    buffer_load_dwordx4 v196, s[4:7], s59 offen offset:1024 sc1 lds
    v_mfma_f32_16x16x32_bf16 v[36:39], v[68:71], a[72:75], v[36:39]
    ds_read_b128 v[64:67], v2 offset:21504
    s_add_u32 m0, s84, 98304
    v_mfma_f32_16x16x32_bf16 v[40:43], v[72:75], a[72:75], v[40:43]
    ds_read_b128 v[68:71], v2 offset:22528
    s_add_u32 s59, s23, 184320
    v_mfma_f32_16x16x32_bf16 v[44:47], v[76:79], a[72:75], v[44:47]
    ds_read_b128 v[72:75], v2 offset:23552
    buffer_load_dwordx4 a[120:123], v2, s[4:7], s70 offen offset:2048 sc1
    v_mfma_f32_16x16x32_bf16 v[48:51], v[80:83], a[72:75], v[48:51]
    ds_read_b128 v[76:79], v2 offset:24576
    s_waitcnt vmcnt(21) lgkmcnt(9)
    v_mfma_f32_16x16x32_bf16 v[32:35], v[84:87], a[76:79], v[32:35]
    ds_read_b128 v[80:83], v2 offset:25600
    v_mfma_f32_16x16x32_bf16 v[36:39], v[88:91], a[76:79], v[36:39]
    ds_read_b128 v[84:87], v2 offset:26624
    buffer_load_dwordx4 a[124:127], v2, s[4:7], s70 offen offset:3072 sc1
    v_mfma_f32_16x16x32_bf16 v[40:43], v[92:95], a[76:79], v[40:43]
    ds_read_b128 v[88:91], v2 offset:27648
Lpoll_211:
    s_mov_b32 s55, 0
Lpoll_211_l:
    s_waitcnt lgkmcnt(0)
    s_bfe_u32 s63, s63, 524288
    s_cmp_ge_u32 s63, 16
    s_cbranch_scc1 Lok_212
    s_mov_b32 s63, 0
    s_atomic_add s63, s[12:13], s56 glc
    s_add_u32 s55, s55, 1
    s_cmp_lt_u32 s55, 400000
    s_cbranch_scc1 Lpoll_211_l
    s_waitcnt lgkmcnt(0)
Lok_212:
    v_mfma_f32_16x16x32_bf16 v[44:47], v[96:99], a[76:79], v[44:47]
    ds_read_b128 v[92:95], v2 offset:28672
    s_add_u32 s70, s70, 12288
    v_mfma_f32_16x16x32_bf16 v[48:51], v[100:103], a[76:79], v[48:51]
    ds_read_b128 v[96:99], v2 offset:29696
    s_waitcnt vmcnt(21)
    v_mfma_f32_16x16x32_bf16 v[32:35], v[104:107], a[80:83], v[32:35]
    ds_read_b128 v[100:103], v2 offset:30720
    buffer_load_dwordx4 a[128:131], v2, s[4:7], s70 offen offset:0 sc1
    v_mfma_f32_16x16x32_bf16 v[36:39], v[108:111], a[80:83], v[36:39]
    ds_read_b128 v[104:107], v2 offset:31744
    v_mfma_f32_16x16x32_bf16 v[40:43], v[112:115], a[80:83], v[40:43]
    ds_read_b128 v[108:111], v2 offset:32768
    buffer_load_dwordx4 a[132:135], v2, s[4:7], s70 offen offset:1024 sc1
    v_mfma_f32_16x16x32_bf16 v[44:47], v[116:119], a[80:83], v[44:47]
    ds_read_b128 v[112:115], v2 offset:33792
    v_mfma_f32_16x16x32_bf16 v[48:51], v[120:123], a[80:83], v[48:51]
    ds_read_b128 v[116:119], v2 offset:34816
    s_waitcnt vmcnt(22)
    v_mfma_f32_16x16x32_bf16 v[32:35], v[64:67], a[84:87], v[32:35]
    ds_read_b128 v[120:123], v2 offset:35840
    buffer_load_dwordx4 v196, s[4:7], s59 offen offset:0 sc1 lds
    v_mfma_f32_16x16x32_bf16 v[36:39], v[68:71], a[84:87], v[36:39]
    s_barrier
    ds_read_b128 v[64:67], v2 offset:36864
    v_mfma_f32_16x16x32_bf16 v[40:43], v[72:75], a[84:87], v[40:43]
    ds_read_b128 v[68:71], v2 offset:37888
    v_mfma_f32_16x16x32_bf16 v[44:47], v[76:79], a[84:87], v[44:47]
    ds_read_b128 v[72:75], v2 offset:38912
    buffer_load_dwordx4 v196, s[4:7], s59 offen offset:1024 sc1 lds
    v_mfma_f32_16x16x32_bf16 v[48:51], v[80:83], a[84:87], v[48:51]
    ds_read_b128 v[76:79], v2 offset:39936
    s_waitcnt vmcnt(23) lgkmcnt(9)
    v_mfma_f32_16x16x32_bf16 v[32:35], v[84:87], a[88:91], v[32:35]
    ds_read_b128 v[80:83], v2 offset:40960
    s_add_u32 m0, s84, 106496
    v_mfma_f32_16x16x32_bf16 v[36:39], v[88:91], a[88:91], v[36:39]
    ds_read_b128 v[84:87], v2 offset:41984
    s_add_u32 s59, s23, 192512
    v_mfma_f32_16x16x32_bf16 v[40:43], v[92:95], a[88:91], v[40:43]
    ds_read_b128 v[88:91], v2 offset:43008
    buffer_load_dwordx4 v196, s[4:7], s59 offen offset:0 sc1 lds
    v_mfma_f32_16x16x32_bf16 v[44:47], v[96:99], a[88:91], v[44:47]
    ds_read_b128 v[92:95], v2 offset:44032
    v_mfma_f32_16x16x32_bf16 v[48:51], v[100:103], a[88:91], v[48:51]
    ds_read_b128 v[96:99], v2 offset:45056
    s_waitcnt vmcnt(23) lgkmcnt(9)
    v_mfma_f32_16x16x32_bf16 v[32:35], v[104:107], a[92:95], v[32:35]
    ds_read_b128 v[100:103], v2 offset:46080
    s_mul_i32 s56, s26, 256
    s_add_u32 s56, s56, s18
    s_add_u32 s56, s56, 114688
    s_mov_b32 s63, 0
    s_atomic_add s63, s[12:13], s56 glc
    v_mfma_f32_16x16x32_bf16 v[36:39], v[108:111], a[92:95], v[36:39]
    ds_read_b128 v[104:107], v2 offset:47104
    buffer_load_dwordx4 v196, s[4:7], s59 offen offset:1024 sc1 lds
    v_mfma_f32_16x16x32_bf16 v[40:43], v[112:115], a[92:95], v[40:43]
    ds_read_b128 v[108:111], v2 offset:48128
    s_add_u32 m0, s84, 114688
    v_mfma_f32_16x16x32_bf16 v[44:47], v[116:119], a[92:95], v[44:47]
    ds_read_b128 v[112:115], v2 offset:49152
    s_add_u32 s59, s23, 200704
    v_mfma_f32_16x16x32_bf16 v[48:51], v[120:123], a[92:95], v[48:51]
    ds_read_b128 v[116:119], v2 offset:50176
    s_waitcnt vmcnt(23) lgkmcnt(9)
    v_mfma_f32_16x16x32_bf16 v[32:35], v[64:67], a[96:99], v[32:35]
    ds_read_b128 v[120:123], v2 offset:51200
    buffer_load_dwordx4 v196, s[4:7], s59 offen offset:0 sc1 lds
    v_mfma_f32_16x16x32_bf16 v[36:39], v[68:71], a[96:99], v[36:39]
    ds_read_b128 v[64:67], v2 offset:52224
    v_mfma_f32_16x16x32_bf16 v[40:43], v[72:75], a[96:99], v[40:43]
    ds_read_b128 v[68:71], v2 offset:53248
    buffer_load_dwordx4 v196, s[4:7], s59 offen offset:1024 sc1 lds
    v_mfma_f32_16x16x32_bf16 v[44:47], v[76:79], a[96:99], v[44:47]
    ds_read_b128 v[72:75], v2 offset:54272
    s_add_u32 m0, s84, 122880
    v_mfma_f32_16x16x32_bf16 v[48:51], v[80:83], a[96:99], v[48:51]
    ds_read_b128 v[76:79], v2 offset:55296
    s_waitcnt vmcnt(24) lgkmcnt(9)
    v_mfma_f32_16x16x32_bf16 v[32:35], v[84:87], a[100:103], v[32:35]
    ds_read_b128 v[80:83], v2 offset:56320
    buffer_load_dwordx4 a[136:139], v2, s[4:7], s70 offen offset:2048 sc1
    v_mfma_f32_16x16x32_bf16 v[36:39], v[88:91], a[100:103], v[36:39]
    s_waitcnt vmcnt(19)
    s_barrier
    ds_read_b128 v[84:87], v2 offset:57344
    v_mfma_f32_16x16x32_bf16 v[40:43], v[92:95], a[100:103], v[40:43]
    ds_read_b128 v[88:91], v2 offset:58368
    s_add_u32 s59, s23, 208896
    v_mfma_f32_16x16x32_bf16 v[44:47], v[96:99], a[100:103], v[44:47]
    ds_read_b128 v[92:95], v2 offset:59392
    buffer_load_dwordx4 a[140:143], v2, s[4:7], s70 offen offset:3072 sc1
    v_mfma_f32_16x16x32_bf16 v[48:51], v[100:103], a[100:103], v[48:51]
    ds_read_b128 v[96:99], v2 offset:60416
    s_waitcnt vmcnt(19) lgkmcnt(9)
    v_mfma_f32_16x16x32_bf16 v[32:35], v[104:107], a[104:107], v[32:35]
    ds_read_b128 v[100:103], v2 offset:61440
    s_add_u32 s70, s70, 4096
    v_mfma_f32_16x16x32_bf16 v[36:39], v[108:111], a[104:107], v[36:39]
    ds_read_b128 v[104:107], v2 offset:62464
    buffer_load_dwordx4 a[144:147], v2, s[4:7], s70 offen offset:0 sc1
    v_mfma_f32_16x16x32_bf16 v[40:43], v[112:115], a[104:107], v[40:43]
    ds_read_b128 v[108:111], v2 offset:63488
    v_mfma_f32_16x16x32_bf16 v[44:47], v[116:119], a[104:107], v[44:47]
    ds_read_b128 v[112:115], v2 offset:64512
    buffer_load_dwordx4 a[148:151], v2, s[4:7], s70 offen offset:1024 sc1
    v_mfma_f32_16x16x32_bf16 v[48:51], v[120:123], a[104:107], v[48:51]
    ds_read_b128 v[116:119], v4 offset:0
    s_waitcnt vmcnt(20) lgkmcnt(9)
    v_mfma_f32_16x16x32_bf16 v[32:35], v[64:67], a[108:111], v[32:35]
    ds_read_b128 v[120:123], v4 offset:1024
    v_mfma_f32_16x16x32_bf16 v[36:39], v[68:71], a[108:111], v[36:39]
    ds_read_b128 v[64:67], v4 offset:2048
    buffer_load_dwordx4 v196, s[4:7], s59 offen offset:0 sc1 lds
    v_mfma_f32_16x16x32_bf16 v[40:43], v[72:75], a[108:111], v[40:43]
    ds_read_b128 v[68:71], v4 offset:3072
    v_mfma_f32_16x16x32_bf16 v[44:47], v[76:79], a[108:111], v[44:47]
    ds_read_b128 v[72:75], v4 offset:4096
    v_mfma_f32_16x16x32_bf16 v[48:51], v[80:83], a[108:111], v[48:51]
    ds_read_b128 v[76:79], v4 offset:5120
    s_waitcnt vmcnt(20) lgkmcnt(9)
    v_mfma_f32_16x16x32_bf16 v[32:35], v[84:87], a[112:115], v[32:35]
    ds_read_b128 v[80:83], v4 offset:6144
    buffer_load_dwordx4 v196, s[4:7], s59 offen offset:1024 sc1 lds
    v_mfma_f32_16x16x32_bf16 v[36:39], v[88:91], a[112:115], v[36:39]
    ds_read_b128 v[84:87], v4 offset:7168
    s_add_u32 m0, s84, 131072
    v_mfma_f32_16x16x32_bf16 v[40:43], v[92:95], a[112:115], v[40:43]
    ds_read_b128 v[88:91], v4 offset:8192
    s_add_u32 s59, s23, 217088
    v_mfma_f32_16x16x32_bf16 v[44:47], v[96:99], a[112:115], v[44:47]
    ds_read_b128 v[92:95], v4 offset:9216
    buffer_load_dwordx4 v196, s[4:7], s59 offen offset:0 sc1 lds
    v_mfma_f32_16x16x32_bf16 v[48:51], v[100:103], a[112:115], v[48:51]
    ds_read_b128 v[96:99], v4 offset:10240
    s_waitcnt vmcnt(21) lgkmcnt(9)
    v_mfma_f32_16x16x32_bf16 v[32:35], v[104:107], a[116:119], v[32:35]
    ds_read_b128 v[100:103], v4 offset:11264
    buffer_load_dwordx4 v196, s[4:7], s59 offen offset:1024 sc1 lds
    v_mfma_f32_16x16x32_bf16 v[36:39], v[108:111], a[116:119], v[36:39]
    s_waitcnt vmcnt(18)
    s_barrier
    ds_read_b128 v[104:107], v4 offset:12288
    v_mfma_f32_16x16x32_bf16 v[40:43], v[112:115], a[116:119], v[40:43]
    ds_read_b128 v[108:111], v4 offset:13312
    s_add_u32 m0, s84, 139264
    v_mfma_f32_16x16x32_bf16 v[44:47], v[116:119], a[116:119], v[44:47]
    ds_read_b128 v[112:115], v4 offset:14336
    buffer_load_dwordx4 a[152:155], v2, s[4:7], s70 offen offset:2048 sc1
    v_mfma_f32_16x16x32_bf16 v[48:51], v[120:123], a[116:119], v[48:51]
    ds_read_b128 v[116:119], v4 offset:15360
    s_waitcnt vmcnt(18) lgkmcnt(9)
    v_mfma_f32_16x16x32_bf16 v[32:35], v[64:67], a[120:123], v[32:35]
    ds_read_b128 v[120:123], v4 offset:16384
    s_add_u32 s59, s23, 225280
    v_mfma_f32_16x16x32_bf16 v[36:39], v[68:71], a[120:123], v[36:39]
    ds_read_b128 v[64:67], v4 offset:17408
    buffer_load_dwordx4 a[156:159], v2, s[4:7], s70 offen offset:3072 sc1
    v_mfma_f32_16x16x32_bf16 v[40:43], v[72:75], a[120:123], v[40:43]
    ds_read_b128 v[68:71], v4 offset:18432
Lpoll_213:
    s_mov_b32 s55, 0
Lpoll_213_l:
    s_waitcnt lgkmcnt(0)
    s_bfe_u32 s63, s63, 524288
    s_cmp_ge_u32 s63, 16
    s_cbranch_scc1 Lok_214
    s_mov_b32 s63, 0
    s_atomic_add s63, s[12:13], s56 glc
    s_add_u32 s55, s55, 1
    s_cmp_lt_u32 s55, 400000
    s_cbranch_scc1 Lpoll_213_l
    s_waitcnt lgkmcnt(0)
Lok_214:
    v_mfma_f32_16x16x32_bf16 v[44:47], v[76:79], a[120:123], v[44:47]
    ds_read_b128 v[72:75], v4 offset:19456
    s_add_u32 s70, s70, 12288
    v_mfma_f32_16x16x32_bf16 v[48:51], v[80:83], a[120:123], v[48:51]
    ds_read_b128 v[76:79], v4 offset:20480
    s_waitcnt vmcnt(18)
    v_mfma_f32_16x16x32_bf16 v[32:35], v[84:87], a[124:127], v[32:35]
    ds_read_b128 v[80:83], v4 offset:21504
    buffer_load_dwordx4 a[0:3], v2, s[4:7], s70 offen offset:0 sc1
    v_mfma_f32_16x16x32_bf16 v[36:39], v[88:91], a[124:127], v[36:39]
    ds_read_b128 v[84:87], v4 offset:22528
    v_mfma_f32_16x16x32_bf16 v[40:43], v[92:95], a[124:127], v[40:43]
    ds_read_b128 v[88:91], v4 offset:23552
    buffer_load_dwordx4 a[4:7], v2, s[4:7], s70 offen offset:1024 sc1
    v_mfma_f32_16x16x32_bf16 v[44:47], v[96:99], a[124:127], v[44:47]
    ds_read_b128 v[92:95], v4 offset:24576
    v_mfma_f32_16x16x32_bf16 v[48:51], v[100:103], a[124:127], v[48:51]
    ds_read_b128 v[96:99], v4 offset:25600
    s_waitcnt vmcnt(19)
    v_mfma_f32_16x16x32_bf16 v[32:35], v[104:107], a[128:131], v[32:35]
    ds_read_b128 v[100:103], v4 offset:26624
    buffer_load_dwordx4 v196, s[4:7], s59 offen offset:0 sc1 lds
    v_mfma_f32_16x16x32_bf16 v[36:39], v[108:111], a[128:131], v[36:39]
    ds_read_b128 v[104:107], v4 offset:27648
    v_mfma_f32_16x16x32_bf16 v[40:43], v[112:115], a[128:131], v[40:43]
    ds_read_b128 v[108:111], v4 offset:28672
    v_mfma_f32_16x16x32_bf16 v[44:47], v[116:119], a[128:131], v[44:47]
    ds_read_b128 v[112:115], v4 offset:29696
    buffer_load_dwordx4 v196, s[4:7], s59 offen offset:1024 sc1 lds
    v_mfma_f32_16x16x32_bf16 v[48:51], v[120:123], a[128:131], v[48:51]
    ds_read_b128 v[116:119], v4 offset:30720
    s_waitcnt vmcnt(20) lgkmcnt(9)
    v_mfma_f32_16x16x32_bf16 v[32:35], v[64:67], a[132:135], v[32:35]
    ds_read_b128 v[120:123], v4 offset:31744
    s_add_u32 m0, s84, 147456
    v_mfma_f32_16x16x32_bf16 v[36:39], v[68:71], a[132:135], v[36:39]
    s_waitcnt vmcnt(14)
    s_barrier
    ds_read_b128 v[64:67], v4 offset:32768
    v_mfma_f32_16x16x32_bf16 v[40:43], v[72:75], a[132:135], v[40:43]
    ds_read_b128 v[68:71], v4 offset:33792
    s_add_u32 s59, s23, 233472
    v_mfma_f32_16x16x32_bf16 v[44:47], v[76:79], a[132:135], v[44:47]
    ds_read_b128 v[72:75], v4 offset:34816
    buffer_load_dwordx4 v196, s[4:7], s59 offen offset:0 sc1 lds
    v_mfma_f32_16x16x32_bf16 v[48:51], v[80:83], a[132:135], v[48:51]
    ds_read_b128 v[76:79], v4 offset:35840
    buffer_load_dwordx4 v196, s[4:7], s59 offen offset:1024 sc1 lds
    s_waitcnt vmcnt(15) lgkmcnt(9)
    v_mfma_f32_16x16x32_bf16 v[32:35], v[84:87], a[136:139], v[32:35]
    ds_read_b128 v[80:83], v4 offset:36864
    s_add_u32 m0, s19, 155648
    v_mfma_f32_16x16x32_bf16 v[36:39], v[88:91], a[136:139], v[36:39]
    ds_read_b128 v[84:87], v4 offset:37888
    s_add_u32 s59, s23, 241664
    v_mfma_f32_16x16x32_bf16 v[40:43], v[92:95], a[136:139], v[40:43]
    ds_read_b128 v[88:91], v4 offset:38912
    buffer_load_dwordx4 v3, s[4:7], s59 offen offset:0 sc1 lds
    v_mfma_f32_16x16x32_bf16 v[44:47], v[96:99], a[136:139], v[44:47]
    ds_read_b128 v[92:95], v4 offset:39936
    buffer_load_dwordx4 a[8:11], v2, s[4:7], s70 offen offset:2048 sc1
    v_mfma_f32_16x16x32_bf16 v[48:51], v[100:103], a[136:139], v[48:51]
    ds_read_b128 v[96:99], v4 offset:40960
    s_waitcnt vmcnt(16) lgkmcnt(9)
    v_mfma_f32_16x16x32_bf16 v[32:35], v[104:107], a[140:143], v[32:35]
    ds_read_b128 v[100:103], v4 offset:41984
    buffer_load_dwordx4 a[12:15], v2, s[4:7], s70 offen offset:3072 sc1
    v_mfma_f32_16x16x32_bf16 v[36:39], v[108:111], a[140:143], v[36:39]
    ds_read_b128 v[104:107], v4 offset:43008
    s_add_u32 s70, s70, 4096
    v_mfma_f32_16x16x32_bf16 v[40:43], v[112:115], a[140:143], v[40:43]
    ds_read_b128 v[108:111], v4 offset:44032
    s_add_u32 m0, s84, 0
    v_mfma_f32_16x16x32_bf16 v[44:47], v[116:119], a[140:143], v[44:47]
    ds_read_b128 v[112:115], v4 offset:45056
    s_add_u32 s59, s20, 0
    v_mfma_f32_16x16x32_bf16 v[48:51], v[120:123], a[140:143], v[48:51]
    ds_read_b128 v[116:119], v4 offset:46080
    s_waitcnt vmcnt(16) lgkmcnt(9)
    v_mfma_f32_16x16x32_bf16 v[32:35], v[64:67], a[144:147], v[32:35]
    ds_read_b128 v[120:123], v4 offset:47104
    buffer_load_dwordx4 a[16:19], v2, s[4:7], s70 offen offset:0 sc1
    v_mfma_f32_16x16x32_bf16 v[36:39], v[68:71], a[144:147], v[36:39]
    ds_read_b128 v[64:67], v4 offset:48128
    v_mfma_f32_16x16x32_bf16 v[40:43], v[72:75], a[144:147], v[40:43]
    ds_read_b128 v[68:71], v4 offset:49152
    v_mfma_f32_16x16x32_bf16 v[44:47], v[76:79], a[144:147], v[44:47]
    ds_read_b128 v[72:75], v4 offset:50176
    v_mfma_f32_16x16x32_bf16 v[48:51], v[80:83], a[144:147], v[48:51]
    ds_read_b128 v[76:79], v4 offset:51200
    s_waitcnt vmcnt(16) lgkmcnt(9)
    v_mfma_f32_16x16x32_bf16 v[32:35], v[84:87], a[148:151], v[32:35]
    ds_read_b128 v[80:83], v4 offset:52224
    buffer_load_dwordx4 a[20:23], v2, s[4:7], s70 offen offset:1024 sc1
    v_mfma_f32_16x16x32_bf16 v[36:39], v[88:91], a[148:151], v[36:39]
    s_waitcnt vmcnt(13)
    s_barrier
    ds_read_b128 v[84:87], v4 offset:53248
    v_mfma_f32_16x16x32_bf16 v[40:43], v[92:95], a[148:151], v[40:43]
    ds_read_b128 v[88:91], v4 offset:54272
    buffer_load_dwordx4 a[24:27], v2, s[4:7], s70 offen offset:2048 sc1
    v_mfma_f32_16x16x32_bf16 v[44:47], v[96:99], a[148:151], v[44:47]
    ds_read_b128 v[92:95], v4 offset:55296
    v_mfma_f32_16x16x32_bf16 v[48:51], v[100:103], a[148:151], v[48:51]
    ds_read_b128 v[96:99], v4 offset:56320
    s_waitcnt vmcnt(13) lgkmcnt(9)
    v_mfma_f32_16x16x32_bf16 v[32:35], v[104:107], a[152:155], v[32:35]
    ds_read_b128 v[100:103], v4 offset:57344
    buffer_load_dwordx4 a[28:31], v2, s[4:7], s70 offen offset:3072 sc1
    v_mfma_f32_16x16x32_bf16 v[36:39], v[108:111], a[152:155], v[36:39]
    ds_read_b128 v[104:107], v4 offset:58368
    v_mfma_f32_16x16x32_bf16 v[40:43], v[112:115], a[152:155], v[40:43]
    ds_read_b128 v[108:111], v4 offset:59392
    v_mfma_f32_16x16x32_bf16 v[44:47], v[116:119], a[152:155], v[44:47]
    ds_read_b128 v[112:115], v4 offset:60416
    buffer_load_dwordx4 v196, s[64:67], s59 offen offset:0 sc1 lds
    v_mfma_f32_16x16x32_bf16 v[48:51], v[120:123], a[152:155], v[48:51]
    ds_read_b128 v[116:119], v4 offset:61440
    s_waitcnt vmcnt(14) lgkmcnt(9)
    v_mfma_f32_16x16x32_bf16 v[32:35], v[64:67], a[156:159], v[32:35]
    ds_read_b128 v[120:123], v4 offset:62464
    buffer_load_dwordx4 v196, s[64:67], s59 offen offset:1024 sc1 lds
    v_mfma_f32_16x16x32_bf16 v[36:39], v[68:71], a[156:159], v[36:39]
    ds_read_b128 v[64:67], v4 offset:63488
    s_add_u32 m0, s84, 8192
    v_mfma_f32_16x16x32_bf16 v[40:43], v[72:75], a[156:159], v[40:43]
    ds_read_b128 v[68:71], v4 offset:64512
    s_add_u32 s59, s20, 8192
    v_mfma_f32_16x16x32_bf16 v[44:47], v[76:79], a[156:159], v[44:47]
    ds_read_b128 v[72:75], v5 offset:0
    buffer_load_dwordx4 v196, s[64:67], s59 offen offset:0 sc1 lds
    v_mfma_f32_16x16x32_bf16 v[48:51], v[80:83], a[156:159], v[48:51]
    ds_read_b128 v[76:79], v5 offset:1024
    s_waitcnt vmcnt(15) lgkmcnt(9)
    v_mfma_f32_16x16x32_bf16 v[32:35], v[84:87], a[0:3], v[32:35]
    ds_read_b128 v[80:83], v5 offset:2048
    v_mfma_f32_16x16x32_bf16 v[36:39], v[88:91], a[0:3], v[36:39]
    ds_read_b128 v[84:87], v5 offset:3072
    buffer_load_dwordx4 v196, s[64:67], s59 offen offset:1024 sc1 lds
    v_mfma_f32_16x16x32_bf16 v[40:43], v[92:95], a[0:3], v[40:43]
    ds_read_b128 v[88:91], v5 offset:4096
    s_add_u32 m0, s84, 16384
    v_mfma_f32_16x16x32_bf16 v[44:47], v[96:99], a[0:3], v[44:47]
    ds_read_b128 v[92:95], v5 offset:5120
    s_add_u32 s59, s20, 16384
    v_mfma_f32_16x16x32_bf16 v[48:51], v[100:103], a[0:3], v[48:51]
    ds_read_b128 v[96:99], v5 offset:6144
    s_waitcnt vmcnt(15) lgkmcnt(9)
    v_mfma_f32_16x16x32_bf16 v[32:35], v[104:107], a[4:7], v[32:35]
    ds_read_b128 v[100:103], v5 offset:7168
    buffer_load_dwordx4 v196, s[64:67], s59 offen offset:0 sc1 lds
    v_mfma_f32_16x16x32_bf16 v[36:39], v[108:111], a[4:7], v[36:39]
    s_waitcnt vmcnt(11)
    s_barrier
    ds_read_b128 v[104:107], v5 offset:8192
    v_mfma_f32_16x16x32_bf16 v[40:43], v[112:115], a[4:7], v[40:43]
    ds_read_b128 v[108:111], v5 offset:9216
    buffer_load_dwordx4 v196, s[64:67], s59 offen offset:1024 sc1 lds
    v_mfma_f32_16x16x32_bf16 v[44:47], v[116:119], a[4:7], v[44:47]
    ds_read_b128 v[112:115], v5 offset:10240
    s_add_u32 m0, s84, 24576
    v_mfma_f32_16x16x32_bf16 v[48:51], v[120:123], a[4:7], v[48:51]
    ds_read_b128 v[116:119], v5 offset:11264
    s_waitcnt vmcnt(11) lgkmcnt(9)
    v_mfma_f32_16x16x32_bf16 v[32:35], v[64:67], a[8:11], v[32:35]
    ds_read_b128 v[120:123], v5 offset:12288
    s_add_u32 s59, s20, 24576
    v_mfma_f32_16x16x32_bf16 v[36:39], v[68:71], a[8:11], v[36:39]
    ds_read_b128 v[64:67], v5 offset:13312
    buffer_load_dwordx4 v196, s[64:67], s59 offen offset:0 sc1 lds
    v_mfma_f32_16x16x32_bf16 v[40:43], v[72:75], a[8:11], v[40:43]
    ds_read_b128 v[68:71], v5 offset:14336
    v_mfma_f32_16x16x32_bf16 v[44:47], v[76:79], a[8:11], v[44:47]
    ds_read_b128 v[72:75], v5 offset:15360
    buffer_load_dwordx4 v196, s[64:67], s59 offen offset:1024 sc1 lds
    v_mfma_f32_16x16x32_bf16 v[48:51], v[80:83], a[8:11], v[48:51]
    ds_read_b128 v[76:79], v5 offset:16384
    s_waitcnt vmcnt(12) lgkmcnt(9)
    v_mfma_f32_16x16x32_bf16 v[32:35], v[84:87], a[12:15], v[32:35]
    ds_read_b128 v[80:83], v5 offset:17408
    s_add_u32 m0, s84, 32768
    v_mfma_f32_16x16x32_bf16 v[36:39], v[88:91], a[12:15], v[36:39]
    ds_read_b128 v[84:87], v5 offset:18432
    s_add_u32 s59, s20, 32768
    v_mfma_f32_16x16x32_bf16 v[40:43], v[92:95], a[12:15], v[40:43]
    ds_read_b128 v[88:91], v5 offset:19456
    buffer_load_dwordx4 v196, s[64:67], s59 offen offset:0 sc1 lds
    v_mfma_f32_16x16x32_bf16 v[44:47], v[96:99], a[12:15], v[44:47]
    ds_read_b128 v[92:95], v5 offset:20480
    v_mfma_f32_16x16x32_bf16 v[48:51], v[100:103], a[12:15], v[48:51]
    ds_read_b128 v[96:99], v5 offset:21504
    s_waitcnt vmcnt(12) lgkmcnt(9)
    v_mfma_f32_16x16x32_bf16 v[32:35], v[104:107], a[16:19], v[32:35]
    ds_read_b128 v[100:103], v5 offset:22528
    buffer_load_dwordx4 v196, s[64:67], s59 offen offset:1024 sc1 lds
    v_mfma_f32_16x16x32_bf16 v[36:39], v[108:111], a[16:19], v[36:39]
    ds_read_b128 v[104:107], v5 offset:23552
    s_add_u32 m0, s84, 40960
    v_mfma_f32_16x16x32_bf16 v[40:43], v[112:115], a[16:19], v[40:43]
    ds_read_b128 v[108:111], v5 offset:24576
    s_add_u32 s59, s20, 40960
    v_mfma_f32_16x16x32_bf16 v[44:47], v[116:119], a[16:19], v[44:47]
    ds_read_b128 v[112:115], v5 offset:25600
    buffer_load_dwordx4 v196, s[64:67], s59 offen offset:0 sc1 lds
    v_mfma_f32_16x16x32_bf16 v[48:51], v[120:123], a[16:19], v[48:51]
    ds_read_b128 v[116:119], v5 offset:26624
    s_waitcnt vmcnt(13) lgkmcnt(9)
    v_mfma_f32_16x16x32_bf16 v[32:35], v[64:67], a[20:23], v[32:35]
    ds_read_b128 v[120:123], v5 offset:27648
    buffer_load_dwordx4 v196, s[64:67], s59 offen offset:1024 sc1 lds
    v_mfma_f32_16x16x32_bf16 v[36:39], v[68:71], a[20:23], v[36:39]
    v_mfma_f32_16x16x32_bf16 v[40:43], v[72:75], a[20:23], v[40:43]
    v_mfma_f32_16x16x32_bf16 v[44:47], v[76:79], a[20:23], v[44:47]
    v_mfma_f32_16x16x32_bf16 v[48:51], v[80:83], a[20:23], v[48:51]
    s_waitcnt vmcnt(13) lgkmcnt(5)
    v_mfma_f32_16x16x32_bf16 v[32:35], v[84:87], a[24:27], v[32:35]
    v_mfma_f32_16x16x32_bf16 v[36:39], v[88:91], a[24:27], v[36:39]
    v_mfma_f32_16x16x32_bf16 v[40:43], v[92:95], a[24:27], v[40:43]
    v_mfma_f32_16x16x32_bf16 v[44:47], v[96:99], a[24:27], v[44:47]
    v_mfma_f32_16x16x32_bf16 v[48:51], v[100:103], a[24:27], v[48:51]
    s_waitcnt vmcnt(12) lgkmcnt(0)
    v_mfma_f32_16x16x32_bf16 v[32:35], v[104:107], a[28:31], v[32:35]
    v_mfma_f32_16x16x32_bf16 v[36:39], v[108:111], a[28:31], v[36:39]
    v_mfma_f32_16x16x32_bf16 v[40:43], v[112:115], a[28:31], v[40:43]
    v_mfma_f32_16x16x32_bf16 v[44:47], v[116:119], a[28:31], v[44:47]
    v_mfma_f32_16x16x32_bf16 v[48:51], v[120:123], a[28:31], v[48:51]
    s_add_u32 s44, s17, s31
    s_add_u32 s44, s44, 25165824
    s_cmp_eq_u32 s16, 1
    s_cbranch_scc1 L_final
    v_cvt_pk_bf16_f32 v208, v32, v33
    v_cvt_pk_bf16_f32 v209, v34, v35
    v_cvt_pk_bf16_f32 v210, v36, v37
    v_cvt_pk_bf16_f32 v211, v38, v39
    buffer_store_dwordx4 v[208:211], v9, s[4:7], s44 offen sc1
    v_cvt_pk_bf16_f32 v216, v48, v49
Lw_11:
    s_cbranch_execz Lw_12
    v_cvt_pk_bf16_f32 v220, v48, v49
    v_cvt_pk_bf16_f32 v217, v50, v51
    v_cvt_pk_bf16_f32 v221, v50, v51
    v_cvt_pk_bf16_f32 v212, v40, v41
    v_cvt_pk_bf16_f32 v213, v42, v43
    v_cvt_pk_bf16_f32 v214, v44, v45
    v_cvt_pk_bf16_f32 v215, v46, v47
    buffer_store_dwordx4 v[212:215], v9, s[4:7], s44 offen offset:2048 sc1
    v_permlane16_swap_b32 v220, v218
    v_permlane16_swap_b32 v221, v219
    s_mov_b32 exec_lo, 0xffff
    s_mov_b32 exec_hi, 0xffff
    buffer_store_dwordx4 v[216:219], v10, s[4:7], s44 offen sc1
    s_mov_b64 exec, -1
    s_mul_i32 s57, s26, 256
    s_add_u32 s57, s57, s18
    s_add_u32 s57, s57, 131072
    s_atomic_add s62, s[12:13], s57
    s_mov_b32 s16, 1
    s_mov_b32 s17, 37748736
    s_mov_b32 s18, 131072
    v_lshlrev_b32 v32, 16, v208
    v_and_b32 v33, 0xffff0000, v208
    v_lshlrev_b32 v34, 16, v209
    v_and_b32 v35, 0xffff0000, v209
    v_lshlrev_b32 v36, 16, v210
    v_and_b32 v37, 0xffff0000, v210
    v_lshlrev_b32 v38, 16, v211
    v_and_b32 v39, 0xffff0000, v211
    v_lshlrev_b32 v40, 16, v212
    v_and_b32 v41, 0xffff0000, v212
    v_lshlrev_b32 v42, 16, v213
    v_and_b32 v43, 0xffff0000, v213
    v_lshlrev_b32 v44, 16, v214
    v_and_b32 v45, 0xffff0000, v214
    v_lshlrev_b32 v46, 16, v215
    v_and_b32 v47, 0xffff0000, v215
    v_lshlrev_b32 v48, 16, v216
    v_and_b32 v49, 0xffff0000, v216
    v_lshlrev_b32 v50, 16, v217
    v_and_b32 v51, 0xffff0000, v217
    v_pk_add_f32 v[224:225], v[32:33], v[34:35]
    v_pk_add_f32 v[226:227], v[36:37], v[38:39]
    v_pk_add_f32 v[224:225], v[224:225], v[40:41]
    v_pk_add_f32 v[226:227], v[226:227], v[42:43]
    v_pk_add_f32 v[224:225], v[224:225], v[44:45]
    v_pk_add_f32 v[226:227], v[226:227], v[46:47]
    v_pk_add_f32 v[224:225], v[224:225], v[48:49]
    v_pk_add_f32 v[226:227], v[226:227], v[50:51]
    v_pk_add_f32 v[224:225], v[224:225], v[226:227]
    v_add_f32 v224, v224, v225
    v_mov_b32 v225, v224
    s_nop 1
    v_permlane16_swap_b32 v224, v225
    v_add_f32 v224, v224, v225
    v_mov_b32 v225, v224
    s_nop 1
    v_permlane32_swap_b32 v224, v225
    v_add_f32 v224, v224, v225
    v_mul_f32 v224, 1011666125, v224
    v_pk_add_f32 v[232:233], v[32:33], v[224:225] op_sel_hi:[1,0] neg_lo:[0,1] neg_hi:[0,1]
    v_pk_mul_f32 v[228:229], v[232:233], v[232:233]
    v_pk_add_f32 v[234:235], v[34:35], v[224:225] op_sel_hi:[1,0] neg_lo:[0,1] neg_hi:[0,1]
    v_pk_mul_f32 v[230:231], v[234:235], v[234:235]
    v_pk_add_f32 v[236:237], v[36:37], v[224:225] op_sel_hi:[1,0] neg_lo:[0,1] neg_hi:[0,1]
    v_pk_fma_f32 v[228:229], v[236:237], v[236:237], v[228:229]
    v_pk_add_f32 v[238:239], v[38:39], v[224:225] op_sel_hi:[1,0] neg_lo:[0,1] neg_hi:[0,1]
    v_pk_fma_f32 v[230:231], v[238:239], v[238:239], v[230:231]
    v_pk_add_f32 v[232:233], v[40:41], v[224:225] op_sel_hi:[1,0] neg_lo:[0,1] neg_hi:[0,1]
    v_pk_fma_f32 v[228:229], v[232:233], v[232:233], v[228:229]
    v_pk_add_f32 v[234:235], v[42:43], v[224:225] op_sel_hi:[1,0] neg_lo:[0,1] neg_hi:[0,1]
    v_pk_fma_f32 v[230:231], v[234:235], v[234:235], v[230:231]
    v_pk_add_f32 v[236:237], v[44:45], v[224:225] op_sel_hi:[1,0] neg_lo:[0,1] neg_hi:[0,1]
    v_pk_fma_f32 v[228:229], v[236:237], v[236:237], v[228:229]
    v_pk_add_f32 v[238:239], v[46:47], v[224:225] op_sel_hi:[1,0] neg_lo:[0,1] neg_hi:[0,1]
    v_pk_fma_f32 v[230:231], v[238:239], v[238:239], v[230:231]
    v_pk_add_f32 v[232:233], v[48:49], v[224:225] op_sel_hi:[1,0] neg_lo:[0,1] neg_hi:[0,1]
    v_pk_fma_f32 v[228:229], v[232:233], v[232:233], v[228:229]
    v_pk_add_f32 v[234:235], v[50:51], v[224:225] op_sel_hi:[1,0] neg_lo:[0,1] neg_hi:[0,1]
    v_pk_fma_f32 v[230:231], v[234:235], v[234:235], v[230:231]
    v_pk_add_f32 v[228:229], v[228:229], v[230:231]
    v_add_f32 v225, v228, v229
    v_mov_b32 v226, v225
    s_nop 1
    v_permlane16_swap_b32 v225, v226
    v_add_f32 v225, v225, v226
    v_mov_b32 v226, v225
    s_nop 1
    v_permlane32_swap_b32 v225, v226
    v_add_f32 v225, v225, v226
    s_add_u32 s44, s17, s32
    s_add_u32 s44, s44, 20971520
    s_mov_b64 exec, 0xffff
    buffer_store_dwordx2 v[224:225], v29, s[4:7], s44 offen sc1
    s_mov_b64 exec, -1
    s_waitcnt vmcnt(10)
    s_barrier
    ds_write_b128 v3, a[160:163] offset:49152
    ds_write_b128 v3, a[164:167] offset:53248
    s_mul_i32 s56, s24, 256
    s_add_u32 s56, s56, s18
    s_mov_b32 s63, 0
    s_atomic_add s63, s[12:13], s56 glc
    ds_write_b128 v3, a[168:171] offset:57344
    ds_write_b128 v3, a[172:175] offset:61440
    ds_write_b128 v199, a[176:179] offset:0
    ds_write_b128 v199, a[180:183] offset:4096
    s_mov_b32 s66, 0
    s_branch L_top
L_final:
Lw_12:
    s_cbranch_execz Lw_done
    s_nop 5
    v_cvt_pk_bf16_f32 v208, v32, v33
    v_cvt_pk_bf16_f32 v209, v34, v35
    v_cvt_pk_bf16_f32 v210, v36, v37
    v_cvt_pk_bf16_f32 v211, v38, v39
    buffer_store_dwordx4 v[208:211], v11, s[8:11], s40 offen
    v_cvt_pk_bf16_f32 v216, v48, v49
    v_cvt_pk_bf16_f32 v220, v48, v49
    v_cvt_pk_bf16_f32 v217, v50, v51
    v_cvt_pk_bf16_f32 v221, v50, v51
    v_cvt_pk_bf16_f32 v212, v40, v41
    v_cvt_pk_bf16_f32 v213, v42, v43
    v_cvt_pk_bf16_f32 v214, v44, v45
    v_cvt_pk_bf16_f32 v215, v46, v47
    buffer_store_dwordx4 v[212:215], v11, s[8:11], s40 offen offset:64
    v_permlane16_swap_b32 v220, v218
    v_permlane16_swap_b32 v221, v219
    s_mov_b32 exec_lo, 0xffff
    s_mov_b32 exec_hi, 0xffff
    buffer_store_dwordx4 v[216:219], v12, s[8:11], s40 offen
    s_mov_b64 exec, -1
    s_waitcnt vmcnt(0)
L_end:
    s_endpgm
L_ijredo:
    s_waitcnt lgkmcnt(0)
    s_mov_b32 s100, s44
    s_mov_b32 s101, 1
    s_branch L_ij
Lkvre_54:
    s_add_u32 s99, s99, 1
    s_cmp_ge_u32 s99, 3000
    s_cbranch_scc1 Lkvre_54_b
    s_add_u32 s44, s17, s39
    s_mov_b64 exec, s[88:89]
    buffer_load_dwordx4 v[72:75], v202, s[4:7], s44 offen sc1
    s_add_u32 s44, s44, 3584
    buffer_load_dwordx4 v[76:79], v202, s[4:7], s44 offen sc1
    s_add_u32 s44, s44, 3584
    buffer_load_dwordx4 v[80:83], v202, s[4:7], s44 offen sc1
    s_add_u32 s44, s44, 3584
    buffer_load_dwordx4 v[84:87], v202, s[4:7], s44 offen sc1
    s_add_u32 s44, s44, 3584
    buffer_load_dwordx4 v[88:91], v202, s[4:7], s44 offen sc1
    s_add_u32 s44, s44, 3584
    buffer_load_dwordx4 v[92:95], v202, s[4:7], s44 offen sc1
    s_add_u32 s44, s44, 3584
    buffer_load_dwordx4 v[96:99], v202, s[4:7], s44 offen sc1
    s_add_u32 s44, s44, 3584
    buffer_load_dwordx4 v[100:103], v202, s[4:7], s44 offen sc1
    s_mov_b64 exec, -1
    s_waitcnt vmcnt(0)
    s_branch Lkvsum_53
Lre_57:
    s_mov_b32 s99, 0
Lre_57_l:
    s_add_u32 s98, s17, s29
    s_add_u32 s98, s98, 8388608
    buffer_load_dwordx4 a[0:3], v2, s[4:7], s98 offen sc1
    s_waitcnt vmcnt(0)
    v_accvgpr_read_b32 v203, a0
    v_cmp_eq_u32 vcc, -1, v203
    s_add_u32 s99, s99, 1
    s_nop 0
    s_cbranch_vccz Lbk_58
    s_cmp_lt_u32 s99, 3000
    s_cbranch_scc1 Lre_57_l
    s_branch Lbk_58
Lre_59:
    s_mov_b32 s99, 0
Lre_59_l:
    s_add_u32 s98, s17, s29
    s_add_u32 s98, s98, 8389632
    buffer_load_dwordx4 a[4:7], v2, s[4:7], s98 offen sc1
    s_waitcnt vmcnt(0)
    v_accvgpr_read_b32 v203, a4
    v_cmp_eq_u32 vcc, -1, v203
    s_add_u32 s99, s99, 1
    s_nop 0
    s_cbranch_vccz Lbk_60
    s_cmp_lt_u32 s99, 3000
    s_cbranch_scc1 Lre_59_l
    s_branch Lbk_60
Lre_61:
    s_mov_b32 s99, 0
Lre_61_l:
    s_add_u32 s98, s17, s29
    s_add_u32 s98, s98, 8390656
    buffer_load_dwordx4 a[8:11], v2, s[4:7], s98 offen sc1
    s_waitcnt vmcnt(0)
    v_accvgpr_read_b32 v203, a8
    v_cmp_eq_u32 vcc, -1, v203
    s_add_u32 s99, s99, 1
    s_nop 0
    s_cbranch_vccz Lbk_62
    s_cmp_lt_u32 s99, 3000
    s_cbranch_scc1 Lre_61_l
    s_branch Lbk_62
Lre_63:
    s_mov_b32 s99, 0
Lre_63_l:
    s_add_u32 s98, s17, s29
    s_add_u32 s98, s98, 8391680
    buffer_load_dwordx4 a[12:15], v2, s[4:7], s98 offen sc1
    s_waitcnt vmcnt(0)
    v_accvgpr_read_b32 v203, a12
    v_cmp_eq_u32 vcc, -1, v203
    s_add_u32 s99, s99, 1
    s_nop 0
    s_cbranch_vccz Lbk_64
    s_cmp_lt_u32 s99, 3000
    s_cbranch_scc1 Lre_63_l
    s_branch Lbk_64
Lre_65:
    s_mov_b32 s99, 0
Lre_65_l:
    s_add_u32 s98, s17, s29
    s_add_u32 s98, s98, 8392704
    buffer_load_dwordx4 a[16:19], v2, s[4:7], s98 offen sc1
    s_waitcnt vmcnt(0)
    v_accvgpr_read_b32 v203, a16
    v_cmp_eq_u32 vcc, -1, v203
    s_add_u32 s99, s99, 1
    s_nop 0
    s_cbranch_vccz Lbk_66
    s_cmp_lt_u32 s99, 3000
    s_cbranch_scc1 Lre_65_l
    s_branch Lbk_66
Lre_67:
    s_mov_b32 s99, 0
Lre_67_l:
    s_add_u32 s98, s17, s29
    s_add_u32 s98, s98, 8404992
    buffer_load_dwordx4 a[20:23], v2, s[4:7], s98 offen sc1
    s_waitcnt vmcnt(0)
    v_accvgpr_read_b32 v203, a20
    v_cmp_eq_u32 vcc, -1, v203
    s_add_u32 s99, s99, 1
    s_nop 0
    s_cbranch_vccz Lbk_68
    s_cmp_lt_u32 s99, 3000
    s_cbranch_scc1 Lre_67_l
    s_branch Lbk_68
Lre_69:
    s_mov_b32 s99, 0
Lre_69_l:
    s_add_u32 s98, s17, s29
    s_add_u32 s98, s98, 8406016
    buffer_load_dwordx4 a[24:27], v2, s[4:7], s98 offen sc1
    s_waitcnt vmcnt(0)
    v_accvgpr_read_b32 v203, a24
    v_cmp_eq_u32 vcc, -1, v203
    s_add_u32 s99, s99, 1
    s_nop 0
    s_cbranch_vccz Lbk_70
    s_cmp_lt_u32 s99, 3000
    s_cbranch_scc1 Lre_69_l
    s_branch Lbk_70
Lre_71:
    s_mov_b32 s99, 0
Lre_71_l:
    s_add_u32 s98, s17, s29
    s_add_u32 s98, s98, 8407040
    buffer_load_dwordx4 a[28:31], v2, s[4:7], s98 offen sc1
    s_waitcnt vmcnt(0)
    v_accvgpr_read_b32 v203, a28
    v_cmp_eq_u32 vcc, -1, v203
    s_add_u32 s99, s99, 1
    s_nop 0
    s_cbranch_vccz Lbk_72
    s_cmp_lt_u32 s99, 3000
    s_cbranch_scc1 Lre_71_l
    s_branch Lbk_72
Lre_73:
    s_mov_b32 s99, 0
Lre_73_l:
    s_add_u32 s98, s17, s29
    s_add_u32 s98, s98, 8408064
    buffer_load_dwordx4 a[32:35], v2, s[4:7], s98 offen sc1
    s_waitcnt vmcnt(0)
    v_accvgpr_read_b32 v203, a32
    v_cmp_eq_u32 vcc, -1, v203
    s_add_u32 s99, s99, 1
    s_nop 0
    s_cbranch_vccz Lbk_74
    s_cmp_lt_u32 s99, 3000
    s_cbranch_scc1 Lre_73_l
    s_branch Lbk_74
Lre_75:
    s_mov_b32 s99, 0
Lre_75_l:
    s_add_u32 s98, s17, s29
    s_add_u32 s98, s98, 8409088
    buffer_load_dwordx4 a[36:39], v2, s[4:7], s98 offen sc1
    s_waitcnt vmcnt(0)
    v_accvgpr_read_b32 v203, a36
    v_cmp_eq_u32 vcc, -1, v203
    s_add_u32 s99, s99, 1
    s_nop 0
    s_cbranch_vccz Lbk_76
    s_cmp_lt_u32 s99, 3000
    s_cbranch_scc1 Lre_75_l
    s_branch Lbk_76
Lre_77:
    s_mov_b32 s99, 0
Lre_77_l:
    s_add_u32 s98, s17, s29
    s_add_u32 s98, s98, 8421376
    buffer_load_dwordx4 a[40:43], v2, s[4:7], s98 offen sc1
    s_waitcnt vmcnt(0)
    v_accvgpr_read_b32 v203, a40
    v_cmp_eq_u32 vcc, -1, v203
    s_add_u32 s99, s99, 1
    s_nop 0
    s_cbranch_vccz Lbk_78
    s_cmp_lt_u32 s99, 3000
    s_cbranch_scc1 Lre_77_l
    s_branch Lbk_78
Lre_79:
    s_mov_b32 s99, 0
Lre_79_l:
    s_add_u32 s98, s17, s29
    s_add_u32 s98, s98, 8422400
    buffer_load_dwordx4 a[44:47], v2, s[4:7], s98 offen sc1
    s_waitcnt vmcnt(0)
    v_accvgpr_read_b32 v203, a44
    v_cmp_eq_u32 vcc, -1, v203
    s_add_u32 s99, s99, 1
    s_nop 0
    s_cbranch_vccz Lbk_80
    s_cmp_lt_u32 s99, 3000
    s_cbranch_scc1 Lre_79_l
    s_branch Lbk_80
Lre_81:
    s_mov_b32 s99, 0
Lre_81_l:
    s_add_u32 s98, s17, s29
    s_add_u32 s98, s98, 8423424
    buffer_load_dwordx4 a[48:51], v2, s[4:7], s98 offen sc1
    s_waitcnt vmcnt(0)
    v_accvgpr_read_b32 v203, a48
    v_cmp_eq_u32 vcc, -1, v203
    s_add_u32 s99, s99, 1
    s_nop 0
    s_cbranch_vccz Lbk_82
    s_cmp_lt_u32 s99, 3000
    s_cbranch_scc1 Lre_81_l
    s_branch Lbk_82
Lre_83:
    s_mov_b32 s99, 0
Lre_83_l:
    s_add_u32 s98, s17, s29
    s_add_u32 s98, s98, 8424448
    buffer_load_dwordx4 a[52:55], v2, s[4:7], s98 offen sc1
    s_waitcnt vmcnt(0)
    v_accvgpr_read_b32 v203, a52
    v_cmp_eq_u32 vcc, -1, v203
    s_add_u32 s99, s99, 1
    s_nop 0
    s_cbranch_vccz Lbk_84
    s_cmp_lt_u32 s99, 3000
    s_cbranch_scc1 Lre_83_l
    s_branch Lbk_84
Lre_85:
    s_mov_b32 s99, 0
Lre_85_l:
    s_add_u32 s98, s17, s29
    s_add_u32 s98, s98, 8425472
    buffer_load_dwordx4 a[56:59], v2, s[4:7], s98 offen sc1
    s_waitcnt vmcnt(0)
    v_accvgpr_read_b32 v203, a56
    v_cmp_eq_u32 vcc, -1, v203
    s_add_u32 s99, s99, 1
    s_nop 0
    s_cbranch_vccz Lbk_86
    s_cmp_lt_u32 s99, 3000
    s_cbranch_scc1 Lre_85_l
    s_branch Lbk_86
Lre_87:
    s_mov_b32 s99, 0
Lre_87_l:
    s_add_u32 s98, s17, s29
    s_add_u32 s98, s98, 8437760
    buffer_load_dwordx4 a[60:63], v2, s[4:7], s98 offen sc1
    s_waitcnt vmcnt(0)
    v_accvgpr_read_b32 v203, a60
    v_cmp_eq_u32 vcc, -1, v203
    s_add_u32 s99, s99, 1
    s_nop 0
    s_cbranch_vccz Lbk_88
    s_cmp_lt_u32 s99, 3000
    s_cbranch_scc1 Lre_87_l
    s_branch Lbk_88
Lre_89:
    s_mov_b32 s99, 0
Lre_89_l:
    s_add_u32 s98, s17, s29
    s_add_u32 s98, s98, 8438784
    buffer_load_dwordx4 a[64:67], v2, s[4:7], s98 offen sc1
    s_waitcnt vmcnt(0)
    v_accvgpr_read_b32 v203, a64
    v_cmp_eq_u32 vcc, -1, v203
    s_add_u32 s99, s99, 1
    s_nop 0
    s_cbranch_vccz Lbk_90
    s_cmp_lt_u32 s99, 3000
    s_cbranch_scc1 Lre_89_l
    s_branch Lbk_90
Lre_91:
    s_mov_b32 s99, 0
Lre_91_l:
    s_add_u32 s98, s17, s29
    s_add_u32 s98, s98, 8439808
    buffer_load_dwordx4 a[68:71], v2, s[4:7], s98 offen sc1
    s_waitcnt vmcnt(0)
    v_accvgpr_read_b32 v203, a68
    v_cmp_eq_u32 vcc, -1, v203
    s_add_u32 s99, s99, 1
    s_nop 0
    s_cbranch_vccz Lbk_92
    s_cmp_lt_u32 s99, 3000
    s_cbranch_scc1 Lre_91_l
    s_branch Lbk_92
Lre_93:
    s_mov_b32 s99, 0
Lre_93_l:
    s_add_u32 s98, s17, s29
    s_add_u32 s98, s98, 8440832
    buffer_load_dwordx4 a[72:75], v2, s[4:7], s98 offen sc1
    s_waitcnt vmcnt(0)
    v_accvgpr_read_b32 v203, a72
    v_cmp_eq_u32 vcc, -1, v203
    s_add_u32 s99, s99, 1
    s_nop 0
    s_cbranch_vccz Lbk_94
    s_cmp_lt_u32 s99, 3000
    s_cbranch_scc1 Lre_93_l
    s_branch Lbk_94
Lre_95:
    s_mov_b32 s99, 0
Lre_95_l:
    s_add_u32 s98, s17, s29
    s_add_u32 s98, s98, 8441856
    buffer_load_dwordx4 a[76:79], v2, s[4:7], s98 offen sc1
    s_waitcnt vmcnt(0)
    v_accvgpr_read_b32 v203, a76
    v_cmp_eq_u32 vcc, -1, v203
    s_add_u32 s99, s99, 1
    s_nop 0
    s_cbranch_vccz Lbk_96
    s_cmp_lt_u32 s99, 3000
    s_cbranch_scc1 Lre_95_l
    s_branch Lbk_96
Lre_101:
    s_mov_b32 s99, 0
Lre_101_l:
    s_add_u32 s98, s17, s27
    s_add_u32 s98, s98, 0
    buffer_load_dwordx4 a[0:3], v2, s[4:7], s98 offen sc1
    s_waitcnt vmcnt(0)
    v_accvgpr_read_b32 v203, a0
    v_cmp_eq_u32 vcc, -1, v203
    s_add_u32 s99, s99, 1
    s_nop 0
    s_cbranch_vccz Lbk_102
    s_cmp_lt_u32 s99, 3000
    s_cbranch_scc1 Lre_101_l
    s_branch Lbk_102
Lre_103:
    s_mov_b32 s99, 0
Lre_103_l:
    s_add_u32 s98, s17, s27
    s_add_u32 s98, s98, 1024
    buffer_load_dwordx4 a[4:7], v2, s[4:7], s98 offen sc1
    s_waitcnt vmcnt(0)
    v_accvgpr_read_b32 v203, a4
    v_cmp_eq_u32 vcc, -1, v203
    s_add_u32 s99, s99, 1
    s_nop 0
    s_cbranch_vccz Lbk_104
    s_cmp_lt_u32 s99, 3000
    s_cbranch_scc1 Lre_103_l
    s_branch Lbk_104
Lre_105:
    s_mov_b32 s99, 0
Lre_105_l:
    s_add_u32 s98, s17, s27
    s_add_u32 s98, s98, 2048
    buffer_load_dwordx4 a[8:11], v2, s[4:7], s98 offen sc1
    s_waitcnt vmcnt(0)
    v_accvgpr_read_b32 v203, a8
    v_cmp_eq_u32 vcc, -1, v203
    s_add_u32 s99, s99, 1
    s_nop 0
    s_cbranch_vccz Lbk_106
    s_cmp_lt_u32 s99, 3000
    s_cbranch_scc1 Lre_105_l
    s_branch Lbk_106
Lre_107:
    s_mov_b32 s99, 0
Lre_107_l:
    s_add_u32 s98, s17, s27
    s_add_u32 s98, s98, 3072
    buffer_load_dwordx4 a[12:15], v2, s[4:7], s98 offen sc1
    s_waitcnt vmcnt(0)
    v_accvgpr_read_b32 v203, a12
    v_cmp_eq_u32 vcc, -1, v203
    s_add_u32 s99, s99, 1
    s_nop 0
    s_cbranch_vccz Lbk_108
    s_cmp_lt_u32 s99, 3000
    s_cbranch_scc1 Lre_107_l
    s_branch Lbk_108
Lre_109:
    s_mov_b32 s99, 0
Lre_109_l:
    s_add_u32 s98, s17, s27
    s_add_u32 s98, s98, 4096
    buffer_load_dwordx4 a[16:19], v2, s[4:7], s98 offen sc1
    s_waitcnt vmcnt(0)
    v_accvgpr_read_b32 v203, a16
    v_cmp_eq_u32 vcc, -1, v203
    s_add_u32 s99, s99, 1
    s_nop 0
    s_cbranch_vccz Lbk_110
    s_cmp_lt_u32 s99, 3000
    s_cbranch_scc1 Lre_109_l
    s_branch Lbk_110
Lre_111:
    s_mov_b32 s99, 0
Lre_111_l:
    s_add_u32 s98, s17, s27
    s_add_u32 s98, s98, 16384
    buffer_load_dwordx4 a[20:23], v2, s[4:7], s98 offen sc1
    s_waitcnt vmcnt(0)
    v_accvgpr_read_b32 v203, a20
    v_cmp_eq_u32 vcc, -1, v203
    s_add_u32 s99, s99, 1
    s_nop 0
    s_cbranch_vccz Lbk_112
    s_cmp_lt_u32 s99, 3000
    s_cbranch_scc1 Lre_111_l
    s_branch Lbk_112
Lre_113:
    s_mov_b32 s99, 0
Lre_113_l:
    s_add_u32 s98, s17, s27
    s_add_u32 s98, s98, 17408
    buffer_load_dwordx4 a[24:27], v2, s[4:7], s98 offen sc1
    s_add_u32 s98, s17, s27
    s_add_u32 s98, s98, 18432
    buffer_load_dwordx4 a[28:31], v2, s[4:7], s98 offen sc1
    s_add_u32 s98, s17, s27
    s_add_u32 s98, s98, 19456
    buffer_load_dwordx4 a[32:35], v2, s[4:7], s98 offen sc1
    s_waitcnt vmcnt(0)
    v_accvgpr_read_b32 v203, a24
    v_accvgpr_read_b32 v23, a28
    v_accvgpr_read_b32 v30, a32
    v_max3_u32 v203, v23, v30, v203
    v_cmp_eq_u32 vcc, -1, v203
    s_add_u32 s99, s99, 1
    s_nop 0
    s_cbranch_vccz Lbk_114
    s_cmp_lt_u32 s99, 3000
    s_cbranch_scc1 Lre_113_l
    s_branch Lbk_114
Lre_115:
    s_mov_b32 s99, 0
Lre_115_l:
    s_add_u32 s98, s17, s27
    s_add_u32 s98, s98, 20480
    buffer_load_dwordx4 a[36:39], v2, s[4:7], s98 offen sc1
    s_add_u32 s98, s17, s27
    s_add_u32 s98, s98, 32768
    buffer_load_dwordx4 a[40:43], v2, s[4:7], s98 offen sc1
    s_add_u32 s98, s17, s27
    s_add_u32 s98, s98, 33792
    buffer_load_dwordx4 a[44:47], v2, s[4:7], s98 offen sc1
    s_waitcnt vmcnt(0)
    v_accvgpr_read_b32 v203, a36
    v_accvgpr_read_b32 v23, a40
    v_accvgpr_read_b32 v30, a44
    v_max3_u32 v203, v23, v30, v203
    v_cmp_eq_u32 vcc, -1, v203
    s_add_u32 s99, s99, 1
    s_nop 0
    s_cbranch_vccz Lbk_116
    s_cmp_lt_u32 s99, 3000
    s_cbranch_scc1 Lre_115_l
    s_branch Lbk_116
Lre_117:
    s_mov_b32 s99, 0
Lre_117_l:
    s_add_u32 s98, s17, s27
    s_add_u32 s98, s98, 34816
    buffer_load_dwordx4 a[48:51], v2, s[4:7], s98 offen sc1
    s_add_u32 s98, s17, s27
    s_add_u32 s98, s98, 35840
    buffer_load_dwordx4 a[52:55], v2, s[4:7], s98 offen sc1
    s_add_u32 s98, s17, s27
    s_add_u32 s98, s98, 36864
    buffer_load_dwordx4 a[56:59], v2, s[4:7], s98 offen sc1
    s_waitcnt vmcnt(0)
    v_accvgpr_read_b32 v203, a48
    v_accvgpr_read_b32 v23, a52
    v_accvgpr_read_b32 v30, a56
    v_max3_u32 v203, v23, v30, v203
    v_cmp_eq_u32 vcc, -1, v203
    s_add_u32 s99, s99, 1
    s_nop 0
    s_cbranch_vccz Lbk_118
    s_cmp_lt_u32 s99, 3000
    s_cbranch_scc1 Lre_117_l
    s_branch Lbk_118
Lre_121:
    s_mov_b32 s99, 0
Lre_121_l:
    s_add_u32 s98, s17, s27
    s_add_u32 s98, s98, 49152
    buffer_load_dwordx4 a[60:63], v2, s[4:7], s98 offen sc1
    s_add_u32 s98, s17, s27
    s_add_u32 s98, s98, 50176
    buffer_load_dwordx4 a[64:67], v2, s[4:7], s98 offen sc1
    s_add_u32 s98, s17, s27
    s_add_u32 s98, s98, 51200
    buffer_load_dwordx4 a[68:71], v2, s[4:7], s98 offen sc1
    s_waitcnt vmcnt(0)
    v_accvgpr_read_b32 v203, a60
    v_accvgpr_read_b32 v23, a64
    v_accvgpr_read_b32 v30, a68
    v_max3_u32 v203, v23, v30, v203
    v_cmp_eq_u32 vcc, -1, v203
    s_add_u32 s99, s99, 1
    s_nop 0
    s_cbranch_vccz Lbk_122
    s_cmp_lt_u32 s99, 3000
    s_cbranch_scc1 Lre_121_l
    s_branch Lbk_122
Lre_123:
    s_mov_b32 s99, 0
Lre_123_l:
    s_add_u32 s98, s17, s27
    s_add_u32 s98, s98, 52224
    buffer_load_dwordx4 a[72:75], v2, s[4:7], s98 offen sc1
    s_add_u32 s98, s17, s27
    s_add_u32 s98, s98, 53248
    buffer_load_dwordx4 a[76:79], v2, s[4:7], s98 offen sc1
    s_add_u32 s98, s17, s27
    s_add_u32 s98, s98, 65536
    buffer_load_dwordx4 a[80:83], v2, s[4:7], s98 offen sc1
    s_waitcnt vmcnt(0)
    v_accvgpr_read_b32 v203, a72
    v_accvgpr_read_b32 v23, a76
    v_accvgpr_read_b32 v30, a80
    v_max3_u32 v203, v23, v30, v203
    v_cmp_eq_u32 vcc, -1, v203
    s_add_u32 s99, s99, 1
    s_nop 0
    s_cbranch_vccz Lbk_124
    s_cmp_lt_u32 s99, 3000
    s_cbranch_scc1 Lre_123_l
    s_branch Lbk_124
Lre_125:
    s_mov_b32 s99, 0
Lre_125_l:
    s_add_u32 s98, s17, s27
    s_add_u32 s98, s98, 66560
    buffer_load_dwordx4 a[84:87], v2, s[4:7], s98 offen sc1
    s_add_u32 s98, s17, s27
    s_add_u32 s98, s98, 67584
    buffer_load_dwordx4 a[88:91], v2, s[4:7], s98 offen sc1
    s_add_u32 s98, s17, s27
    s_add_u32 s98, s98, 68608
    buffer_load_dwordx4 a[92:95], v2, s[4:7], s98 offen sc1
    s_waitcnt vmcnt(0)
    v_accvgpr_read_b32 v203, a84
    v_accvgpr_read_b32 v23, a88
    v_accvgpr_read_b32 v30, a92
    v_max3_u32 v203, v23, v30, v203
    v_cmp_eq_u32 vcc, -1, v203
    s_add_u32 s99, s99, 1
    s_nop 0
    s_cbranch_vccz Lbk_126
    s_cmp_lt_u32 s99, 3000
    s_cbranch_scc1 Lre_125_l
    s_branch Lbk_126
Lre_127:
    s_mov_b32 s99, 0
Lre_127_l:
    s_add_u32 s98, s17, s27
    s_add_u32 s98, s98, 69632
    buffer_load_dwordx4 a[96:99], v2, s[4:7], s98 offen sc1
    s_add_u32 s98, s17, s27
    s_add_u32 s98, s98, 81920
    buffer_load_dwordx4 a[100:103], v2, s[4:7], s98 offen sc1
    s_add_u32 s98, s17, s27
    s_add_u32 s98, s98, 82944
    buffer_load_dwordx4 a[104:107], v2, s[4:7], s98 offen sc1
    s_waitcnt vmcnt(0)
    v_accvgpr_read_b32 v203, a96
    v_accvgpr_read_b32 v23, a100
    v_accvgpr_read_b32 v30, a104
    v_max3_u32 v203, v23, v30, v203
    v_cmp_eq_u32 vcc, -1, v203
    s_add_u32 s99, s99, 1
    s_nop 0
    s_cbranch_vccz Lbk_128
    s_cmp_lt_u32 s99, 3000
    s_cbranch_scc1 Lre_127_l
    s_branch Lbk_128
Lre_129:
    s_mov_b32 s99, 0
Lre_129_l:
    s_add_u32 s98, s17, s27
    s_add_u32 s98, s98, 83968
    buffer_load_dwordx4 a[108:111], v2, s[4:7], s98 offen sc1
    s_waitcnt vmcnt(0)
    v_accvgpr_read_b32 v203, a108
    v_cmp_eq_u32 vcc, -1, v203
    s_add_u32 s99, s99, 1
    s_nop 0
    s_cbranch_vccz Lbk_130
    s_cmp_lt_u32 s99, 3000
    s_cbranch_scc1 Lre_129_l
    s_branch Lbk_130
Lkvre_134:
    s_add_u32 s99, s99, 1
    s_cmp_ge_u32 s99, 3000
    s_cbranch_scc1 Lkvre_134_b
    s_add_u32 s44, s17, s39
    s_mov_b64 exec, s[88:89]
    buffer_load_dwordx4 v[72:75], v202, s[4:7], s44 offen sc1
    s_add_u32 s44, s44, 3584
    buffer_load_dwordx4 v[76:79], v202, s[4:7], s44 offen sc1
    s_add_u32 s44, s44, 3584
    buffer_load_dwordx4 v[80:83], v202, s[4:7], s44 offen sc1
    s_add_u32 s44, s44, 3584
    buffer_load_dwordx4 v[84:87], v202, s[4:7], s44 offen sc1
    s_add_u32 s44, s44, 3584
    buffer_load_dwordx4 v[88:91], v202, s[4:7], s44 offen sc1
    s_add_u32 s44, s44, 3584
    buffer_load_dwordx4 v[92:95], v202, s[4:7], s44 offen sc1
    s_add_u32 s44, s44, 3584
    buffer_load_dwordx4 v[96:99], v202, s[4:7], s44 offen sc1
    s_add_u32 s44, s44, 3584
    buffer_load_dwordx4 v[100:103], v202, s[4:7], s44 offen sc1
    s_mov_b64 exec, -1
    s_waitcnt vmcnt(0)
    s_branch Lkvsum_133
Lre_137:
    s_mov_b32 s99, 0
Lre_137_l:
    s_add_u32 s98, s17, s29
    s_add_u32 s98, s98, 8388608
    buffer_load_dwordx4 a[0:3], v2, s[4:7], s98 offen sc1
    s_waitcnt vmcnt(0)
    v_accvgpr_read_b32 v203, a0
    v_cmp_eq_u32 vcc, -1, v203
    s_add_u32 s99, s99, 1
    s_nop 0
    s_cbranch_vccz Lbk_138
    s_cmp_lt_u32 s99, 3000
    s_cbranch_scc1 Lre_137_l
    s_branch Lbk_138
Lre_139:
    s_mov_b32 s99, 0
Lre_139_l:
    s_add_u32 s98, s17, s29
    s_add_u32 s98, s98, 8389632
    buffer_load_dwordx4 a[4:7], v2, s[4:7], s98 offen sc1
    s_waitcnt vmcnt(0)
    v_accvgpr_read_b32 v203, a4
    v_cmp_eq_u32 vcc, -1, v203
    s_add_u32 s99, s99, 1
    s_nop 0
    s_cbranch_vccz Lbk_140
    s_cmp_lt_u32 s99, 3000
    s_cbranch_scc1 Lre_139_l
    s_branch Lbk_140
Lre_141:
    s_mov_b32 s99, 0
Lre_141_l:
    s_add_u32 s98, s17, s29
    s_add_u32 s98, s98, 8390656
    buffer_load_dwordx4 a[8:11], v2, s[4:7], s98 offen sc1
    s_waitcnt vmcnt(0)
    v_accvgpr_read_b32 v203, a8
    v_cmp_eq_u32 vcc, -1, v203
    s_add_u32 s99, s99, 1
    s_nop 0
    s_cbranch_vccz Lbk_142
    s_cmp_lt_u32 s99, 3000
    s_cbranch_scc1 Lre_141_l
    s_branch Lbk_142
Lre_143:
    s_mov_b32 s99, 0
Lre_143_l:
    s_add_u32 s98, s17, s29
    s_add_u32 s98, s98, 8391680
    buffer_load_dwordx4 a[12:15], v2, s[4:7], s98 offen sc1
    s_waitcnt vmcnt(0)
    v_accvgpr_read_b32 v203, a12
    v_cmp_eq_u32 vcc, -1, v203
    s_add_u32 s99, s99, 1
    s_nop 0
    s_cbranch_vccz Lbk_144
    s_cmp_lt_u32 s99, 3000
    s_cbranch_scc1 Lre_143_l
    s_branch Lbk_144
Lre_145:
    s_mov_b32 s99, 0
Lre_145_l:
    s_add_u32 s98, s17, s29
    s_add_u32 s98, s98, 8392704
    buffer_load_dwordx4 a[16:19], v2, s[4:7], s98 offen sc1
    s_waitcnt vmcnt(0)
    v_accvgpr_read_b32 v203, a16
    v_cmp_eq_u32 vcc, -1, v203
    s_add_u32 s99, s99, 1
    s_nop 0
    s_cbranch_vccz Lbk_146
    s_cmp_lt_u32 s99, 3000
    s_cbranch_scc1 Lre_145_l
    s_branch Lbk_146
Lre_147:
    s_mov_b32 s99, 0
Lre_147_l:
    s_add_u32 s98, s17, s29
    s_add_u32 s98, s98, 8404992
    buffer_load_dwordx4 a[20:23], v2, s[4:7], s98 offen sc1
    s_waitcnt vmcnt(0)
    v_accvgpr_read_b32 v203, a20
    v_cmp_eq_u32 vcc, -1, v203
    s_add_u32 s99, s99, 1
    s_nop 0
    s_cbranch_vccz Lbk_148
    s_cmp_lt_u32 s99, 3000
    s_cbranch_scc1 Lre_147_l
    s_branch Lbk_148
Lre_149:
    s_mov_b32 s99, 0
Lre_149_l:
    s_add_u32 s98, s17, s29
    s_add_u32 s98, s98, 8406016
    buffer_load_dwordx4 a[24:27], v2, s[4:7], s98 offen sc1
    s_waitcnt vmcnt(0)
    v_accvgpr_read_b32 v203, a24
    v_cmp_eq_u32 vcc, -1, v203
    s_add_u32 s99, s99, 1
    s_nop 0
    s_cbranch_vccz Lbk_150
    s_cmp_lt_u32 s99, 3000
    s_cbranch_scc1 Lre_149_l
    s_branch Lbk_150
Lre_151:
    s_mov_b32 s99, 0
Lre_151_l:
    s_add_u32 s98, s17, s29
    s_add_u32 s98, s98, 8407040
    buffer_load_dwordx4 a[28:31], v2, s[4:7], s98 offen sc1
    s_waitcnt vmcnt(0)
    v_accvgpr_read_b32 v203, a28
    v_cmp_eq_u32 vcc, -1, v203
    s_add_u32 s99, s99, 1
    s_nop 0
    s_cbranch_vccz Lbk_152
    s_cmp_lt_u32 s99, 3000
    s_cbranch_scc1 Lre_151_l
    s_branch Lbk_152
Lre_153:
    s_mov_b32 s99, 0
Lre_153_l:
    s_add_u32 s98, s17, s29
    s_add_u32 s98, s98, 8408064
    buffer_load_dwordx4 a[32:35], v2, s[4:7], s98 offen sc1
    s_waitcnt vmcnt(0)
    v_accvgpr_read_b32 v203, a32
    v_cmp_eq_u32 vcc, -1, v203
    s_add_u32 s99, s99, 1
    s_nop 0
    s_cbranch_vccz Lbk_154
    s_cmp_lt_u32 s99, 3000
    s_cbranch_scc1 Lre_153_l
    s_branch Lbk_154
Lre_155:
    s_mov_b32 s99, 0
Lre_155_l:
    s_add_u32 s98, s17, s29
    s_add_u32 s98, s98, 8409088
    buffer_load_dwordx4 a[36:39], v2, s[4:7], s98 offen sc1
    s_waitcnt vmcnt(0)
    v_accvgpr_read_b32 v203, a36
    v_cmp_eq_u32 vcc, -1, v203
    s_add_u32 s99, s99, 1
    s_nop 0
    s_cbranch_vccz Lbk_156
    s_cmp_lt_u32 s99, 3000
    s_cbranch_scc1 Lre_155_l
    s_branch Lbk_156
Lre_157:
    s_mov_b32 s99, 0
Lre_157_l:
    s_add_u32 s98, s17, s29
    s_add_u32 s98, s98, 8421376
    buffer_load_dwordx4 a[40:43], v2, s[4:7], s98 offen sc1
    s_waitcnt vmcnt(0)
    v_accvgpr_read_b32 v203, a40
    v_cmp_eq_u32 vcc, -1, v203
    s_add_u32 s99, s99, 1
    s_nop 0
    s_cbranch_vccz Lbk_158
    s_cmp_lt_u32 s99, 3000
    s_cbranch_scc1 Lre_157_l
    s_branch Lbk_158
Lre_159:
    s_mov_b32 s99, 0
Lre_159_l:
    s_add_u32 s98, s17, s29
    s_add_u32 s98, s98, 8422400
    buffer_load_dwordx4 a[44:47], v2, s[4:7], s98 offen sc1
    s_waitcnt vmcnt(0)
    v_accvgpr_read_b32 v203, a44
    v_cmp_eq_u32 vcc, -1, v203
    s_add_u32 s99, s99, 1
    s_nop 0
    s_cbranch_vccz Lbk_160
    s_cmp_lt_u32 s99, 3000
    s_cbranch_scc1 Lre_159_l
    s_branch Lbk_160
Lre_161:
    s_mov_b32 s99, 0
Lre_161_l:
    s_add_u32 s98, s17, s29
    s_add_u32 s98, s98, 8423424
    buffer_load_dwordx4 a[48:51], v2, s[4:7], s98 offen sc1
    s_waitcnt vmcnt(0)
    v_accvgpr_read_b32 v203, a48
    v_cmp_eq_u32 vcc, -1, v203
    s_add_u32 s99, s99, 1
    s_nop 0
    s_cbranch_vccz Lbk_162
    s_cmp_lt_u32 s99, 3000
    s_cbranch_scc1 Lre_161_l
    s_branch Lbk_162
Lre_163:
    s_mov_b32 s99, 0
Lre_163_l:
    s_add_u32 s98, s17, s29
    s_add_u32 s98, s98, 8424448
    buffer_load_dwordx4 a[52:55], v2, s[4:7], s98 offen sc1
    s_waitcnt vmcnt(0)
    v_accvgpr_read_b32 v203, a52
    v_cmp_eq_u32 vcc, -1, v203
    s_add_u32 s99, s99, 1
    s_nop 0
    s_cbranch_vccz Lbk_164
    s_cmp_lt_u32 s99, 3000
    s_cbranch_scc1 Lre_163_l
    s_branch Lbk_164
Lre_165:
    s_mov_b32 s99, 0
Lre_165_l:
    s_add_u32 s98, s17, s29
    s_add_u32 s98, s98, 8425472
    buffer_load_dwordx4 a[56:59], v2, s[4:7], s98 offen sc1
    s_waitcnt vmcnt(0)
    v_accvgpr_read_b32 v203, a56
    v_cmp_eq_u32 vcc, -1, v203
    s_add_u32 s99, s99, 1
    s_nop 0
    s_cbranch_vccz Lbk_166
    s_cmp_lt_u32 s99, 3000
    s_cbranch_scc1 Lre_165_l
    s_branch Lbk_166
Lre_167:
    s_mov_b32 s99, 0
Lre_167_l:
    s_add_u32 s98, s17, s29
    s_add_u32 s98, s98, 8437760
    buffer_load_dwordx4 a[60:63], v2, s[4:7], s98 offen sc1
    s_waitcnt vmcnt(0)
    v_accvgpr_read_b32 v203, a60
    v_cmp_eq_u32 vcc, -1, v203
    s_add_u32 s99, s99, 1
    s_nop 0
    s_cbranch_vccz Lbk_168
    s_cmp_lt_u32 s99, 3000
    s_cbranch_scc1 Lre_167_l
    s_branch Lbk_168
Lre_169:
    s_mov_b32 s99, 0
Lre_169_l:
    s_add_u32 s98, s17, s29
    s_add_u32 s98, s98, 8438784
    buffer_load_dwordx4 a[64:67], v2, s[4:7], s98 offen sc1
    s_waitcnt vmcnt(0)
    v_accvgpr_read_b32 v203, a64
    v_cmp_eq_u32 vcc, -1, v203
    s_add_u32 s99, s99, 1
    s_nop 0
    s_cbranch_vccz Lbk_170
    s_cmp_lt_u32 s99, 3000
    s_cbranch_scc1 Lre_169_l
    s_branch Lbk_170
Lre_171:
    s_mov_b32 s99, 0
Lre_171_l:
    s_add_u32 s98, s17, s29
    s_add_u32 s98, s98, 8439808
    buffer_load_dwordx4 a[68:71], v2, s[4:7], s98 offen sc1
    s_waitcnt vmcnt(0)
    v_accvgpr_read_b32 v203, a68
    v_cmp_eq_u32 vcc, -1, v203
    s_add_u32 s99, s99, 1
    s_nop 0
    s_cbranch_vccz Lbk_172
    s_cmp_lt_u32 s99, 3000
    s_cbranch_scc1 Lre_171_l
    s_branch Lbk_172
Lre_173:
    s_mov_b32 s99, 0
Lre_173_l:
    s_add_u32 s98, s17, s29
    s_add_u32 s98, s98, 8440832
    buffer_load_dwordx4 a[72:75], v2, s[4:7], s98 offen sc1
    s_waitcnt vmcnt(0)
    v_accvgpr_read_b32 v203, a72
    v_cmp_eq_u32 vcc, -1, v203
    s_add_u32 s99, s99, 1
    s_nop 0
    s_cbranch_vccz Lbk_174
    s_cmp_lt_u32 s99, 3000
    s_cbranch_scc1 Lre_173_l
    s_branch Lbk_174
Lre_175:
    s_mov_b32 s99, 0
Lre_175_l:
    s_add_u32 s98, s17, s29
    s_add_u32 s98, s98, 8441856
    buffer_load_dwordx4 a[76:79], v2, s[4:7], s98 offen sc1
    s_waitcnt vmcnt(0)
    v_accvgpr_read_b32 v203, a76
    v_cmp_eq_u32 vcc, -1, v203
    s_add_u32 s99, s99, 1
    s_nop 0
    s_cbranch_vccz Lbk_176
    s_cmp_lt_u32 s99, 3000
    s_cbranch_scc1 Lre_175_l
    s_branch Lbk_176
Lre_179:
    s_mov_b32 s99, 0
Lre_179_l:
    s_add_u32 s98, s17, s27
    s_add_u32 s98, s98, 4194304
    buffer_load_dwordx4 a[0:3], v2, s[4:7], s98 offen sc1
    s_waitcnt vmcnt(0)
    v_accvgpr_read_b32 v203, a0
    v_cmp_eq_u32 vcc, -1, v203
    s_add_u32 s99, s99, 1
    s_nop 0
    s_cbranch_vccz Lbk_180
    s_cmp_lt_u32 s99, 3000
    s_cbranch_scc1 Lre_179_l
    s_branch Lbk_180
Lre_181:
    s_mov_b32 s99, 0
Lre_181_l:
    s_add_u32 s98, s17, s27
    s_add_u32 s98, s98, 4195328
    buffer_load_dwordx4 a[4:7], v2, s[4:7], s98 offen sc1
    s_waitcnt vmcnt(0)
    v_accvgpr_read_b32 v203, a4
    v_cmp_eq_u32 vcc, -1, v203
    s_add_u32 s99, s99, 1
    s_nop 0
    s_cbranch_vccz Lbk_182
    s_cmp_lt_u32 s99, 3000
    s_cbranch_scc1 Lre_181_l
    s_branch Lbk_182
Lre_183:
    s_mov_b32 s99, 0
Lre_183_l:
    s_add_u32 s98, s17, s27
    s_add_u32 s98, s98, 4196352
    buffer_load_dwordx4 a[8:11], v2, s[4:7], s98 offen sc1
    s_waitcnt vmcnt(0)
    v_accvgpr_read_b32 v203, a8
    v_cmp_eq_u32 vcc, -1, v203
    s_add_u32 s99, s99, 1
    s_nop 0
    s_cbranch_vccz Lbk_184
    s_cmp_lt_u32 s99, 3000
    s_cbranch_scc1 Lre_183_l
    s_branch Lbk_184
Lre_185:
    s_mov_b32 s99, 0
Lre_185_l:
    s_add_u32 s98, s17, s27
    s_add_u32 s98, s98, 4197376
    buffer_load_dwordx4 a[12:15], v2, s[4:7], s98 offen sc1
    s_waitcnt vmcnt(0)
    v_accvgpr_read_b32 v203, a12
    v_cmp_eq_u32 vcc, -1, v203
    s_add_u32 s99, s99, 1
    s_nop 0
    s_cbranch_vccz Lbk_186
    s_cmp_lt_u32 s99, 3000
    s_cbranch_scc1 Lre_185_l
    s_branch Lbk_186
Lre_187:
    s_mov_b32 s99, 0
Lre_187_l:
    s_add_u32 s98, s17, s27
    s_add_u32 s98, s98, 4198400
    buffer_load_dwordx4 a[16:19], v2, s[4:7], s98 offen sc1
    s_waitcnt vmcnt(0)
    v_accvgpr_read_b32 v203, a16
    v_cmp_eq_u32 vcc, -1, v203
    s_add_u32 s99, s99, 1
    s_nop 0
    s_cbranch_vccz Lbk_188
    s_cmp_lt_u32 s99, 3000
    s_cbranch_scc1 Lre_187_l
    s_branch Lbk_188
Lre_189:
    s_mov_b32 s99, 0
Lre_189_l:
    s_add_u32 s98, s17, s27
    s_add_u32 s98, s98, 4210688
    buffer_load_dwordx4 a[20:23], v2, s[4:7], s98 offen sc1
    s_waitcnt vmcnt(0)
    v_accvgpr_read_b32 v203, a20
    v_cmp_eq_u32 vcc, -1, v203
    s_add_u32 s99, s99, 1
    s_nop 0
    s_cbranch_vccz Lbk_190
    s_cmp_lt_u32 s99, 3000
    s_cbranch_scc1 Lre_189_l
    s_branch Lbk_190
Lre_191:
    s_mov_b32 s99, 0
Lre_191_l:
    s_add_u32 s98, s17, s27
    s_add_u32 s98, s98, 4211712
    buffer_load_dwordx4 a[24:27], v2, s[4:7], s98 offen sc1
    s_add_u32 s98, s17, s27
    s_add_u32 s98, s98, 4212736
    buffer_load_dwordx4 a[28:31], v2, s[4:7], s98 offen sc1
    s_add_u32 s98, s17, s27
    s_add_u32 s98, s98, 4213760
    buffer_load_dwordx4 a[32:35], v2, s[4:7], s98 offen sc1
    s_waitcnt vmcnt(0)
    v_accvgpr_read_b32 v203, a24
    v_accvgpr_read_b32 v23, a28
    v_accvgpr_read_b32 v30, a32
    v_max3_u32 v203, v23, v30, v203
    v_cmp_eq_u32 vcc, -1, v203
    s_add_u32 s99, s99, 1
    s_nop 0
    s_cbranch_vccz Lbk_192
    s_cmp_lt_u32 s99, 3000
    s_cbranch_scc1 Lre_191_l
    s_branch Lbk_192
Lre_193:
    s_mov_b32 s99, 0
Lre_193_l:
    s_add_u32 s98, s17, s27
    s_add_u32 s98, s98, 4214784
    buffer_load_dwordx4 a[36:39], v2, s[4:7], s98 offen sc1
    s_add_u32 s98, s17, s27
    s_add_u32 s98, s98, 4227072
    buffer_load_dwordx4 a[40:43], v2, s[4:7], s98 offen sc1
    s_add_u32 s98, s17, s27
    s_add_u32 s98, s98, 4228096
    buffer_load_dwordx4 a[44:47], v2, s[4:7], s98 offen sc1
    s_waitcnt vmcnt(0)
    v_accvgpr_read_b32 v203, a36
    v_accvgpr_read_b32 v23, a40
    v_accvgpr_read_b32 v30, a44
    v_max3_u32 v203, v23, v30, v203
    v_cmp_eq_u32 vcc, -1, v203
    s_add_u32 s99, s99, 1
    s_nop 0
    s_cbranch_vccz Lbk_194
    s_cmp_lt_u32 s99, 3000
    s_cbranch_scc1 Lre_193_l
    s_branch Lbk_194
Lre_195:
    s_mov_b32 s99, 0
Lre_195_l:
    s_add_u32 s98, s17, s27
    s_add_u32 s98, s98, 4229120
    buffer_load_dwordx4 a[48:51], v2, s[4:7], s98 offen sc1
    s_add_u32 s98, s17, s27
    s_add_u32 s98, s98, 4230144
    buffer_load_dwordx4 a[52:55], v2, s[4:7], s98 offen sc1
    s_add_u32 s98, s17, s27
    s_add_u32 s98, s98, 4231168
    buffer_load_dwordx4 a[56:59], v2, s[4:7], s98 offen sc1
    s_waitcnt vmcnt(0)
    v_accvgpr_read_b32 v203, a48
    v_accvgpr_read_b32 v23, a52
    v_accvgpr_read_b32 v30, a56
    v_max3_u32 v203, v23, v30, v203
    v_cmp_eq_u32 vcc, -1, v203
    s_add_u32 s99, s99, 1
    s_nop 0
    s_cbranch_vccz Lbk_196
    s_cmp_lt_u32 s99, 3000
    s_cbranch_scc1 Lre_195_l
    s_branch Lbk_196
Lre_199:
    s_mov_b32 s99, 0
Lre_199_l:
    s_add_u32 s98, s17, s27
    s_add_u32 s98, s98, 4243456
    buffer_load_dwordx4 a[60:63], v2, s[4:7], s98 offen sc1
    s_add_u32 s98, s17, s27
    s_add_u32 s98, s98, 4244480
    buffer_load_dwordx4 a[64:67], v2, s[4:7], s98 offen sc1
    s_add_u32 s98, s17, s27
    s_add_u32 s98, s98, 4245504
    buffer_load_dwordx4 a[68:71], v2, s[4:7], s98 offen sc1
    s_waitcnt vmcnt(0)
    v_accvgpr_read_b32 v203, a60
    v_accvgpr_read_b32 v23, a64
    v_accvgpr_read_b32 v30, a68
    v_max3_u32 v203, v23, v30, v203
    v_cmp_eq_u32 vcc, -1, v203
    s_add_u32 s99, s99, 1
    s_nop 0
    s_cbranch_vccz Lbk_200
    s_cmp_lt_u32 s99, 3000
    s_cbranch_scc1 Lre_199_l
    s_branch Lbk_200
Lre_201:
    s_mov_b32 s99, 0
Lre_201_l:
    s_add_u32 s98, s17, s27
    s_add_u32 s98, s98, 4246528
    buffer_load_dwordx4 a[72:75], v2, s[4:7], s98 offen sc1
    s_add_u32 s98, s17, s27
    s_add_u32 s98, s98, 4247552
    buffer_load_dwordx4 a[76:79], v2, s[4:7], s98 offen sc1
    s_add_u32 s98, s17, s27
    s_add_u32 s98, s98, 4259840
    buffer_load_dwordx4 a[80:83], v2, s[4:7], s98 offen sc1
    s_waitcnt vmcnt(0)
    v_accvgpr_read_b32 v203, a72
    v_accvgpr_read_b32 v23, a76
    v_accvgpr_read_b32 v30, a80
    v_max3_u32 v203, v23, v30, v203
    v_cmp_eq_u32 vcc, -1, v203
    s_add_u32 s99, s99, 1
    s_nop 0
    s_cbranch_vccz Lbk_202
    s_cmp_lt_u32 s99, 3000
    s_cbranch_scc1 Lre_201_l
    s_branch Lbk_202
Lre_203:
    s_mov_b32 s99, 0
Lre_203_l:
    s_add_u32 s98, s17, s27
    s_add_u32 s98, s98, 4260864
    buffer_load_dwordx4 a[84:87], v2, s[4:7], s98 offen sc1
    s_add_u32 s98, s17, s27
    s_add_u32 s98, s98, 4261888
    buffer_load_dwordx4 a[88:91], v2, s[4:7], s98 offen sc1
    s_add_u32 s98, s17, s27
    s_add_u32 s98, s98, 4262912
    buffer_load_dwordx4 a[92:95], v2, s[4:7], s98 offen sc1
    s_waitcnt vmcnt(0)
    v_accvgpr_read_b32 v203, a84
    v_accvgpr_read_b32 v23, a88
    v_accvgpr_read_b32 v30, a92
    v_max3_u32 v203, v23, v30, v203
    v_cmp_eq_u32 vcc, -1, v203
    s_add_u32 s99, s99, 1
    s_nop 0
    s_cbranch_vccz Lbk_204
    s_cmp_lt_u32 s99, 3000
    s_cbranch_scc1 Lre_203_l
    s_branch Lbk_204
Lre_205:
    s_mov_b32 s99, 0
Lre_205_l:
    s_add_u32 s98, s17, s27
    s_add_u32 s98, s98, 4263936
    buffer_load_dwordx4 a[96:99], v2, s[4:7], s98 offen sc1
    s_add_u32 s98, s17, s27
    s_add_u32 s98, s98, 4276224
    buffer_load_dwordx4 a[100:103], v2, s[4:7], s98 offen sc1
    s_add_u32 s98, s17, s27
    s_add_u32 s98, s98, 4277248
    buffer_load_dwordx4 a[104:107], v2, s[4:7], s98 offen sc1
    s_waitcnt vmcnt(0)
    v_accvgpr_read_b32 v203, a96
    v_accvgpr_read_b32 v23, a100
    v_accvgpr_read_b32 v30, a104
    v_max3_u32 v203, v23, v30, v203
    v_cmp_eq_u32 vcc, -1, v203
    s_add_u32 s99, s99, 1
    s_nop 0
    s_cbranch_vccz Lbk_206
    s_cmp_lt_u32 s99, 3000
    s_cbranch_scc1 Lre_205_l
    s_branch Lbk_206
.section .rodata,"a"
.p2align 6
.amdhsa_kernel interleave_layers__linear_attn_block__glu_gated_swiglu__prompt_kernel
  .amdhsa_next_free_vgpr 512
  .amdhsa_next_free_sgpr 102
  .amdhsa_accum_offset 256
  .amdhsa_group_segment_fixed_size 0
  .amdhsa_kernarg_size 80
  .amdhsa_user_sgpr_count 2
  .amdhsa_user_sgpr_kernarg_segment_ptr 1
  .amdhsa_system_sgpr_workgroup_id_x 1
.end_amdhsa_kernel
```
